```python
import torch

def _softmax(x, axis=-1):
    return torch.softmax(x, dim=axis)
def _gelu(x):
    return torch.nn.functional.gelu(x, approximate="tanh")
def _silu(x):
    return torch.nn.functional.silu(x)
def _sigmoid(x):
    return torch.sigmoid(x)
def _layernorm(x, axis=-1, eps=1e-5):
    m = x.mean(dim=axis, keepdim=True)
    v = x.var(dim=axis, keepdim=True, unbiased=False)
    return (x - m) / torch.sqrt(v + eps)
def _scatter_add(tgt, idx, src, axis=0):
    return tgt.clone().index_add_(axis, idx, src)
def _segment_sum(src, seg, n):
    out = torch.zeros((n,) + src.shape[1:], dtype=src.dtype)
    return out.index_add_(0, seg, src)
def _pad(x, pw):
    flat = tuple(v for pair in reversed(pw) for v in pair)
    return torch.nn.functional.pad(x, flat)

kernel_name = 'gated_mix__linear_kernel_hedgehog__dense_activation_gelu__prompt'

def setup_inputs():

    _w = (lambda a: (lambda t: t.to(torch.bfloat16) if t.is_floating_point() else t)(torch.as_tensor(a)))
    def _A_setup():
        B, S, D, H = 1, 2048, 640, 32
        Dh = D // H
        return {
            "x": _w((lambda *s: torch.randn(*s, dtype=torch.bfloat16) * 0.05)(B, S, D)),
            "wqkv": _w((lambda *s: torch.randn(*s, dtype=torch.bfloat16) * 0.8)(D, 3 * D)),
            "w_phi": _w((lambda *s: torch.randn(*s, dtype=torch.bfloat16) * 0.8)(H, Dh, Dh) * (Dh ** -0.5)),
            "wo": _w((lambda *s: torch.randn(*s, dtype=torch.bfloat16) * 0.05)(D, D)),
        }
    _A_in = _A_setup()

    def _B_setup():
        B, S, D, F = 1, 2048, 640, 1728
        return {
            "x": _w((lambda *s: torch.randn(*s, dtype=torch.bfloat16) * 0.05)(B, S, D)),
            "w1": _w((lambda *s: torch.randn(*s, dtype=torch.bfloat16) * 3.2)(D, F) * (D ** -0.5)),
            "b1": _w((lambda *s: torch.randn(*s, dtype=torch.bfloat16) * 3.2)(F) * 0.01),
            "w2": _w((lambda *s: torch.randn(*s, dtype=torch.bfloat16) * 0.4)(F, D) * (F ** -0.5)),
            "b2": _w((lambda *s: torch.randn(*s, dtype=torch.bfloat16) * 0.8)(D) * 0.01),
        }
    _B_in = _B_setup()

    return {
        "A_x": _A_in["x"],
        "A_wqkv": _A_in["wqkv"],
        "A_w_phi": _A_in["w_phi"],
        "A_wo": _A_in["wo"],
        "B_x": _B_in["x"],
        "B_w1": _B_in["w1"],
        "B_b1": _B_in["b1"],
        "B_w2": _B_in["w2"],
        "B_b2": _B_in["b2"],
        "gate_w": _w((lambda *s: torch.randn(*s, dtype=torch.bfloat16) * 0.05)(640) * 16.0),
    }

def reference(A_x, A_wqkv, A_w_phi, A_wo, B_x, B_w1, B_b1, B_w2, B_b2, gate_w):
    def _A_ref(x, wqkv, w_phi, wo):
        B, S, D = x.shape
        H = 32; Dh = D // H
        qkv = (lambda x, *d: x.permute(*d))((x @ wqkv).reshape(B, S, 3, H, Dh), 2, 0, 3, 1, 4)
        q, k, v = qkv[0], qkv[1], qkv[2]
        pq = torch.einsum("bhsd,hdf->bhsf", q, w_phi)
        pk = torch.einsum("bhsd,hdf->bhsf", k, w_phi)
        phi_q = torch.concatenate([_softmax(pq, axis=-1), _softmax(-pq, axis=-1)], axis=-1)
        phi_k = torch.concatenate([_softmax(pk, axis=-1), _softmax(-pk, axis=-1)], axis=-1)
        kv = torch.einsum("bhsf,bhsd->bhfd", phi_k, v)
        z  = torch.einsum("bhsf->bhf", phi_k)
        num = torch.einsum("bhqf,bhfd->bhqd", phi_q, kv)
        den = torch.einsum("bhqf,bhf->bhq", phi_q, z)[..., None] + 1e-6
        o = num / den
        return (lambda x, *d: x.permute(*d))(o, 0, 2, 1, 3).reshape(B, S, D) @ wo

    def _B_ref(x, w1, b1, w2, b2):
        h = torch.einsum("bsd,df->bsf", x, w1) + b1
        h = _gelu(h)
        return torch.einsum("bsf,fd->bsd", h, w2) + b2

    x = A_x
    g = _sigmoid((x * gate_w).sum(-1, keepdims=True))
    a = _A_ref(x, A_wqkv, A_w_phi, A_wo)
    b = _B_ref(x, B_w1, B_b1, B_w2, B_b2)
    return g * a + (1 - g) * b
```

```asm
; @launch grid=(256,1,1) block=(256,1,1) lds=163840
.amdgcn_target "amdgcn-amd-amdhsa--gfx950"
.text
.globl gated_mix__linear_kernel_hedgehog__dense_activation_gelu__prompt_kernel
.p2align 8
.type gated_mix__linear_kernel_hedgehog__dense_activation_gelu__prompt_kernel,@function
gated_mix__linear_kernel_hedgehog__dense_activation_gelu__prompt_kernel:
    s_cmp_ge_u32 s2, 256
    s_cbranch_scc1 L_end
    s_load_dwordx16 s[32:47], s[0:1], 0
    s_load_dwordx4 s[48:51], s[0:1], 64
    s_load_dwordx2 s[52:53], s[0:1], 80
    s_load_dwordx2 s[56:57], s[0:1], 96
    s_getpc_b64 s[96:97]
L_pf:
    s_lshr_b32 s74, s2, 3
    s_lshl_b32 s74, s74, 11
    v_lshrrev_b32 v1, 4, v0
    v_lshlrev_b32 v1, 7, v1
    v_add_u32 v1, s74, v1
    v_cmp_gt_u32 vcc, L_end-L_pf, v1
    s_nop 1
    v_cndmask_b32 v1, 0, v1, vcc
    global_load_dword v255, v1, s[96:97]
    v_lshrrev_b32 v1, 6, v0
    v_and_b32 v0, 63, v0
    s_and_b32 s74, s2, 7
    v_readfirstlane_b32 s3, v1
    s_lshr_b32 s75, s2, 3
    s_lshr_b32 s76, s74, 1
    s_and_b32 s77, s75, 3
    s_lshl_b32 s60, s76, 2
    s_add_u32 s60, s60, s77
    s_lshr_b32 s78, s75, 2
    s_and_b32 s61, s74, 1
    s_lshl_b32 s61, s61, 2
    s_and_b32 s79, s78, 3
    s_add_u32 s61, s61, s79
    s_xor_b32 s64, s77, s78
    s_and_b32 s64, s64, 1
    s_lshl_b32 s64, s64, 7
    v_and_b32 v1, 15, v0
    v_lshrrev_b32 v2, 4, v0
    v_bfe_u32 v3, v0, 2, 2
    v_and_b32 v4, 3, v0
    v_lshrrev_b32 v5, 3, v0
    v_lshlrev_b32 v6, 4, v0
    s_lshl_b32 s76, s60, 2
    s_add_u32 s76, s76, s3
    s_mul_i32 s76, s76, 40960
    v_xor_b32 v7, v2, v0
    v_and_b32 v7, 7, v7
    v_lshlrev_b32 v7, 4, v7
    v_mul_u32_u24 v8, 1280, v5
    v_add_u32 v8, s76, v8
    v_add_u32 v208, v8, v7
    v_xor_b32 v7, 64, v7
    v_add_u32 v209, v8, v7
    v_add_u32 v209, 9216, v209
    v_add_u32 v210, 18432, v208
    v_add_u32 v211, 18432, v209
    s_lshl_b32 s80, s3, 12
    s_xor_b32 s65, s64, 128
    s_mov_b32 s6, 2621440
    s_mov_b32 s7, 0x20000
    s_mov_b32 s10, 2457600
    s_mov_b32 s11, 0x20000
    s_mov_b32 s14, 2211840
    s_mov_b32 s15, 0x20000
    s_mov_b32 s26, 3456
    s_mov_b32 s27, 0x20000
    s_bitcmp1_b32 s2, 7
    s_cbranch_scc1 L_QH
    s_mul_i32 s81, s3, 5120
    s_add_u32 s81, s81, 16384
    s_lshl_b32 s82, s3, 11
    s_add_u32 s82, s82, 36864
    s_lshl_b32 s89, s61, 7
    s_add_u32 s89, s89, 2432
    s_waitcnt lgkmcnt(0)
    s_load_dwordx2 s[58:59], s[56:57], 0
    s_mov_b32 s4, s32
    s_and_b32 s5, s33, 0xffff
    s_mov_b32 s24, s44
    s_and_b32 s25, s45, 0xffff
    s_mov_b32 s8, s34
    s_and_b32 s9, s35, 0xffff
    s_mov_b32 s12, s42
    s_and_b32 s13, s43, 0xffff
    s_add_u32 m0, s80, 0
    s_nop 0
    buffer_load_dwordx4 v208, s[4:7], s64 offen offset:0  lds
    buffer_load_dwordx4 v209, s[4:7], s64 offen offset:1024  lds
    buffer_load_dwordx4 v210, s[4:7], s64 offen offset:2048  lds
    buffer_load_dwordx4 v211, s[4:7], s64 offen offset:3072  lds
    s_mov_b32 m0, 162176
    s_mov_b64 exec, 0xff
    buffer_load_dwordx4 v6, s[24:27], s89 offen lds
    s_mov_b64 exec, -1
    s_and_b32 s74, s3, 1
    s_mul_i32 s74, s74, 320
    s_lshr_b32 s75, s3, 1
    s_add_u32 s75, s75, 1
    s_mul_i32 s75, s75, 1280
    s_mul_i32 s77, s61, 160
    s_add_u32 s75, s75, s77
    v_add_u32 v9, 0, v0
    v_add_u32 v9, s74, v9
    v_mul_u32_u24 v10, 6554, v9
    v_lshrrev_b32 v10, 16, v10
    v_mad_i32_i24 v11, v10, -10, v9
    v_lshrrev_b32 v12, 1, v10
    v_xor_b32 v12, v12, v10
    v_and_b32 v12, 4, v12
    v_mul_u32_u24 v12, 3, v12
    v_xor_b32 v10, v10, v12
    v_mul_u32_u24 v10, 3840, v10
    v_lshl_add_u32 v10, v11, 4, v10
    v_add_u32 v212, s75, v10
    s_mul_i32 s0, s64, 1920
    s_add_u32 m0, s81, 0
    s_nop 0
    buffer_load_dwordx4 v212, s[8:11], s0 offen offset:0  lds
    v_add_u32 v9, 64, v0
    v_add_u32 v9, s74, v9
    v_mul_u32_u24 v10, 6554, v9
    v_lshrrev_b32 v10, 16, v10
    v_mad_i32_i24 v11, v10, -10, v9
    v_lshrrev_b32 v12, 1, v10
    v_xor_b32 v12, v12, v10
    v_and_b32 v12, 4, v12
    v_mul_u32_u24 v12, 3, v12
    v_xor_b32 v10, v10, v12
    v_mul_u32_u24 v10, 3840, v10
    v_lshl_add_u32 v10, v11, 4, v10
    v_add_u32 v213, s75, v10
    v_subrev_u32 v213, 1024, v213
    buffer_load_dwordx4 v213, s[8:11], s0 offen offset:1024  lds
    v_add_u32 v9, 128, v0
    v_add_u32 v9, s74, v9
    v_mul_u32_u24 v10, 6554, v9
    v_lshrrev_b32 v10, 16, v10
    v_mad_i32_i24 v11, v10, -10, v9
    v_lshrrev_b32 v12, 1, v10
    v_xor_b32 v12, v12, v10
    v_and_b32 v12, 4, v12
    v_mul_u32_u24 v12, 3, v12
    v_xor_b32 v10, v10, v12
    v_mul_u32_u24 v10, 3840, v10
    v_lshl_add_u32 v10, v11, 4, v10
    v_add_u32 v214, s75, v10
    v_subrev_u32 v214, 2048, v214
    buffer_load_dwordx4 v214, s[8:11], s0 offen offset:2048  lds
    v_add_u32 v9, 192, v0
    v_add_u32 v9, s74, v9
    v_mul_u32_u24 v10, 6554, v9
    v_lshrrev_b32 v10, 16, v10
    v_mad_i32_i24 v11, v10, -10, v9
    v_lshrrev_b32 v12, 1, v10
    v_xor_b32 v12, v12, v10
    v_and_b32 v12, 4, v12
    v_mul_u32_u24 v12, 3, v12
    v_xor_b32 v10, v10, v12
    v_mul_u32_u24 v10, 3840, v10
    v_lshl_add_u32 v10, v11, 4, v10
    v_add_u32 v215, s75, v10
    v_subrev_u32 v215, 3072, v215
    buffer_load_dwordx4 v215, s[8:11], s0 offen offset:3072  lds
    v_add_u32 v9, 256, v0
    v_add_u32 v9, s74, v9
    v_mul_u32_u24 v10, 6554, v9
    v_lshrrev_b32 v10, 16, v10
    v_mad_i32_i24 v11, v10, -10, v9
    v_lshrrev_b32 v12, 1, v10
    v_xor_b32 v12, v12, v10
    v_and_b32 v12, 4, v12
    v_mul_u32_u24 v12, 3, v12
    v_xor_b32 v10, v10, v12
    v_mul_u32_u24 v10, 3840, v10
    v_lshl_add_u32 v10, v11, 4, v10
    v_add_u32 v216, s75, v10
    s_add_u32 m0, m0, 4096
    s_nop 0
    buffer_load_dwordx4 v216, s[8:11], s0 offen offset:0  lds
    s_lshl_b32 s77, s3, 4
    v_lshlrev_b32 v11, 1, v2
    v_xor_b32 v11, v11, v0
    v_and_b32 v11, 7, v11
    v_add_u32 v10, 0, v5
    v_add_u32 v10, s77, v10
    v_lshrrev_b32 v12, 1, v10
    v_xor_b32 v12, v12, v10
    v_and_b32 v12, 4, v12
    v_mul_u32_u24 v12, 3, v12
    v_xor_b32 v10, v10, v12
    v_mul_u32_u24 v10, 3456, v10
    v_lshl_add_u32 v10, v11, 4, v10
    v_add_u32 v10, s89, v10
    v_subrev_u32 v217, 0, v10
    s_mul_i32 s1, s64, 1728
    s_add_u32 m0, s82, 0
    s_nop 0
    buffer_load_dwordx4 v217, s[12:15], s1 offen offset:0  lds
    v_add_u32 v10, 8, v5
    v_add_u32 v10, s77, v10
    v_lshrrev_b32 v12, 1, v10
    v_xor_b32 v12, v12, v10
    v_and_b32 v12, 4, v12
    v_mul_u32_u24 v12, 3, v12
    v_xor_b32 v10, v10, v12
    v_mul_u32_u24 v10, 3456, v10
    v_lshl_add_u32 v10, v11, 4, v10
    v_add_u32 v10, s89, v10
    v_subrev_u32 v218, 1024, v10
    buffer_load_dwordx4 v218, s[12:15], s1 offen offset:1024  lds
    s_mov_b32 s24, s50
    s_and_b32 s25, s51, 0xffff
    s_mov_b32 s26, 1280
    s_mov_b32 s27, 0x20000
    v_xor_b32 v9, s64, v6
    v_add_u32 v11, 1024, v9
    s_mov_b32 m0, 160896
    s_nop 0
    buffer_load_dwordx4 v9, s[24:27], 0 offen lds
    s_mov_b32 m0, 161920
    s_mov_b64 exec, 0xffff
    buffer_load_dwordx4 v11, s[24:27], 0 offen lds
    s_mov_b64 exec, -1
    s_cmp_eq_u32 s3, 0
    s_cselect_b64 s[28:29], s[4:5], s[12:13]
    s_cselect_b32 s30, s6, s14
    s_cselect_b32 s74, 12, 0
    s_add_u32 s74, s74, 68
    s_cmp_eq_u32 s3, 1
    s_cselect_b64 s[28:29], s[8:9], s[28:29]
    s_cselect_b32 s30, s10, s30
    s_cselect_b32 s74, 75, s74
    s_lshl_b32 s75, 1, s3
    s_and_b32 s75, s75, 7
    s_cselect_b32 s30, s30, 0
    s_mov_b32 s31, 0x20000
    s_mul_i32 s75, s74, s2
    s_lshl_b32 s75, s75, 7
    v_lshlrev_b32 v10, 7, v0
    v_add_u32 v11, 64, v0
    v_cmp_gt_u32 vcc, s74, v11
    v_lshlrev_b32 v11, 7, v11
    v_mov_b32 v14, 2146435072
    v_cndmask_b32 v11, v14, v11, vcc
    buffer_load_dword v255, v10, s[28:31], s75 offen
    buffer_load_dword v255, v11, s[28:31], s75 offen
    v_lshrrev_b32 v9, 1, v1
    v_xor_b32 v9, v9, v2
    v_lshlrev_b32 v9, 4, v9
    v_lshl_add_u32 v9, v1, 7, v9
    v_add_u32 v220, s80, v9
    v_xor_b32 v221, 64, v220
    v_add_u32 v222, 45056, v220
    v_add_u32 v223, 45056, v221
    v_add_u32 v224, 90112, v220
    v_add_u32 v225, 90112, v221
    v_lshrrev_b32 v8, 1, v2
    v_lshl_add_u32 v8, v8, 4, v3
    v_and_b32 v7, 1, v2
    v_lshl_add_u32 v8, v7, 2, v8
    v_mul_u32_u24 v9, 160, v8
    v_mad_u32_u24 v9, v4, 40, v9
    v_add_u32 v226, 16384, v9
    v_add_u32 v227, 45056, v226
    v_add_u32 v228, 90112, v226
    v_lshlrev_b32 v9, 7, v8
    v_lshl_add_u32 v9, v4, 3, v9
    v_add_u32 v9, 36864, v9
    v_bfe_u32 v10, v8, 1, 2
    v_xor_b32 v11, 0, v10
    v_lshl_add_u32 v229, v11, 5, v9
    v_add_u32 v204, 90112, v229
    v_xor_b32 v11, 1, v10
    v_lshl_add_u32 v230, v11, 5, v9
    v_add_u32 v205, 90112, v230
    v_xor_b32 v11, 2, v10
    v_lshl_add_u32 v231, v11, 5, v9
    v_add_u32 v206, 90112, v231
    v_xor_b32 v11, 3, v10
    v_lshl_add_u32 v232, v11, 5, v9
    v_add_u32 v207, 90112, v232
    v_lshlrev_b32 v233, 4, v2
    v_add_u32 v233, 160896, v233
    v_lshlrev_b32 v253, 3, v2
    v_add_u32 v253, 162176, v253
    s_and_b32 s74, s2, 7
    s_lshr_b32 s75, s2, 3
    s_lshr_b32 s76, s74, 1
    s_and_b32 s77, s75, 3
    s_lshr_b32 s78, s75, 2
    s_lshr_b32 s79, s75, 2
    s_and_b32 s79, s79, 4
    s_xor_b32 s79, s79, s75
    s_and_b32 s62, s79, 7
    s_bfe_u32 s79, s75, 0x20002
    s_lshl_b32 s76, s76, 3
    s_add_u32 s62, s62, s76
    s_and_b32 s63, s74, 1
    s_lshl_b32 s63, s63, 2
    s_add_u32 s63, s63, s79
    s_mov_b32 s16, s56
    s_and_b32 s17, s57, 0xffff
    s_mov_b32 s18, 268435456
    s_mov_b32 s19, 0x20000
    s_mov_b32 s24, s36
    s_and_b32 s25, s37, 0xffff
    s_mov_b32 s26, 25600
    s_mov_b32 s27, 0x20000
    s_lshl_b32 s77, s61, 2
    s_add_u32 s77, s77, s3
    s_mul_i32 s36, s77, 800
    s_mul_i32 s37, s3, 800
    s_add_u32 s37, s37, 157696
    s_add_u32 s66, s64, 256
    s_add_u32 s67, s65, 256
    s_add_u32 s68, s66, 256
    s_add_u32 s69, s67, 256
    s_add_u32 s70, s68, 256
    s_add_u32 s71, s69, 256
    s_add_u32 s72, s70, 256
    s_add_u32 s73, s71, 256
    s_mul_i32 s97, s63, 74
    s_add_u32 s97, s97, s3
    s_mul_i32 s97, s97, 5120
    s_add_u32 s97, s97, 3145728
    s_mul_i32 s96, s62, 74
    s_add_u32 s96, s96, s3
    s_lshl_b32 s96, s96, 12
    s_add_u32 s96, s96, 6291456
    s_add_u32 s86, s97, 184320
    s_add_u32 s87, s96, 147456
    s_cmp_lt_u32 s3, 2
    s_cselect_b32 s86, s86, 2146435072
    s_cselect_b32 s87, s87, 2146435072
    s_mul_i32 s88, s3, 18432
    v_add_u32 v240, 4096, v6
    s_add_u32 s77, s3, 0
    s_and_b32 s77, s77, 3
    s_lshl_b32 s77, s77, 10
    v_add_u32 v236, s77, v6
    s_add_u32 s77, s3, 1
    s_and_b32 s77, s77, 3
    s_lshl_b32 s77, s77, 10
    v_add_u32 v237, s77, v6
    s_add_u32 s77, s3, 2
    s_and_b32 s77, s77, 3
    s_lshl_b32 s77, s77, 10
    v_add_u32 v238, s77, v6
    s_add_u32 s77, s3, 3
    s_and_b32 s77, s77, 3
    s_lshl_b32 s77, s77, 10
    v_add_u32 v239, s77, v6
    s_lshl_b32 s91, s2, 7
    s_add_u32 s91, s91, 98304
    s_cmp_eq_u32 s3, 0
    s_cselect_b32 s91, s91, 2146435072
    v_mov_b32 v245, 2146435072
    v_cmp_eq_u32 vcc, 0, v0
    s_nop 1
    v_cndmask_b32 v245, v245, 0, vcc
    s_lshl_b32 s74, s2, 2
    s_add_u32 s74, s74, s3
    s_mul_i32 s76, s74, 886
    s_lshr_b32 s76, s76, 16
    s_mul_i32 s75, s76, 74
    s_sub_u32 s75, s74, s75
    s_sub_u32 s77, s75, 54
    s_and_b32 s77, s77, 63
    s_mul_i32 s78, s77, 52
    s_lshr_b32 s78, s78, 8
    s_mul_i32 s79, s78, 5
    s_sub_u32 s79, s77, s79
    s_mul_i32 s100, s78, 160
    s_lshr_b32 s101, s79, 1
    s_mul_i32 s101, s101, 80
    s_and_b32 s77, s79, 1
    s_lshl_b32 s77, s77, 3
    s_add_u32 s101, s101, s77
    s_cmp_eq_u32 s79, 4
    s_cselect_b32 s101, 16, s101
    s_cselect_b32 s77, 80, 4
    s_add_u32 s100, s100, s101
    s_lshl_b32 s101, s75, 5
    s_cmp_lt_u32 s75, 54
    s_cselect_b32 s100, s101, s100
    s_cselect_b32 s77, 16, s77
    s_mov_b32 s78, 24576
    s_cselect_b32 s78, 4096, s78
    s_mov_b32 s22, 819200
    s_cselect_b32 s22, 2211840, s22
    s_mov_b32 s23, 0x20000
    s_cmp_lt_u32 s74, 740
    s_cselect_b32 s22, s22, 0
    s_mul_i32 s100, s100, 1280
    s_lshl_b32 s101, s76, 7
    s_add_u32 s32, s100, s101
    s_add_u32 s33, s32, s78
    s_add_u32 s34, s33, s78
    s_add_u32 s35, s34, s78
    v_lshrrev_b32 v9, 5, v0
    v_mul_lo_u32 v9, v9, s77
    v_and_b32 v10, 3, v5
    v_add_u32 v9, v9, v10
    v_mul_u32_u24 v9, 1280, v9
    v_and_b32 v10, 7, v0
    v_lshl_add_u32 v252, v10, 4, v9
    v_lshlrev_b32 v9, 10, v2
    v_lshl_add_u32 v9, v3, 7, v9
    v_add_u32 v9, s80, v9
    v_add_u32 v9, 141312, v9
    s_lshl_b32 s77, s76, 1
    s_add_u32 s77, s77, 0
    s_mul_i32 s78, s77, 52
    s_lshr_b32 s78, s78, 8
    s_mul_i32 s79, s78, 5
    s_sub_u32 s79, s77, s79
    s_cmp_eq_u32 s79, 2
    s_cselect_b32 s77, 3, 4
    s_cselect_b32 s101, 32, 8
    v_lshlrev_b32 v10, s77, v4
    v_add_u32 v200, v9, v10
    v_add_u32 v201, s101, v200
    s_mul_i32 s78, s78, 740
    s_mul_i32 s101, s75, 5
    s_add_u32 s78, s78, s101
    s_lshl_b32 s77, s79, 1
    s_add_u32 s77, s77, 0
    s_add_u32 s92, s77, 364
    s_cmp_eq_u32 s77, 5
    s_cselect_b32 s92, 374, s92
    s_cmp_lt_u32 s77, 5
    s_cselect_b32 s92, s77, s92
    s_add_u32 s92, s92, s78
    s_lshl_b32 s92, s92, 10
    s_add_u32 s92, s92, 3145728
    s_cmp_lt_u32 s74, 740
    s_cselect_b32 s92, s92, 2146435072
    s_lshl_b32 s77, s79, 1
    s_add_u32 s77, s77, 1
    s_add_u32 s93, s77, 364
    s_cmp_eq_u32 s77, 5
    s_cselect_b32 s93, 374, s93
    s_cmp_lt_u32 s77, 5
    s_cselect_b32 s93, s77, s93
    s_add_u32 s93, s93, s78
    s_lshl_b32 s93, s93, 10
    s_add_u32 s93, s93, 3145728
    s_cmp_lt_u32 s74, 740
    s_cselect_b32 s93, s93, 2146435072
    s_lshl_b32 s77, s76, 1
    s_add_u32 s77, s77, 1
    s_mul_i32 s78, s77, 52
    s_lshr_b32 s78, s78, 8
    s_mul_i32 s79, s78, 5
    s_sub_u32 s79, s77, s79
    s_cmp_eq_u32 s79, 2
    s_cselect_b32 s77, 3, 4
    s_cselect_b32 s101, 32, 8
    v_lshlrev_b32 v10, s77, v4
    v_add_u32 v202, v9, v10
    v_add_u32 v203, s101, v202
    s_mul_i32 s78, s78, 740
    s_mul_i32 s101, s75, 5
    s_add_u32 s78, s78, s101
    s_lshl_b32 s77, s79, 1
    s_add_u32 s77, s77, 0
    s_add_u32 s94, s77, 364
    s_cmp_eq_u32 s77, 5
    s_cselect_b32 s94, 374, s94
    s_cmp_lt_u32 s77, 5
    s_cselect_b32 s94, s77, s94
    s_add_u32 s94, s94, s78
    s_lshl_b32 s94, s94, 10
    s_add_u32 s94, s94, 3145728
    s_cmp_lt_u32 s74, 740
    s_cselect_b32 s94, s94, 2146435072
    s_lshl_b32 s77, s79, 1
    s_add_u32 s77, s77, 1
    s_add_u32 s95, s77, 364
    s_cmp_eq_u32 s77, 5
    s_cselect_b32 s95, 374, s95
    s_cmp_lt_u32 s77, 5
    s_cselect_b32 s95, s77, s95
    s_add_u32 s95, s95, s78
    s_lshl_b32 s95, s95, 10
    s_add_u32 s95, s95, 3145728
    s_cmp_lt_u32 s74, 740
    s_cselect_b32 s95, s95, 2146435072
    s_cmp_lt_u32 s75, 54
    s_cselect_b32 s20, s46, s38
    s_cselect_b32 s21, s47, s39
    s_and_b32 s21, s21, 0xffff
    v_lshrrev_b32 v8, 2, v1
    v_mul_u32_u24 v8, 2560, v8
    v_lshl_add_u32 v8, v4, 5, v8
    v_lshrrev_b32 v9, 1, v2
    v_lshl_add_u32 v8, v9, 9, v8
    v_and_b32 v9, 1, v2
    v_lshl_add_u32 v8, v9, 4, v8
    s_lshl_b32 s74, s3, 7
    v_add_u32 v241, s74, v8
    v_add_u32 v243, 10240, v241
    v_mov_b32 v9, 2146435072
    v_cmp_ge_u32 vcc, 7, v1
    s_nop 1
    v_cndmask_b32 v243, v9, v243, vcc
    v_cmp_gt_u32 vcc, 2, v2
    s_nop 1
    v_cndmask_b32 v242, v9, v241, vcc
    v_cndmask_b32 v244, v9, v243, vcc
    v_mul_u32_u24 v12, 15360, v2
    v_min_u32 v10, 14, v1
    v_lshl_add_u32 v12, v10, 4, v12
    v_lshlrev_b32 v13, 4, v1
    v_cmp_gt_u32 vcc, 16, v0
    s_nop 1
    v_cndmask_b32 v234, v9, v13, vcc
    v_cmp_gt_u32 vcc, 15, v0
    s_nop 1
    v_cndmask_b32 v13, v9, v13, vcc
    s_waitcnt lgkmcnt(0)
    s_add_u32 s58, s58, 1
    v_mov_b32 v247, s59
    v_mov_b32 v246, s58
    s_movk_i32 s42, 1023
    s_waitcnt vmcnt(11)
    ds_read_b64 v[136:137], v253 offset:0
    ds_read_b64 v[138:139], v253 offset:32
    ds_read_b64 v[140:141], v253 offset:64
    ds_read_b64 v[142:143], v253 offset:96
    s_waitcnt lgkmcnt(3)
    v_lshlrev_b32 v96, 16, v136
    v_and_b32 v97, 0xffff0000, v136
    v_lshlrev_b32 v98, 16, v137
    v_and_b32 v99, 0xffff0000, v137
    s_waitcnt lgkmcnt(2)
    v_lshlrev_b32 v104, 16, v138
    v_and_b32 v105, 0xffff0000, v138
    v_lshlrev_b32 v106, 16, v139
    v_and_b32 v107, 0xffff0000, v139
    s_waitcnt lgkmcnt(1)
    v_lshlrev_b32 v112, 16, v140
    v_and_b32 v113, 0xffff0000, v140
    v_lshlrev_b32 v114, 16, v141
    v_and_b32 v115, 0xffff0000, v141
    s_waitcnt lgkmcnt(0)
    v_lshlrev_b32 v120, 16, v142
    v_and_b32 v121, 0xffff0000, v142
    v_lshlrev_b32 v122, 16, v143
    v_and_b32 v123, 0xffff0000, v143
    v_mul_u32_u24 v254, 800, v2
    v_mad_u32_u24 v254, v3, 40, v254
    v_add_u32 v254, 157696, v254
    s_waitcnt vmcnt(2)
    s_barrier
    ds_read_b64_tr_b16 v[168:169], v226 offset:0
    ds_read_b64_tr_b16 v[170:171], v226 offset:1280
    ds_read_b64_tr_b16 v[172:173], v226 offset:5120
    ds_read_b64_tr_b16 v[174:175], v226 offset:6400
    ds_read_b128 v[144:147], v220 offset:2048
    ds_read_b128 v[148:151], v221 offset:2048
    ds_read_b128 v[136:139], v220 offset:0
    ds_read_b128 v[140:143], v221 offset:0
    ds_read_b64_tr_b16 v[176:177], v226 offset:8
    ds_read_b64_tr_b16 v[178:179], v226 offset:1288
    ds_read_b64_tr_b16 v[180:181], v226 offset:5128
    ds_read_b64_tr_b16 v[182:183], v226 offset:6408
    s_waitcnt lgkmcnt(7)
    v_mfma_f32_16x16x32_bf16 v[20:23], v[168:171], v[144:147], 0
    ds_read_b64_tr_b16 v[184:185], v226 offset:16
    s_waitcnt lgkmcnt(7)
    v_mfma_f32_16x16x32_bf16 v[20:23], v[172:175], v[148:151], v[20:23]
    ds_read_b64_tr_b16 v[186:187], v226 offset:1296
    s_waitcnt lgkmcnt(7)
    v_mfma_f32_16x16x32_bf16 v[16:19], v[168:171], v[136:139], 0
    ds_read_b64_tr_b16 v[188:189], v226 offset:5136
    s_add_u32 m0, s80, 45056
    s_waitcnt lgkmcnt(7)
    v_mfma_f32_16x16x32_bf16 v[16:19], v[172:175], v[140:143], v[16:19]
    buffer_load_dwordx4 v208, s[4:7], s65 offen offset:0  lds
    s_waitcnt lgkmcnt(3)
    v_mfma_f32_16x16x32_bf16 v[28:31], v[176:179], v[144:147], 0
    buffer_load_dwordx4 v209, s[4:7], s65 offen offset:1024  lds
    ds_read_b64_tr_b16 v[190:191], v226 offset:6416
    v_mfma_f32_16x16x32_bf16 v[28:31], v[180:183], v[148:151], v[28:31]
    ds_read_b64_tr_b16 v[192:193], v226 offset:24
    ds_read_b64_tr_b16 v[194:195], v226 offset:1304
    v_mfma_f32_16x16x32_bf16 v[24:27], v[176:179], v[136:139], 0
    buffer_load_dwordx4 v210, s[4:7], s65 offen offset:2048  lds
    ds_read_b64_tr_b16 v[196:197], v226 offset:5144
    v_mfma_f32_16x16x32_bf16 v[24:27], v[180:183], v[140:143], v[24:27]
    ds_read_b64_tr_b16 v[198:199], v226 offset:6424
    s_waitcnt lgkmcnt(4)
    v_mfma_f32_16x16x32_bf16 v[36:39], v[184:187], v[144:147], 0
    buffer_load_dwordx4 v211, s[4:7], s65 offen offset:3072  lds
    ds_read_b64_tr_b16 v[168:169], v226 offset:32
    v_mfma_f32_16x16x32_bf16 v[36:39], v[188:191], v[148:151], v[36:39]
    ds_read_b64_tr_b16 v[170:171], v226 offset:1312
    ds_read_b64_tr_b16 v[172:173], v226 offset:5152
    v_mfma_f32_16x16x32_bf16 v[32:35], v[184:187], v[136:139], 0
    ds_read_b64_tr_b16 v[174:175], v226 offset:6432
    s_mul_i32 s0, s65, 1920
    v_mfma_f32_16x16x32_bf16 v[32:35], v[188:191], v[140:143], v[32:35]
    ds_read_b64_tr_b16 v[176:177], v226 offset:10240
    s_waitcnt lgkmcnt(5)
    v_mfma_f32_16x16x32_bf16 v[44:47], v[192:195], v[144:147], 0
    ds_read_b64_tr_b16 v[178:179], v226 offset:11520
    ds_read_b64_tr_b16 v[180:181], v226 offset:15360
    v_mfma_f32_16x16x32_bf16 v[44:47], v[196:199], v[148:151], v[44:47]
    ds_read_b64_tr_b16 v[182:183], v226 offset:16640
    s_add_u32 m0, s81, 45056
    v_mfma_f32_16x16x32_bf16 v[40:43], v[192:195], v[136:139], 0
    buffer_load_dwordx4 v212, s[8:11], s0 offen offset:0  lds
    ds_read_b64_tr_b16 v[184:185], v226 offset:10248
    v_mfma_f32_16x16x32_bf16 v[40:43], v[196:199], v[140:143], v[40:43]
    buffer_load_dwordx4 v213, s[8:11], s0 offen offset:1024  lds
    s_waitcnt lgkmcnt(5)
    v_mfma_f32_16x16x32_bf16 v[52:55], v[168:171], v[144:147], 0
    ds_read_b64_tr_b16 v[186:187], v226 offset:11528
    ds_read_b64_tr_b16 v[188:189], v226 offset:15368
    v_mfma_f32_16x16x32_bf16 v[52:55], v[172:175], v[148:151], v[52:55]
    buffer_load_dwordx4 v214, s[8:11], s0 offen offset:2048  lds
    ds_read_b64_tr_b16 v[190:191], v226 offset:16648
    v_mfma_f32_16x16x32_bf16 v[48:51], v[168:171], v[136:139], 0
    ds_read_b64_tr_b16 v[192:193], v226 offset:10256
    v_mfma_f32_16x16x32_bf16 v[48:51], v[172:175], v[140:143], v[48:51]
    ds_read_b64_tr_b16 v[194:195], v226 offset:11536
    s_waitcnt lgkmcnt(6)
    v_mfma_f32_16x16x32_bf16 v[60:63], v[176:179], v[144:147], 0
    buffer_load_dwordx4 v215, s[8:11], s0 offen offset:3072  lds
    ds_read_b64_tr_b16 v[196:197], v226 offset:15376
    v_mfma_f32_16x16x32_bf16 v[60:63], v[180:183], v[148:151], v[60:63]
    ds_read_b64_tr_b16 v[198:199], v226 offset:16656
    s_add_u32 m0, m0, 4096
    v_mfma_f32_16x16x32_bf16 v[56:59], v[176:179], v[136:139], 0
    buffer_load_dwordx4 v216, s[8:11], s0 offen offset:0  lds
    ds_read_b64_tr_b16 v[168:169], v226 offset:10264
    v_mfma_f32_16x16x32_bf16 v[56:59], v[180:183], v[140:143], v[56:59]
    ds_read_b64_tr_b16 v[170:171], v226 offset:11544
    s_waitcnt lgkmcnt(6)
    v_mfma_f32_16x16x32_bf16 v[68:71], v[184:187], v[144:147], 0
    ds_read_b64_tr_b16 v[172:173], v226 offset:15384
    ds_read_b64_tr_b16 v[174:175], v226 offset:16664
    v_mfma_f32_16x16x32_bf16 v[68:71], v[188:191], v[148:151], v[68:71]
    ds_read_b64_tr_b16 v[176:177], v226 offset:10272
    s_mul_i32 s1, s65, 1728
    v_mfma_f32_16x16x32_bf16 v[64:67], v[184:187], v[136:139], 0
    ds_read_b64_tr_b16 v[178:179], v226 offset:11552
    s_add_u32 m0, s82, 45056
    v_mfma_f32_16x16x32_bf16 v[64:67], v[188:191], v[140:143], v[64:67]
    buffer_load_dwordx4 v217, s[12:15], s1 offen offset:0  lds
    s_waitcnt lgkmcnt(6)
    v_mfma_f32_16x16x32_bf16 v[76:79], v[192:195], v[144:147], 0
    buffer_load_dwordx4 v218, s[12:15], s1 offen offset:1024  lds
    ds_read_b64_tr_b16 v[180:181], v226 offset:15392
    v_mfma_f32_16x16x32_bf16 v[76:79], v[196:199], v[148:151], v[76:79]
    ds_read_b64_tr_b16 v[182:183], v226 offset:16672
    v_mfma_f32_16x16x32_bf16 v[72:75], v[192:195], v[136:139], 0
    ds_read_b64_tr_b16 v[184:185], v229 offset:0
    v_mfma_f32_16x16x32_bf16 v[72:75], v[196:199], v[140:143], v[72:75]
    s_mov_b32 m0, s37
    s_mov_b32 exec_hi, 0x3ffff
    buffer_load_dwordx4 v6, s[24:27], s36 offen lds
    s_mov_b64 exec, -1
    s_waitcnt lgkmcnt(5)
    v_mfma_f32_16x16x32_bf16 v[84:87], v[168:171], v[144:147], 0
    ds_read_b64_tr_b16 v[186:187], v229 offset:1024
    ds_read_b64_tr_b16 v[188:189], v229 offset:4096
    v_mfma_f32_16x16x32_bf16 v[84:87], v[172:175], v[148:151], v[84:87]
    ds_read_b64_tr_b16 v[190:191], v229 offset:5120
    s_add_u32 m0, s80, 90112
    v_mfma_f32_16x16x32_bf16 v[80:83], v[168:171], v[136:139], 0
    buffer_load_dwordx4 v208, s[4:7], s66 offen offset:0  lds
    ds_read_b64_tr_b16 v[192:193], v230 offset:0
    v_mfma_f32_16x16x32_bf16 v[80:83], v[172:175], v[140:143], v[80:83]
    ds_read_b64_tr_b16 v[194:195], v230 offset:1024
    s_waitcnt lgkmcnt(6)
    v_mfma_f32_16x16x32_bf16 v[92:95], v[176:179], v[144:147], 0
    buffer_load_dwordx4 v209, s[4:7], s66 offen offset:1024  lds
    ds_read_b64_tr_b16 v[196:197], v230 offset:4096
    v_mfma_f32_16x16x32_bf16 v[92:95], v[180:183], v[148:151], v[92:95]
    ds_read_b64_tr_b16 v[198:199], v230 offset:5120
    v_mfma_f32_16x16x32_bf16 v[88:91], v[176:179], v[136:139], 0
    ds_read_b64_tr_b16 v[168:169], v231 offset:0
    v_mfma_f32_16x16x32_bf16 v[88:91], v[180:183], v[140:143], v[88:91]
    buffer_load_dwordx4 v210, s[4:7], s66 offen offset:2048  lds
    s_waitcnt lgkmcnt(5)
    v_mfma_f32_16x16x32_bf16 v[100:103], v[184:187], v[144:147], v[96:99]
    ds_read_b64_tr_b16 v[170:171], v231 offset:1024
    ds_read_b64_tr_b16 v[172:173], v231 offset:4096
    v_mfma_f32_16x16x32_bf16 v[100:103], v[188:191], v[148:151], v[100:103]
    ds_read_b64_tr_b16 v[174:175], v231 offset:5120
    v_mfma_f32_16x16x32_bf16 v[96:99], v[184:187], v[136:139], v[96:99]
    buffer_load_dwordx4 v211, s[4:7], s66 offen offset:3072  lds
    ds_read_b64_tr_b16 v[176:177], v232 offset:0
    v_mfma_f32_16x16x32_bf16 v[96:99], v[188:191], v[140:143], v[96:99]
    ds_read_b64_tr_b16 v[178:179], v232 offset:1024
    s_waitcnt lgkmcnt(6)
    v_mfma_f32_16x16x32_bf16 v[108:111], v[192:195], v[144:147], v[104:107]
    ds_read_b64_tr_b16 v[180:181], v232 offset:4096
    ds_read_b64_tr_b16 v[182:183], v232 offset:5120
    v_mfma_f32_16x16x32_bf16 v[108:111], v[196:199], v[148:151], v[108:111]
    ds_read_b128 v[184:187], v233 offset:0
    s_mul_i32 s0, s66, 1920
    v_mfma_f32_16x16x32_bf16 v[104:107], v[192:195], v[136:139], v[104:107]
    ds_read_b128 v[188:191], v233 offset:64
    s_add_u32 m0, s81, 90112
    v_mfma_f32_16x16x32_bf16 v[104:107], v[196:199], v[140:143], v[104:107]
    buffer_load_dwordx4 v212, s[8:11], s0 offen offset:0  lds
    s_waitcnt lgkmcnt(6)
    v_mfma_f32_16x16x32_bf16 v[116:119], v[168:171], v[144:147], v[112:115]
    s_waitcnt vmcnt(6) lgkmcnt(0)
    s_barrier
    ds_read_b64_tr_b16 v[192:193], v227 offset:0
    v_mfma_f32_16x16x32_bf16 v[116:119], v[172:175], v[148:151], v[116:119]
    buffer_load_dwordx4 v213, s[8:11], s0 offen offset:1024  lds
    v_mfma_f32_16x16x32_bf16 v[112:115], v[168:171], v[136:139], v[112:115]
    buffer_load_dwordx4 v214, s[8:11], s0 offen offset:2048  lds
    ds_read_b64_tr_b16 v[194:195], v227 offset:1280
    v_mfma_f32_16x16x32_bf16 v[112:115], v[172:175], v[140:143], v[112:115]
    ds_read_b64_tr_b16 v[196:197], v227 offset:5120
    v_mfma_f32_16x16x32_bf16 v[124:127], v[176:179], v[144:147], v[120:123]
    ds_read_b64_tr_b16 v[198:199], v227 offset:6400
    ds_read_b128 v[152:155], v222 offset:0
    v_mfma_f32_16x16x32_bf16 v[124:127], v[180:183], v[148:151], v[124:127]
    buffer_load_dwordx4 v215, s[8:11], s0 offen offset:3072  lds
    ds_read_b128 v[156:159], v223 offset:0
    v_mfma_f32_16x16x32_bf16 v[120:123], v[176:179], v[136:139], v[120:123]
    ds_read_b128 v[160:163], v222 offset:2048
    s_add_u32 m0, m0, 4096
    v_mfma_f32_16x16x32_bf16 v[120:123], v[180:183], v[140:143], v[120:123]
    buffer_load_dwordx4 v216, s[8:11], s0 offen offset:0  lds
    ds_read_b128 v[164:167], v223 offset:2048
    s_mul_i32 s1, s66, 1728
    v_mfma_f32_16x16x32_bf16 v[132:135], v[184:187], v[144:147], 0
    ds_read_b64_tr_b16 v[168:169], v227 offset:8
    ds_read_b64_tr_b16 v[170:171], v227 offset:1288
    s_add_u32 m0, s82, 90112
    v_mfma_f32_16x16x32_bf16 v[132:135], v[188:191], v[148:151], v[132:135]
    buffer_load_dwordx4 v217, s[12:15], s1 offen offset:0  lds
    ds_read_b64_tr_b16 v[172:173], v227 offset:5128
    v_mfma_f32_16x16x32_bf16 v[128:131], v[184:187], v[136:139], 0
    buffer_load_dwordx4 v218, s[12:15], s1 offen offset:1024  lds
    ds_read_b64_tr_b16 v[174:175], v227 offset:6408
    v_mfma_f32_16x16x32_bf16 v[128:131], v[188:191], v[140:143], v[128:131]
    ds_read_b64_tr_b16 v[176:177], v227 offset:16
    s_waitcnt lgkmcnt(8)
    v_mfma_f32_16x16x32_bf16 v[16:19], v[192:195], v[152:155], v[16:19]
    ds_read_b64_tr_b16 v[178:179], v227 offset:1296
    s_add_u32 m0, s80, 141312
    s_waitcnt lgkmcnt(8)
    v_mfma_f32_16x16x32_bf16 v[16:19], v[196:199], v[156:159], v[16:19]
    buffer_load_dwordx4 v252, s[20:23], s32 offen offset:0 nt lds
    s_waitcnt lgkmcnt(7)
    v_mfma_f32_16x16x32_bf16 v[20:23], v[192:195], v[160:163], v[20:23]
    buffer_load_dwordx4 v252, s[20:23], s33 offen offset:1024 nt lds
    s_waitcnt lgkmcnt(6)
    v_mfma_f32_16x16x32_bf16 v[20:23], v[196:199], v[164:167], v[20:23]
    ds_read_b64_tr_b16 v[180:181], v227 offset:5136
    s_waitcnt lgkmcnt(3)
    v_mfma_f32_16x16x32_bf16 v[24:27], v[168:171], v[152:155], v[24:27]
    ds_read_b64_tr_b16 v[182:183], v227 offset:6416
    ds_read_b64_tr_b16 v[184:185], v227 offset:24
    v_mfma_f32_16x16x32_bf16 v[24:27], v[172:175], v[156:159], v[24:27]
    buffer_load_dwordx4 v252, s[20:23], s34 offen offset:2048 nt lds
    ds_read_b64_tr_b16 v[186:187], v227 offset:1304
    v_mfma_f32_16x16x32_bf16 v[28:31], v[168:171], v[160:163], v[28:31]
    ds_read_b64_tr_b16 v[188:189], v227 offset:5144
    ds_read_b64_tr_b16 v[190:191], v227 offset:6424
    v_mfma_f32_16x16x32_bf16 v[28:31], v[172:175], v[164:167], v[28:31]
    ds_read_b64_tr_b16 v[192:193], v227 offset:32
    s_waitcnt lgkmcnt(5)
    v_mfma_f32_16x16x32_bf16 v[32:35], v[176:179], v[152:155], v[32:35]
    buffer_load_dwordx4 v252, s[20:23], s35 offen offset:3072 nt lds
    ds_read_b64_tr_b16 v[194:195], v227 offset:1312
    v_mfma_f32_16x16x32_bf16 v[32:35], v[180:183], v[156:159], v[32:35]
    ds_read_b64_tr_b16 v[196:197], v227 offset:5152
    ds_read_b64_tr_b16 v[198:199], v227 offset:6432
    v_mfma_f32_16x16x32_bf16 v[36:39], v[176:179], v[160:163], v[36:39]
    ds_read_b64_tr_b16 v[168:169], v227 offset:10240
    s_add_u32 m0, s80, 0
    v_mfma_f32_16x16x32_bf16 v[36:39], v[180:183], v[164:167], v[36:39]
    buffer_load_dwordx4 v208, s[4:7], s67 offen offset:0  lds
    s_waitcnt lgkmcnt(5)
    v_mfma_f32_16x16x32_bf16 v[40:43], v[184:187], v[152:155], v[40:43]
    ds_read_b64_tr_b16 v[170:171], v227 offset:11520
    ds_read_b64_tr_b16 v[172:173], v227 offset:15360
    v_mfma_f32_16x16x32_bf16 v[40:43], v[188:191], v[156:159], v[40:43]
    ds_read_b64_tr_b16 v[174:175], v227 offset:16640
    v_mfma_f32_16x16x32_bf16 v[44:47], v[184:187], v[160:163], v[44:47]
    buffer_load_dwordx4 v209, s[4:7], s67 offen offset:1024  lds
    ds_read_b64_tr_b16 v[176:177], v227 offset:10248
    v_mfma_f32_16x16x32_bf16 v[44:47], v[188:191], v[164:167], v[44:47]
    ds_read_b64_tr_b16 v[178:179], v227 offset:11528
    s_waitcnt lgkmcnt(6)
    v_mfma_f32_16x16x32_bf16 v[48:51], v[192:195], v[152:155], v[48:51]
    ds_read_b64_tr_b16 v[180:181], v227 offset:15368
    ds_read_b64_tr_b16 v[182:183], v227 offset:16648
    v_mfma_f32_16x16x32_bf16 v[48:51], v[196:199], v[156:159], v[48:51]
    buffer_load_dwordx4 v210, s[4:7], s67 offen offset:2048  lds
    v_mfma_f32_16x16x32_bf16 v[52:55], v[192:195], v[160:163], v[52:55]
    ds_read_b64_tr_b16 v[184:185], v227 offset:10256
    v_mfma_f32_16x16x32_bf16 v[52:55], v[196:199], v[164:167], v[52:55]
    ds_read_b64_tr_b16 v[186:187], v227 offset:11536
    s_waitcnt lgkmcnt(6)
    v_mfma_f32_16x16x32_bf16 v[56:59], v[168:171], v[152:155], v[56:59]
    buffer_load_dwordx4 v211, s[4:7], s67 offen offset:3072  lds
    ds_read_b64_tr_b16 v[188:189], v227 offset:15376
    v_mfma_f32_16x16x32_bf16 v[56:59], v[172:175], v[156:159], v[56:59]
    ds_read_b64_tr_b16 v[190:191], v227 offset:16656
    s_mul_i32 s0, s67, 1920
    v_mfma_f32_16x16x32_bf16 v[60:63], v[168:171], v[160:163], v[60:63]
    ds_read_b64_tr_b16 v[192:193], v227 offset:10264
    s_add_u32 m0, s81, 0
    v_mfma_f32_16x16x32_bf16 v[60:63], v[172:175], v[164:167], v[60:63]
    buffer_load_dwordx4 v212, s[8:11], s0 offen offset:0  lds
    s_waitcnt lgkmcnt(5)
    v_mfma_f32_16x16x32_bf16 v[64:67], v[176:179], v[152:155], v[64:67]
    ds_read_b64_tr_b16 v[194:195], v227 offset:11544
    ds_read_b64_tr_b16 v[196:197], v227 offset:15384
    v_mfma_f32_16x16x32_bf16 v[64:67], v[180:183], v[156:159], v[64:67]
    ds_read_b64_tr_b16 v[198:199], v227 offset:16664
    v_mfma_f32_16x16x32_bf16 v[68:71], v[176:179], v[160:163], v[68:71]
    buffer_load_dwordx4 v213, s[8:11], s0 offen offset:1024  lds
    ds_read_b64_tr_b16 v[168:169], v227 offset:10272
    v_mfma_f32_16x16x32_bf16 v[68:71], v[180:183], v[164:167], v[68:71]
    ds_read_b64_tr_b16 v[170:171], v227 offset:11552
    s_waitcnt lgkmcnt(6)
    v_mfma_f32_16x16x32_bf16 v[72:75], v[184:187], v[152:155], v[72:75]
    ds_read_b64_tr_b16 v[172:173], v227 offset:15392
    ds_read_b64_tr_b16 v[174:175], v227 offset:16672
    v_mfma_f32_16x16x32_bf16 v[72:75], v[188:191], v[156:159], v[72:75]
    ds_read_b64_tr_b16 v[176:177], v229 offset:45056
    v_mfma_f32_16x16x32_bf16 v[76:79], v[184:187], v[160:163], v[76:79]
    buffer_load_dwordx4 v214, s[8:11], s0 offen offset:2048  lds
    ds_read_b64_tr_b16 v[178:179], v229 offset:46080
    v_mfma_f32_16x16x32_bf16 v[76:79], v[188:191], v[164:167], v[76:79]
    ds_read_b64_tr_b16 v[180:181], v229 offset:49152
    s_waitcnt lgkmcnt(7)
    v_mfma_f32_16x16x32_bf16 v[80:83], v[192:195], v[152:155], v[80:83]
    ds_read_b64_tr_b16 v[182:183], v229 offset:50176
    v_mfma_f32_16x16x32_bf16 v[80:83], v[196:199], v[156:159], v[80:83]
    buffer_load_dwordx4 v215, s[8:11], s0 offen offset:3072  lds
    v_mfma_f32_16x16x32_bf16 v[84:87], v[192:195], v[160:163], v[84:87]
    ds_read_b64_tr_b16 v[184:185], v230 offset:45056
    s_add_u32 m0, m0, 4096
    v_mfma_f32_16x16x32_bf16 v[84:87], v[196:199], v[164:167], v[84:87]
    ds_read_b64_tr_b16 v[186:187], v230 offset:46080
    s_waitcnt lgkmcnt(6)
    v_mfma_f32_16x16x32_bf16 v[88:91], v[168:171], v[152:155], v[88:91]
    buffer_load_dwordx4 v216, s[8:11], s0 offen offset:0  lds
    ds_read_b64_tr_b16 v[188:189], v230 offset:49152
    v_mfma_f32_16x16x32_bf16 v[88:91], v[172:175], v[156:159], v[88:91]
    ds_read_b64_tr_b16 v[190:191], v230 offset:50176
    s_mul_i32 s1, s67, 1728
    v_mfma_f32_16x16x32_bf16 v[92:95], v[168:171], v[160:163], v[92:95]
    ds_read_b64_tr_b16 v[192:193], v231 offset:45056
    s_add_u32 m0, s82, 0
    v_mfma_f32_16x16x32_bf16 v[92:95], v[172:175], v[164:167], v[92:95]
    buffer_load_dwordx4 v217, s[12:15], s1 offen offset:0  lds
    s_waitcnt lgkmcnt(5)
    v_mfma_f32_16x16x32_bf16 v[96:99], v[176:179], v[152:155], v[96:99]
    ds_read_b64_tr_b16 v[194:195], v231 offset:46080
    ds_read_b64_tr_b16 v[196:197], v231 offset:49152
    v_mfma_f32_16x16x32_bf16 v[96:99], v[180:183], v[156:159], v[96:99]
    ds_read_b64_tr_b16 v[198:199], v231 offset:50176
    v_mfma_f32_16x16x32_bf16 v[100:103], v[176:179], v[160:163], v[100:103]
    buffer_load_dwordx4 v218, s[12:15], s1 offen offset:1024  lds
    ds_read_b64_tr_b16 v[168:169], v232 offset:45056
    v_mfma_f32_16x16x32_bf16 v[100:103], v[180:183], v[164:167], v[100:103]
    ds_read_b64_tr_b16 v[170:171], v232 offset:46080
    s_waitcnt lgkmcnt(6)
    v_mfma_f32_16x16x32_bf16 v[104:107], v[184:187], v[152:155], v[104:107]
    ds_read_b64_tr_b16 v[172:173], v232 offset:49152
    ds_read_b64_tr_b16 v[174:175], v232 offset:50176
    v_mfma_f32_16x16x32_bf16 v[104:107], v[188:191], v[156:159], v[104:107]
    ds_read_b128 v[176:179], v233 offset:128
    v_mfma_f32_16x16x32_bf16 v[108:111], v[184:187], v[160:163], v[108:111]
    ds_read_b128 v[180:183], v233 offset:192
    v_mfma_f32_16x16x32_bf16 v[108:111], v[188:191], v[164:167], v[108:111]
    s_waitcnt lgkmcnt(6)
    v_mfma_f32_16x16x32_bf16 v[112:115], v[192:195], v[152:155], v[112:115]
    s_waitcnt vmcnt(15) lgkmcnt(0)
    s_barrier
    ds_read_b64_tr_b16 v[184:185], v228 offset:0
    v_mfma_f32_16x16x32_bf16 v[112:115], v[196:199], v[156:159], v[112:115]
    ds_read_b64_tr_b16 v[186:187], v228 offset:1280
    s_add_u32 m0, s80, 45056
    v_mfma_f32_16x16x32_bf16 v[116:119], v[192:195], v[160:163], v[116:119]
    buffer_load_dwordx4 v208, s[4:7], s68 offen offset:0  lds
    ds_read_b64_tr_b16 v[188:189], v228 offset:5120
    v_mfma_f32_16x16x32_bf16 v[116:119], v[196:199], v[164:167], v[116:119]
    ds_read_b64_tr_b16 v[190:191], v228 offset:6400
    v_mfma_f32_16x16x32_bf16 v[120:123], v[168:171], v[152:155], v[120:123]
    ds_read_b128 v[136:139], v224 offset:0
    v_mfma_f32_16x16x32_bf16 v[120:123], v[172:175], v[156:159], v[120:123]
    ds_read_b128 v[140:143], v225 offset:0
    v_mfma_f32_16x16x32_bf16 v[124:127], v[168:171], v[160:163], v[124:127]
    ds_read_b128 v[144:147], v224 offset:2048
    v_mfma_f32_16x16x32_bf16 v[124:127], v[172:175], v[164:167], v[124:127]
    buffer_load_dwordx4 v209, s[4:7], s68 offen offset:1024  lds
    ds_read_b128 v[148:151], v225 offset:2048
    v_mfma_f32_16x16x32_bf16 v[128:131], v[176:179], v[152:155], v[128:131]
    ds_read_b64_tr_b16 v[192:193], v228 offset:8
    ds_read_b64_tr_b16 v[194:195], v228 offset:1288
    v_mfma_f32_16x16x32_bf16 v[128:131], v[180:183], v[156:159], v[128:131]
    ds_read_b64_tr_b16 v[196:197], v228 offset:5128
    ds_read_b64_tr_b16 v[198:199], v228 offset:6408
    v_mfma_f32_16x16x32_bf16 v[132:135], v[176:179], v[160:163], v[132:135]
    ds_read_b64_tr_b16 v[168:169], v228 offset:16
    v_mfma_f32_16x16x32_bf16 v[132:135], v[180:183], v[164:167], v[132:135]
    ds_read_b64_tr_b16 v[170:171], v228 offset:1296
    s_waitcnt lgkmcnt(9)
    v_mfma_f32_16x16x32_bf16 v[16:19], v[184:187], v[136:139], v[16:19]
    buffer_load_dwordx4 v210, s[4:7], s68 offen offset:2048  lds
    s_waitcnt lgkmcnt(8)
    v_mfma_f32_16x16x32_bf16 v[16:19], v[188:191], v[140:143], v[16:19]
    ds_read_b64_tr_b16 v[172:173], v228 offset:5136
    s_waitcnt lgkmcnt(8)
    v_mfma_f32_16x16x32_bf16 v[20:23], v[184:187], v[144:147], v[20:23]
    ds_read_b64_tr_b16 v[174:175], v228 offset:6416
    s_waitcnt lgkmcnt(8)
    v_mfma_f32_16x16x32_bf16 v[20:23], v[188:191], v[148:151], v[20:23]
    ds_read_b64_tr_b16 v[176:177], v228 offset:24
    s_waitcnt lgkmcnt(5)
    v_mfma_f32_16x16x32_bf16 v[24:27], v[192:195], v[136:139], v[24:27]
    ds_read_b64_tr_b16 v[178:179], v228 offset:1304
    ds_read_b64_tr_b16 v[180:181], v228 offset:5144
    v_mfma_f32_16x16x32_bf16 v[24:27], v[196:199], v[140:143], v[24:27]
    buffer_load_dwordx4 v211, s[4:7], s68 offen offset:3072  lds
    ds_read_b64_tr_b16 v[182:183], v228 offset:6424
    v_mfma_f32_16x16x32_bf16 v[28:31], v[192:195], v[144:147], v[28:31]
    ds_read_b64_tr_b16 v[184:185], v228 offset:32
    v_mfma_f32_16x16x32_bf16 v[28:31], v[196:199], v[148:151], v[28:31]
    ds_read_b64_tr_b16 v[186:187], v228 offset:1312
    s_waitcnt lgkmcnt(6)
    v_mfma_f32_16x16x32_bf16 v[32:35], v[168:171], v[136:139], v[32:35]
    ds_read_b64_tr_b16 v[188:189], v228 offset:5152
    ds_read_b64_tr_b16 v[190:191], v228 offset:6432
    v_mfma_f32_16x16x32_bf16 v[32:35], v[172:175], v[140:143], v[32:35]
    ds_read_b64_tr_b16 v[192:193], v228 offset:10240
    s_mul_i32 s0, s68, 1920
    v_mfma_f32_16x16x32_bf16 v[36:39], v[168:171], v[144:147], v[36:39]
    ds_read_b64_tr_b16 v[194:195], v228 offset:11520
    s_add_u32 m0, s81, 45056
    v_mfma_f32_16x16x32_bf16 v[36:39], v[172:175], v[148:151], v[36:39]
    buffer_load_dwordx4 v212, s[8:11], s0 offen offset:0  lds
    s_waitcnt lgkmcnt(6)
    v_mfma_f32_16x16x32_bf16 v[40:43], v[176:179], v[136:139], v[40:43]
    ds_read_b64_tr_b16 v[196:197], v228 offset:15360
    ds_read_b64_tr_b16 v[198:199], v228 offset:16640
    v_mfma_f32_16x16x32_bf16 v[40:43], v[180:183], v[140:143], v[40:43]
    ds_read_b64_tr_b16 v[168:169], v228 offset:10248
    v_mfma_f32_16x16x32_bf16 v[44:47], v[176:179], v[144:147], v[44:47]
    ds_read_b64_tr_b16 v[170:171], v228 offset:11528
    v_mfma_f32_16x16x32_bf16 v[44:47], v[180:183], v[148:151], v[44:47]
    buffer_load_dwordx4 v213, s[8:11], s0 offen offset:1024  lds
    s_waitcnt lgkmcnt(6)
    v_mfma_f32_16x16x32_bf16 v[48:51], v[184:187], v[136:139], v[48:51]
    ds_read_b64_tr_b16 v[172:173], v228 offset:15368
    ds_read_b64_tr_b16 v[174:175], v228 offset:16648
    v_mfma_f32_16x16x32_bf16 v[48:51], v[188:191], v[140:143], v[48:51]
    ds_read_b64_tr_b16 v[176:177], v228 offset:10256
    v_mfma_f32_16x16x32_bf16 v[52:55], v[184:187], v[144:147], v[52:55]
    ds_read_b64_tr_b16 v[178:179], v228 offset:11536
    v_mfma_f32_16x16x32_bf16 v[52:55], v[188:191], v[148:151], v[52:55]
    ds_read_b64_tr_b16 v[180:181], v228 offset:15376
    s_waitcnt lgkmcnt(7)
    v_mfma_f32_16x16x32_bf16 v[56:59], v[192:195], v[136:139], v[56:59]
    buffer_load_dwordx4 v214, s[8:11], s0 offen offset:2048  lds
    ds_read_b64_tr_b16 v[182:183], v228 offset:16656
    v_mfma_f32_16x16x32_bf16 v[56:59], v[196:199], v[140:143], v[56:59]
    ds_read_b64_tr_b16 v[184:185], v228 offset:10264
    v_mfma_f32_16x16x32_bf16 v[60:63], v[192:195], v[144:147], v[60:63]
    ds_read_b64_tr_b16 v[186:187], v228 offset:11544
    v_mfma_f32_16x16x32_bf16 v[60:63], v[196:199], v[148:151], v[60:63]
    ds_read_b64_tr_b16 v[188:189], v228 offset:15384
    s_waitcnt lgkmcnt(7)
    v_mfma_f32_16x16x32_bf16 v[64:67], v[168:171], v[136:139], v[64:67]
    ds_read_b64_tr_b16 v[190:191], v228 offset:16664
    v_mfma_f32_16x16x32_bf16 v[64:67], v[172:175], v[140:143], v[64:67]
    buffer_load_dwordx4 v215, s[8:11], s0 offen offset:3072  lds
    v_mfma_f32_16x16x32_bf16 v[68:71], v[168:171], v[144:147], v[68:71]
    ds_read_b64_tr_b16 v[192:193], v228 offset:10272
    v_mfma_f32_16x16x32_bf16 v[68:71], v[172:175], v[148:151], v[68:71]
    ds_read_b64_tr_b16 v[194:195], v228 offset:11552
    s_waitcnt lgkmcnt(6)
    v_mfma_f32_16x16x32_bf16 v[72:75], v[176:179], v[136:139], v[72:75]
    ds_read_b64_tr_b16 v[196:197], v228 offset:15392
    ds_read_b64_tr_b16 v[198:199], v228 offset:16672
    v_mfma_f32_16x16x32_bf16 v[72:75], v[180:183], v[140:143], v[72:75]
    ds_read_b64_tr_b16 v[168:169], v204 offset:0
    s_add_u32 m0, m0, 4096
    v_mfma_f32_16x16x32_bf16 v[76:79], v[176:179], v[144:147], v[76:79]
    buffer_load_dwordx4 v216, s[8:11], s0 offen offset:0  lds
    ds_read_b64_tr_b16 v[170:171], v204 offset:1024
    v_mfma_f32_16x16x32_bf16 v[76:79], v[180:183], v[148:151], v[76:79]
    ds_read_b64_tr_b16 v[172:173], v204 offset:4096
    s_waitcnt lgkmcnt(7)
    v_mfma_f32_16x16x32_bf16 v[80:83], v[184:187], v[136:139], v[80:83]
    ds_read_b64_tr_b16 v[174:175], v204 offset:5120
    v_mfma_f32_16x16x32_bf16 v[80:83], v[188:191], v[140:143], v[80:83]
    ds_read_b64_tr_b16 v[176:177], v205 offset:0
    s_mul_i32 s1, s68, 1728
    v_mfma_f32_16x16x32_bf16 v[84:87], v[184:187], v[144:147], v[84:87]
    ds_read_b64_tr_b16 v[178:179], v205 offset:1024
    s_add_u32 m0, s82, 45056
    v_mfma_f32_16x16x32_bf16 v[84:87], v[188:191], v[148:151], v[84:87]
    buffer_load_dwordx4 v217, s[12:15], s1 offen offset:0  lds
    s_waitcnt lgkmcnt(6)
    v_mfma_f32_16x16x32_bf16 v[88:91], v[192:195], v[136:139], v[88:91]
    ds_read_b64_tr_b16 v[180:181], v205 offset:4096
    ds_read_b64_tr_b16 v[182:183], v205 offset:5120
    v_mfma_f32_16x16x32_bf16 v[88:91], v[196:199], v[140:143], v[88:91]
    ds_read_b64_tr_b16 v[184:185], v206 offset:0
    v_mfma_f32_16x16x32_bf16 v[92:95], v[192:195], v[144:147], v[92:95]
    ds_read_b64_tr_b16 v[186:187], v206 offset:1024
    v_mfma_f32_16x16x32_bf16 v[92:95], v[196:199], v[148:151], v[92:95]
    ds_read_b64_tr_b16 v[188:189], v206 offset:4096
    s_waitcnt lgkmcnt(7)
    v_mfma_f32_16x16x32_bf16 v[96:99], v[168:171], v[136:139], v[96:99]
    buffer_load_dwordx4 v218, s[12:15], s1 offen offset:1024  lds
    ds_read_b64_tr_b16 v[190:191], v206 offset:5120
    v_mfma_f32_16x16x32_bf16 v[96:99], v[172:175], v[140:143], v[96:99]
    ds_read_b64_tr_b16 v[192:193], v207 offset:0
    v_mfma_f32_16x16x32_bf16 v[100:103], v[168:171], v[144:147], v[100:103]
    ds_read_b64_tr_b16 v[194:195], v207 offset:1024
    v_mfma_f32_16x16x32_bf16 v[100:103], v[172:175], v[148:151], v[100:103]
    ds_read_b64_tr_b16 v[196:197], v207 offset:4096
    s_waitcnt lgkmcnt(7)
    v_mfma_f32_16x16x32_bf16 v[104:107], v[176:179], v[136:139], v[104:107]
    ds_read_b64_tr_b16 v[198:199], v207 offset:5120
    v_mfma_f32_16x16x32_bf16 v[104:107], v[180:183], v[140:143], v[104:107]
    ds_read_b128 v[168:171], v233 offset:256
    v_mfma_f32_16x16x32_bf16 v[108:111], v[176:179], v[144:147], v[108:111]
    ds_read_b128 v[172:175], v233 offset:320
    v_mfma_f32_16x16x32_bf16 v[108:111], v[180:183], v[148:151], v[108:111]
    s_waitcnt lgkmcnt(6)
    v_mfma_f32_16x16x32_bf16 v[112:115], v[184:187], v[136:139], v[112:115]
    s_waitcnt vmcnt(11) lgkmcnt(0)
    s_barrier
    ds_read_b64_tr_b16 v[176:177], v226 offset:0
    v_mfma_f32_16x16x32_bf16 v[112:115], v[188:191], v[140:143], v[112:115]
    ds_read_b64_tr_b16 v[178:179], v226 offset:1280
    s_add_u32 m0, s80, 90112
    v_mfma_f32_16x16x32_bf16 v[116:119], v[184:187], v[144:147], v[116:119]
    buffer_load_dwordx4 v208, s[4:7], s69 offen offset:0  lds
    ds_read_b64_tr_b16 v[180:181], v226 offset:5120
    v_mfma_f32_16x16x32_bf16 v[116:119], v[188:191], v[148:151], v[116:119]
    ds_read_b64_tr_b16 a[160:161], v200 offset:0
    ds_read_b64_tr_b16 v[182:183], v226 offset:6400
    v_mfma_f32_16x16x32_bf16 v[120:123], v[192:195], v[136:139], v[120:123]
    ds_read_b64_tr_b16 a[204:205], v254 offset:0
    ds_read_b128 v[152:155], v220 offset:0
    v_mfma_f32_16x16x32_bf16 v[120:123], v[196:199], v[140:143], v[120:123]
    buffer_load_dwordx4 v209, s[4:7], s69 offen offset:1024  lds
    ds_read_b128 v[156:159], v221 offset:0
    v_mfma_f32_16x16x32_bf16 v[124:127], v[192:195], v[144:147], v[124:127]
    ds_read_b64_tr_b16 a[162:163], v200 offset:512
    ds_read_b128 v[160:163], v220 offset:2048
    v_mfma_f32_16x16x32_bf16 v[124:127], v[196:199], v[148:151], v[124:127]
    ds_read_b64_tr_b16 a[164:165], v201 offset:0
    ds_read_b128 v[164:167], v221 offset:2048
    v_mfma_f32_16x16x32_bf16 v[128:131], v[168:171], v[136:139], v[128:131]
    ds_read_b64_tr_b16 v[184:185], v226 offset:8
    ds_read_b64_tr_b16 v[186:187], v226 offset:1288
    v_mfma_f32_16x16x32_bf16 v[128:131], v[172:175], v[140:143], v[128:131]
    buffer_load_dwordx4 v210, s[4:7], s69 offen offset:2048  lds
    ds_read_b64_tr_b16 v[188:189], v226 offset:5128
    v_mfma_f32_16x16x32_bf16 v[132:135], v[168:171], v[144:147], v[132:135]
    ds_read_b64_tr_b16 a[166:167], v201 offset:512
    v_mfma_f32_16x16x32_bf16 v[132:135], v[172:175], v[148:151], v[132:135]
    ds_read_b64_tr_b16 a[206:207], v254 offset:8
    s_waitcnt lgkmcnt(10)
    v_mfma_f32_16x16x32_bf16 v[16:19], v[176:179], v[152:155], v[16:19]
    ds_read_b64_tr_b16 a[168:169], v202 offset:64
    ds_read_b64_tr_b16 v[190:191], v226 offset:6408
    s_waitcnt lgkmcnt(11)
    v_mfma_f32_16x16x32_bf16 v[16:19], v[180:183], v[156:159], v[16:19]
    buffer_load_dwordx4 v211, s[4:7], s69 offen offset:3072  lds
    s_waitcnt lgkmcnt(9)
    v_mfma_f32_16x16x32_bf16 v[20:23], v[176:179], v[160:163], v[20:23]
    ds_read_b64_tr_b16 a[170:171], v202 offset:576
    s_waitcnt lgkmcnt(8)
    v_mfma_f32_16x16x32_bf16 v[20:23], v[180:183], v[164:167], v[20:23]
    ds_read_b64_tr_b16 a[208:209], v254 offset:16
    s_waitcnt lgkmcnt(2)
    v_mfma_f32_16x16x32_bf16 v[24:27], v[184:187], v[152:155], v[24:27]
    ds_read_b64_tr_b16 a[172:173], v203 offset:64
    ds_read_b64_tr_b16 v[192:193], v226 offset:16
    ds_read_b64_tr_b16 v[194:195], v226 offset:1296
    ds_read_b64_tr_b16 v[196:197], v226 offset:5136
    ds_read_b64_tr_b16 v[198:199], v226 offset:6416
    v_mfma_f32_16x16x32_bf16 v[24:27], v[188:191], v[156:159], v[24:27]
    ds_read_b64_tr_b16 v[168:169], v226 offset:24
    ds_read_b64_tr_b16 v[170:171], v226 offset:1304
    v_mfma_f32_16x16x32_bf16 v[28:31], v[184:187], v[160:163], v[28:31]
    ds_read_b64_tr_b16 v[172:173], v226 offset:5144
    ds_read_b64_tr_b16 v[174:175], v226 offset:6424
    s_mul_i32 s0, s69, 1920
    v_mfma_f32_16x16x32_bf16 v[28:31], v[188:191], v[164:167], v[28:31]
    ds_read_b64_tr_b16 v[176:177], v226 offset:32
    s_add_u32 m0, s81, 90112
    s_waitcnt lgkmcnt(5)
    v_mfma_f32_16x16x32_bf16 v[32:35], v[192:195], v[152:155], v[32:35]
    buffer_load_dwordx4 v212, s[8:11], s0 offen offset:0  lds
    ds_read_b64_tr_b16 v[178:179], v226 offset:1312
    v_mfma_f32_16x16x32_bf16 v[32:35], v[196:199], v[156:159], v[32:35]
    ds_read_b64_tr_b16 a[174:175], v203 offset:576
    ds_read_b64_tr_b16 v[180:181], v226 offset:5152
    v_mfma_f32_16x16x32_bf16 v[36:39], v[192:195], v[160:163], v[36:39]
    ds_read_b64_tr_b16 a[210:211], v254 offset:24
    ds_read_b64_tr_b16 v[182:183], v226 offset:6432
    v_mfma_f32_16x16x32_bf16 v[36:39], v[196:199], v[164:167], v[36:39]
    buffer_load_dwordx4 v213, s[8:11], s0 offen offset:1024  lds
    s_waitcnt lgkmcnt(6)
    v_mfma_f32_16x16x32_bf16 v[40:43], v[168:171], v[152:155], v[40:43]
    buffer_load_dwordx4 v214, s[8:11], s0 offen offset:2048  lds
    ds_read_b64_tr_b16 v[184:185], v226 offset:10240
    v_mfma_f32_16x16x32_bf16 v[40:43], v[172:175], v[156:159], v[40:43]
    ds_read_b64_tr_b16 a[212:213], v254 offset:32
    ds_read_b64_tr_b16 v[186:187], v226 offset:11520
    v_mfma_f32_16x16x32_bf16 v[44:47], v[168:171], v[160:163], v[44:47]
    ds_read_b64_tr_b16 v[188:189], v226 offset:15360
    ds_read_b64_tr_b16 v[190:191], v226 offset:16640
    v_mfma_f32_16x16x32_bf16 v[44:47], v[172:175], v[164:167], v[44:47]
    buffer_load_dwordx4 v215, s[8:11], s0 offen offset:3072  lds
    s_waitcnt lgkmcnt(5)
    v_mfma_f32_16x16x32_bf16 v[48:51], v[176:179], v[152:155], v[48:51]
    ds_read_b64_tr_b16 v[192:193], v226 offset:10248
    ds_read_b64_tr_b16 v[194:195], v226 offset:11528
    v_mfma_f32_16x16x32_bf16 v[48:51], v[180:183], v[156:159], v[48:51]
    ds_read_b64_tr_b16 a[214:215], v254 offset:160
    ds_read_b64_tr_b16 v[196:197], v226 offset:15368
    v_mfma_f32_16x16x32_bf16 v[52:55], v[176:179], v[160:163], v[52:55]
    ds_read_b64_tr_b16 v[198:199], v226 offset:16648
    s_add_u32 m0, m0, 4096
    v_mfma_f32_16x16x32_bf16 v[52:55], v[180:183], v[164:167], v[52:55]
    buffer_load_dwordx4 v216, s[8:11], s0 offen offset:0  lds
    s_waitcnt lgkmcnt(5)
    v_mfma_f32_16x16x32_bf16 v[56:59], v[184:187], v[152:155], v[56:59]
    ds_read_b64_tr_b16 v[168:169], v226 offset:10256
    ds_read_b64_tr_b16 v[170:171], v226 offset:11536
    v_mfma_f32_16x16x32_bf16 v[56:59], v[188:191], v[156:159], v[56:59]
    ds_read_b64_tr_b16 v[172:173], v226 offset:15376
    ds_read_b64_tr_b16 v[174:175], v226 offset:16656
    v_mfma_f32_16x16x32_bf16 v[60:63], v[184:187], v[160:163], v[60:63]
    ds_read_b64_tr_b16 a[216:217], v254 offset:168
    ds_read_b64_tr_b16 v[176:177], v226 offset:10264
    v_mfma_f32_16x16x32_bf16 v[60:63], v[188:191], v[164:167], v[60:63]
    ds_read_b64_tr_b16 v[178:179], v226 offset:11544
    s_waitcnt lgkmcnt(7)
    v_mfma_f32_16x16x32_bf16 v[64:67], v[192:195], v[152:155], v[64:67]
    ds_read_b64_tr_b16 v[180:181], v226 offset:15384
    ds_read_b64_tr_b16 v[182:183], v226 offset:16664
    v_mfma_f32_16x16x32_bf16 v[64:67], v[196:199], v[156:159], v[64:67]
    ds_read_b64_tr_b16 v[184:185], v226 offset:10272
    s_mul_i32 s1, s69, 1728
    s_add_u32 m0, s82, 90112
    v_mfma_f32_16x16x32_bf16 v[68:71], v[192:195], v[160:163], v[68:71]
    buffer_load_dwordx4 v217, s[12:15], s1 offen offset:0  lds
    ds_read_b64_tr_b16 v[186:187], v226 offset:11552
    v_mfma_f32_16x16x32_bf16 v[68:71], v[196:199], v[164:167], v[68:71]
    buffer_load_dwordx4 v218, s[12:15], s1 offen offset:1024  lds
    s_waitcnt lgkmcnt(7)
    v_mfma_f32_16x16x32_bf16 v[72:75], v[168:171], v[152:155], v[72:75]
    ds_read_b64_tr_b16 a[218:219], v254 offset:176
    ds_read_b64_tr_b16 v[188:189], v226 offset:15392
    v_mfma_f32_16x16x32_bf16 v[72:75], v[172:175], v[156:159], v[72:75]
    ds_read_b64_tr_b16 v[190:191], v226 offset:16672
    v_mfma_f32_16x16x32_bf16 v[76:79], v[168:171], v[160:163], v[76:79]
    buffer_store_dwordx4 a[160:163], v6, s[16:19], s92 offen sc1
    ds_read_b64_tr_b16 v[192:193], v229 offset:0
    v_mfma_f32_16x16x32_bf16 v[76:79], v[172:175], v[164:167], v[76:79]
    ds_read_b64_tr_b16 v[194:195], v229 offset:1024
    s_waitcnt lgkmcnt(7)
    v_mfma_f32_16x16x32_bf16 v[80:83], v[176:179], v[152:155], v[80:83]
    ds_read_b64_tr_b16 a[220:221], v254 offset:184
    ds_read_b64_tr_b16 v[196:197], v229 offset:4096
    v_mfma_f32_16x16x32_bf16 v[80:83], v[180:183], v[156:159], v[80:83]
    ds_read_b64_tr_b16 v[198:199], v229 offset:5120
    v_mfma_f32_16x16x32_bf16 v[84:87], v[176:179], v[160:163], v[84:87]
    buffer_store_dwordx4 a[164:167], v6, s[16:19], s93 offen sc1
    ds_read_b64_tr_b16 v[168:169], v230 offset:0
    v_mfma_f32_16x16x32_bf16 v[84:87], v[180:183], v[164:167], v[84:87]
    ds_read_b64_tr_b16 v[170:171], v230 offset:1024
    s_waitcnt lgkmcnt(7)
    v_mfma_f32_16x16x32_bf16 v[88:91], v[184:187], v[152:155], v[88:91]
    ds_read_b64_tr_b16 v[172:173], v230 offset:4096
    ds_read_b64_tr_b16 v[174:175], v230 offset:5120
    v_mfma_f32_16x16x32_bf16 v[88:91], v[188:191], v[156:159], v[88:91]
    ds_read_b64_tr_b16 a[222:223], v254 offset:192
    v_mfma_f32_16x16x32_bf16 v[92:95], v[184:187], v[160:163], v[92:95]
    buffer_store_dwordx4 a[168:171], v6, s[16:19], s94 offen sc1
    ds_read_b64_tr_b16 v[176:177], v231 offset:0
    v_mfma_f32_16x16x32_bf16 v[92:95], v[188:191], v[164:167], v[92:95]
    ds_read_b64_tr_b16 v[178:179], v231 offset:1024
    s_waitcnt lgkmcnt(7)
    v_mfma_f32_16x16x32_bf16 v[96:99], v[192:195], v[152:155], v[96:99]
    ds_read_b64_tr_b16 v[180:181], v231 offset:4096
    ds_read_b64_tr_b16 v[182:183], v231 offset:5120
    v_mfma_f32_16x16x32_bf16 v[96:99], v[196:199], v[156:159], v[96:99]
    ds_read_b64_tr_b16 v[184:185], v232 offset:0
    v_mfma_f32_16x16x32_bf16 v[100:103], v[192:195], v[160:163], v[100:103]
    buffer_store_dwordx4 a[172:175], v6, s[16:19], s95 offen sc1
    ds_read_b64_tr_b16 v[186:187], v232 offset:1024
    v_mfma_f32_16x16x32_bf16 v[100:103], v[196:199], v[164:167], v[100:103]
    ds_read_b64_tr_b16 a[224:225], v254 offset:320
    s_waitcnt lgkmcnt(8)
    v_mfma_f32_16x16x32_bf16 v[104:107], v[168:171], v[152:155], v[104:107]
    ds_read_b64_tr_b16 v[188:189], v232 offset:4096
    ds_read_b64_tr_b16 v[190:191], v232 offset:5120
    v_mfma_f32_16x16x32_bf16 v[104:107], v[172:175], v[156:159], v[104:107]
    ds_read_b128 v[192:195], v233 offset:384
    v_mfma_f32_16x16x32_bf16 v[108:111], v[168:171], v[160:163], v[108:111]
    ds_read_b128 v[196:199], v233 offset:448
    v_mfma_f32_16x16x32_bf16 v[108:111], v[172:175], v[164:167], v[108:111]
    ds_read_b64_tr_b16 a[226:227], v254 offset:328
    s_waitcnt lgkmcnt(8)
    v_mfma_f32_16x16x32_bf16 v[112:115], v[176:179], v[152:155], v[112:115]
    s_waitcnt vmcnt(15) lgkmcnt(0)
    s_barrier
    ds_read_b64_tr_b16 v[168:169], v227 offset:0
    v_mfma_f32_16x16x32_bf16 v[112:115], v[180:183], v[156:159], v[112:115]
    ds_read_b64_tr_b16 v[170:171], v227 offset:1280
    s_add_u32 m0, s80, 0
    v_mfma_f32_16x16x32_bf16 v[116:119], v[176:179], v[160:163], v[116:119]
    buffer_load_dwordx4 v208, s[4:7], s70 offen offset:0  lds
    ds_read_b64_tr_b16 v[172:173], v227 offset:5120
    v_mfma_f32_16x16x32_bf16 v[116:119], v[180:183], v[164:167], v[116:119]
    ds_read_b64_tr_b16 v[174:175], v227 offset:6400
    v_mfma_f32_16x16x32_bf16 v[120:123], v[184:187], v[152:155], v[120:123]
    ds_read_b64_tr_b16 a[228:229], v254 offset:336
    ds_read_b128 v[136:139], v222 offset:0
    v_mfma_f32_16x16x32_bf16 v[120:123], v[188:191], v[156:159], v[120:123]
    ds_read_b128 v[140:143], v223 offset:0
    v_mfma_f32_16x16x32_bf16 v[124:127], v[184:187], v[160:163], v[124:127]
    ds_read_b128 v[144:147], v222 offset:2048
    v_mfma_f32_16x16x32_bf16 v[124:127], v[188:191], v[164:167], v[124:127]
    buffer_load_dwordx4 v209, s[4:7], s70 offen offset:1024  lds
    ds_read_b128 v[148:151], v223 offset:2048
    v_mfma_f32_16x16x32_bf16 v[128:131], v[192:195], v[152:155], v[128:131]
    ds_read_b64_tr_b16 v[176:177], v227 offset:8
    ds_read_b64_tr_b16 v[178:179], v227 offset:1288
    v_mfma_f32_16x16x32_bf16 v[128:131], v[196:199], v[156:159], v[128:131]
    ds_read_b64_tr_b16 a[230:231], v254 offset:344
    ds_read_b64_tr_b16 v[180:181], v227 offset:5128
    v_mfma_f32_16x16x32_bf16 v[132:135], v[192:195], v[160:163], v[132:135]
    ds_read_b64_tr_b16 v[182:183], v227 offset:6408
    v_mfma_f32_16x16x32_bf16 v[132:135], v[196:199], v[164:167], v[132:135]
    ds_read_b64_tr_b16 v[184:185], v227 offset:16
    s_waitcnt lgkmcnt(9)
    v_mfma_f32_16x16x32_bf16 v[16:19], v[168:171], v[136:139], v[16:19]
    buffer_load_dwordx4 v210, s[4:7], s70 offen offset:2048  lds
    s_waitcnt lgkmcnt(8)
    v_mfma_f32_16x16x32_bf16 v[16:19], v[172:175], v[140:143], v[16:19]
    ds_read_b64_tr_b16 v[186:187], v227 offset:1296
    s_waitcnt lgkmcnt(8)
    v_mfma_f32_16x16x32_bf16 v[20:23], v[168:171], v[144:147], v[20:23]
    ds_read_b64_tr_b16 a[232:233], v254 offset:352
    s_waitcnt lgkmcnt(8)
    v_mfma_f32_16x16x32_bf16 v[20:23], v[172:175], v[148:151], v[20:23]
    ds_read_b64_tr_b16 v[188:189], v227 offset:5136
    s_waitcnt lgkmcnt(4)
    v_mfma_f32_16x16x32_bf16 v[24:27], v[176:179], v[136:139], v[24:27]
    ds_read_b64_tr_b16 v[190:191], v227 offset:6416
    ds_read_b64_tr_b16 v[192:193], v227 offset:24
    v_mfma_f32_16x16x32_bf16 v[24:27], v[180:183], v[140:143], v[24:27]
    buffer_load_dwordx4 v211, s[4:7], s70 offen offset:3072  lds
    ds_read_b64_tr_b16 v[194:195], v227 offset:1304
    v_mfma_f32_16x16x32_bf16 v[28:31], v[176:179], v[144:147], v[28:31]
    ds_read_b64_tr_b16 v[196:197], v227 offset:5144
    ds_read_b64_tr_b16 v[198:199], v227 offset:6424
    v_mfma_f32_16x16x32_bf16 v[28:31], v[180:183], v[148:151], v[28:31]
    ds_read_b64_tr_b16 a[234:235], v254 offset:480
    s_waitcnt lgkmcnt(5)
    v_mfma_f32_16x16x32_bf16 v[32:35], v[184:187], v[136:139], v[32:35]
    ds_read_b64_tr_b16 v[168:169], v227 offset:32
    ds_read_b64_tr_b16 v[170:171], v227 offset:1312
    v_mfma_f32_16x16x32_bf16 v[32:35], v[188:191], v[140:143], v[32:35]
    ds_read_b64_tr_b16 v[172:173], v227 offset:5152
    ds_read_b64_tr_b16 v[174:175], v227 offset:6432
    v_mfma_f32_16x16x32_bf16 v[36:39], v[184:187], v[144:147], v[36:39]
    ds_read_b64_tr_b16 v[176:177], v227 offset:10240
    s_mul_i32 s0, s70, 1920
    v_mfma_f32_16x16x32_bf16 v[36:39], v[188:191], v[148:151], v[36:39]
    ds_read_b64_tr_b16 v[178:179], v227 offset:11520
    s_waitcnt lgkmcnt(7)
    v_mfma_f32_16x16x32_bf16 v[40:43], v[192:195], v[136:139], v[40:43]
    ds_read_b64_tr_b16 v[180:181], v227 offset:15360
    ds_read_b64_tr_b16 v[182:183], v227 offset:16640
    s_add_u32 m0, s81, 0
    v_mfma_f32_16x16x32_bf16 v[40:43], v[196:199], v[140:143], v[40:43]
    buffer_load_dwordx4 v212, s[8:11], s0 offen offset:0  lds
    v_mfma_f32_16x16x32_bf16 v[44:47], v[192:195], v[144:147], v[44:47]
    ds_read_b64_tr_b16 a[236:237], v254 offset:488
    ds_read_b64_tr_b16 v[184:185], v227 offset:10248
    v_mfma_f32_16x16x32_bf16 v[44:47], v[196:199], v[148:151], v[44:47]
    buffer_load_dwordx4 v213, s[8:11], s0 offen offset:1024  lds
    s_waitcnt lgkmcnt(6)
    v_mfma_f32_16x16x32_bf16 v[48:51], v[168:171], v[136:139], v[48:51]
    ds_read_b64_tr_b16 v[186:187], v227 offset:11528
    ds_read_b64_tr_b16 v[188:189], v227 offset:15368
    v_mfma_f32_16x16x32_bf16 v[48:51], v[172:175], v[140:143], v[48:51]
    ds_read_b64_tr_b16 a[238:239], v254 offset:496
    ds_read_b64_tr_b16 v[190:191], v227 offset:16648
    v_mfma_f32_16x16x32_bf16 v[52:55], v[168:171], v[144:147], v[52:55]
    ds_read_b64_tr_b16 v[192:193], v227 offset:10256
    v_mfma_f32_16x16x32_bf16 v[52:55], v[172:175], v[148:151], v[52:55]
    ds_read_b64_tr_b16 v[194:195], v227 offset:11536
    s_waitcnt lgkmcnt(8)
    v_mfma_f32_16x16x32_bf16 v[56:59], v[176:179], v[136:139], v[56:59]
    buffer_load_dwordx4 v214, s[8:11], s0 offen offset:2048  lds
    ds_read_b64_tr_b16 v[196:197], v227 offset:15376
    v_mfma_f32_16x16x32_bf16 v[56:59], v[180:183], v[140:143], v[56:59]
    ds_read_b64_tr_b16 v[198:199], v227 offset:16656
    v_mfma_f32_16x16x32_bf16 v[60:63], v[176:179], v[144:147], v[60:63]
    ds_read_b64_tr_b16 a[240:241], v254 offset:504
    ds_read_b64_tr_b16 v[168:169], v227 offset:10264
    v_mfma_f32_16x16x32_bf16 v[60:63], v[180:183], v[148:151], v[60:63]
    ds_read_b64_tr_b16 v[170:171], v227 offset:11544
    s_waitcnt lgkmcnt(7)
    v_mfma_f32_16x16x32_bf16 v[64:67], v[184:187], v[136:139], v[64:67]
    ds_read_b64_tr_b16 v[172:173], v227 offset:15384
    ds_read_b64_tr_b16 v[174:175], v227 offset:16664
    v_mfma_f32_16x16x32_bf16 v[64:67], v[188:191], v[140:143], v[64:67]
    buffer_load_dwordx4 v215, s[8:11], s0 offen offset:3072  lds
    v_mfma_f32_16x16x32_bf16 v[68:71], v[184:187], v[144:147], v[68:71]
    ds_read_b64_tr_b16 v[176:177], v227 offset:10272
    v_mfma_f32_16x16x32_bf16 v[68:71], v[188:191], v[148:151], v[68:71]
    ds_read_b64_tr_b16 a[242:243], v254 offset:512
    s_waitcnt lgkmcnt(7)
    v_mfma_f32_16x16x32_bf16 v[72:75], v[192:195], v[136:139], v[72:75]
    ds_read_b64_tr_b16 v[178:179], v227 offset:11552
    ds_read_b64_tr_b16 v[180:181], v227 offset:15392
    v_mfma_f32_16x16x32_bf16 v[72:75], v[196:199], v[140:143], v[72:75]
    ds_read_b64_tr_b16 v[182:183], v227 offset:16672
    s_add_u32 m0, m0, 4096
    v_mfma_f32_16x16x32_bf16 v[76:79], v[192:195], v[144:147], v[76:79]
    buffer_load_dwordx4 v216, s[8:11], s0 offen offset:0  lds
    ds_read_b64_tr_b16 v[184:185], v229 offset:45056
    v_mfma_f32_16x16x32_bf16 v[76:79], v[196:199], v[148:151], v[76:79]
    ds_read_b64_tr_b16 v[186:187], v229 offset:46080
    s_waitcnt lgkmcnt(7)
    v_mfma_f32_16x16x32_bf16 v[80:83], v[168:171], v[136:139], v[80:83]
    ds_read_b64_tr_b16 a[244:245], v254 offset:640
    ds_read_b64_tr_b16 v[188:189], v229 offset:49152
    v_mfma_f32_16x16x32_bf16 v[80:83], v[172:175], v[140:143], v[80:83]
    ds_read_b64_tr_b16 v[190:191], v229 offset:50176
    s_mul_i32 s1, s70, 1728
    v_mfma_f32_16x16x32_bf16 v[84:87], v[168:171], v[144:147], v[84:87]
    ds_read_b64_tr_b16 v[192:193], v230 offset:45056
    s_add_u32 m0, s82, 0
    v_mfma_f32_16x16x32_bf16 v[84:87], v[172:175], v[148:151], v[84:87]
    buffer_load_dwordx4 v217, s[12:15], s1 offen offset:0  lds
    s_waitcnt lgkmcnt(6)
    v_mfma_f32_16x16x32_bf16 v[88:91], v[176:179], v[136:139], v[88:91]
    ds_read_b64_tr_b16 v[194:195], v230 offset:46080
    ds_read_b64_tr_b16 v[196:197], v230 offset:49152
    v_mfma_f32_16x16x32_bf16 v[88:91], v[180:183], v[140:143], v[88:91]
    ds_read_b64_tr_b16 a[246:247], v254 offset:648
    ds_read_b64_tr_b16 v[198:199], v230 offset:50176
    v_mfma_f32_16x16x32_bf16 v[92:95], v[176:179], v[144:147], v[92:95]
    ds_read_b64_tr_b16 v[168:169], v231 offset:45056
    v_mfma_f32_16x16x32_bf16 v[92:95], v[180:183], v[148:151], v[92:95]
    ds_read_b64_tr_b16 v[170:171], v231 offset:46080
    s_waitcnt lgkmcnt(7)
    v_mfma_f32_16x16x32_bf16 v[96:99], v[184:187], v[136:139], v[96:99]
    buffer_load_dwordx4 v218, s[12:15], s1 offen offset:1024  lds
    ds_read_b64_tr_b16 v[172:173], v231 offset:49152
    v_mfma_f32_16x16x32_bf16 v[96:99], v[188:191], v[140:143], v[96:99]
    ds_read_b64_tr_b16 v[174:175], v231 offset:50176
    v_mfma_f32_16x16x32_bf16 v[100:103], v[184:187], v[144:147], v[100:103]
    ds_read_b64_tr_b16 a[248:249], v254 offset:656
    ds_read_b64_tr_b16 v[176:177], v232 offset:45056
    v_mfma_f32_16x16x32_bf16 v[100:103], v[188:191], v[148:151], v[100:103]
    ds_read_b64_tr_b16 v[178:179], v232 offset:46080
    s_waitcnt lgkmcnt(7)
    v_mfma_f32_16x16x32_bf16 v[104:107], v[192:195], v[136:139], v[104:107]
    ds_read_b64_tr_b16 v[180:181], v232 offset:49152
    ds_read_b64_tr_b16 v[182:183], v232 offset:50176
    v_mfma_f32_16x16x32_bf16 v[104:107], v[196:199], v[140:143], v[104:107]
    ds_read_b128 v[184:187], v233 offset:512
    v_mfma_f32_16x16x32_bf16 v[108:111], v[192:195], v[144:147], v[108:111]
    ds_read_b128 v[188:191], v233 offset:576
    v_mfma_f32_16x16x32_bf16 v[108:111], v[196:199], v[148:151], v[108:111]
    ds_read_b64_tr_b16 a[250:251], v254 offset:664
    s_waitcnt lgkmcnt(8)
    v_mfma_f32_16x16x32_bf16 v[112:115], v[168:171], v[136:139], v[112:115]
    s_waitcnt vmcnt(15) lgkmcnt(0)
    s_barrier
    ds_read_b64_tr_b16 v[192:193], v228 offset:0
    v_mfma_f32_16x16x32_bf16 v[112:115], v[172:175], v[140:143], v[112:115]
    ds_read_b64_tr_b16 v[194:195], v228 offset:1280
    s_add_u32 m0, s80, 45056
    v_mfma_f32_16x16x32_bf16 v[116:119], v[168:171], v[144:147], v[116:119]
    buffer_load_dwordx4 v208, s[4:7], s71 offen offset:0  lds
    ds_read_b64_tr_b16 v[196:197], v228 offset:5120
    v_mfma_f32_16x16x32_bf16 v[116:119], v[172:175], v[148:151], v[116:119]
    ds_read_b64_tr_b16 v[198:199], v228 offset:6400
    v_mfma_f32_16x16x32_bf16 v[120:123], v[176:179], v[136:139], v[120:123]
    ds_read_b64_tr_b16 a[252:253], v254 offset:672
    ds_read_b128 v[152:155], v224 offset:0
    v_mfma_f32_16x16x32_bf16 v[120:123], v[180:183], v[140:143], v[120:123]
    ds_read_b128 v[156:159], v225 offset:0
    v_mfma_f32_16x16x32_bf16 v[124:127], v[176:179], v[144:147], v[124:127]
    ds_read_b128 v[160:163], v224 offset:2048
    v_mfma_f32_16x16x32_bf16 v[124:127], v[180:183], v[148:151], v[124:127]
    buffer_load_dwordx4 v209, s[4:7], s71 offen offset:1024  lds
    ds_read_b128 v[164:167], v225 offset:2048
    v_mfma_f32_16x16x32_bf16 v[128:131], v[184:187], v[136:139], v[128:131]
    ds_read_b64_tr_b16 v[168:169], v228 offset:8
    ds_read_b64_tr_b16 v[170:171], v228 offset:1288
    v_mfma_f32_16x16x32_bf16 v[128:131], v[188:191], v[140:143], v[128:131]
    ds_read_b64_tr_b16 v[172:173], v228 offset:5128
    ds_read_b64_tr_b16 v[174:175], v228 offset:6408
    v_mfma_f32_16x16x32_bf16 v[132:135], v[184:187], v[144:147], v[132:135]
    ds_read_b64_tr_b16 v[176:177], v228 offset:16
    v_mfma_f32_16x16x32_bf16 v[132:135], v[188:191], v[148:151], v[132:135]
    ds_read_b64_tr_b16 v[178:179], v228 offset:1296
    s_waitcnt lgkmcnt(9)
    v_mfma_f32_16x16x32_bf16 v[16:19], v[192:195], v[152:155], v[16:19]
    buffer_load_dwordx4 v210, s[4:7], s71 offen offset:2048  lds
    s_waitcnt lgkmcnt(8)
    v_mfma_f32_16x16x32_bf16 v[16:19], v[196:199], v[156:159], v[16:19]
    ds_read_b64_tr_b16 v[180:181], v228 offset:5136
    s_waitcnt lgkmcnt(8)
    v_mfma_f32_16x16x32_bf16 v[20:23], v[192:195], v[160:163], v[20:23]
    ds_read_b64_tr_b16 v[182:183], v228 offset:6416
    s_waitcnt lgkmcnt(8)
    v_mfma_f32_16x16x32_bf16 v[20:23], v[196:199], v[164:167], v[20:23]
    ds_read_b64_tr_b16 v[184:185], v228 offset:24
    s_waitcnt lgkmcnt(5)
    v_mfma_f32_16x16x32_bf16 v[24:27], v[168:171], v[152:155], v[24:27]
    ds_read_b64_tr_b16 v[186:187], v228 offset:1304
    ds_read_b64_tr_b16 v[188:189], v228 offset:5144
    v_mfma_f32_16x16x32_bf16 v[24:27], v[172:175], v[156:159], v[24:27]
    buffer_load_dwordx4 v211, s[4:7], s71 offen offset:3072  lds
    ds_read_b64_tr_b16 v[190:191], v228 offset:6424
    v_mfma_f32_16x16x32_bf16 v[28:31], v[168:171], v[160:163], v[28:31]
    ds_read_b64_tr_b16 v[192:193], v228 offset:32
    v_mfma_f32_16x16x32_bf16 v[28:31], v[172:175], v[164:167], v[28:31]
    ds_read_b64_tr_b16 v[194:195], v228 offset:1312
    s_waitcnt lgkmcnt(6)
    v_mfma_f32_16x16x32_bf16 v[32:35], v[176:179], v[152:155], v[32:35]
    ds_read_b64_tr_b16 v[196:197], v228 offset:5152
    ds_read_b64_tr_b16 v[198:199], v228 offset:6432
    v_mfma_f32_16x16x32_bf16 v[32:35], v[180:183], v[156:159], v[32:35]
    ds_read_b64_tr_b16 v[168:169], v228 offset:10240
    s_mul_i32 s0, s71, 1920
    v_mfma_f32_16x16x32_bf16 v[36:39], v[176:179], v[160:163], v[36:39]
    ds_read_b64_tr_b16 v[170:171], v228 offset:11520
    s_add_u32 m0, s81, 45056
    v_mfma_f32_16x16x32_bf16 v[36:39], v[180:183], v[164:167], v[36:39]
    buffer_load_dwordx4 v212, s[8:11], s0 offen offset:0  lds
    s_waitcnt lgkmcnt(6)
    v_mfma_f32_16x16x32_bf16 v[40:43], v[184:187], v[152:155], v[40:43]
    ds_read_b64_tr_b16 v[172:173], v228 offset:15360
    ds_read_b64_tr_b16 v[174:175], v228 offset:16640
    v_mfma_f32_16x16x32_bf16 v[40:43], v[188:191], v[156:159], v[40:43]
    ds_read_b64_tr_b16 v[176:177], v228 offset:10248
    v_mfma_f32_16x16x32_bf16 v[44:47], v[184:187], v[160:163], v[44:47]
    ds_read_b64_tr_b16 v[178:179], v228 offset:11528
    v_mfma_f32_16x16x32_bf16 v[44:47], v[188:191], v[164:167], v[44:47]
    buffer_load_dwordx4 v213, s[8:11], s0 offen offset:1024  lds
    s_waitcnt lgkmcnt(6)
    v_mfma_f32_16x16x32_bf16 v[48:51], v[192:195], v[152:155], v[48:51]
    ds_read_b64_tr_b16 v[180:181], v228 offset:15368
    ds_read_b64_tr_b16 v[182:183], v228 offset:16648
    v_mfma_f32_16x16x32_bf16 v[48:51], v[196:199], v[156:159], v[48:51]
    ds_read_b64_tr_b16 v[184:185], v228 offset:10256
    v_mfma_f32_16x16x32_bf16 v[52:55], v[192:195], v[160:163], v[52:55]
    ds_read_b64_tr_b16 v[186:187], v228 offset:11536
    v_mfma_f32_16x16x32_bf16 v[52:55], v[196:199], v[164:167], v[52:55]
    ds_read_b64_tr_b16 v[188:189], v228 offset:15376
    s_waitcnt lgkmcnt(7)
    v_mfma_f32_16x16x32_bf16 v[56:59], v[168:171], v[152:155], v[56:59]
    buffer_load_dwordx4 v214, s[8:11], s0 offen offset:2048  lds
    ds_read_b64_tr_b16 v[190:191], v228 offset:16656
    v_mfma_f32_16x16x32_bf16 v[56:59], v[172:175], v[156:159], v[56:59]
    ds_read_b64_tr_b16 v[192:193], v228 offset:10264
    v_mfma_f32_16x16x32_bf16 v[60:63], v[168:171], v[160:163], v[60:63]
    ds_read_b64_tr_b16 v[194:195], v228 offset:11544
    v_mfma_f32_16x16x32_bf16 v[60:63], v[172:175], v[164:167], v[60:63]
    ds_read_b64_tr_b16 v[196:197], v228 offset:15384
    s_waitcnt lgkmcnt(7)
    v_mfma_f32_16x16x32_bf16 v[64:67], v[176:179], v[152:155], v[64:67]
    ds_read_b64_tr_b16 v[198:199], v228 offset:16664
    v_mfma_f32_16x16x32_bf16 v[64:67], v[180:183], v[156:159], v[64:67]
    buffer_load_dwordx4 v215, s[8:11], s0 offen offset:3072  lds
    v_mfma_f32_16x16x32_bf16 v[68:71], v[176:179], v[160:163], v[68:71]
    ds_read_b64_tr_b16 v[168:169], v228 offset:10272
    v_mfma_f32_16x16x32_bf16 v[68:71], v[180:183], v[164:167], v[68:71]
    ds_read_b64_tr_b16 v[170:171], v228 offset:11552
    s_waitcnt lgkmcnt(6)
    v_mfma_f32_16x16x32_bf16 v[72:75], v[184:187], v[152:155], v[72:75]
    ds_read_b64_tr_b16 v[172:173], v228 offset:15392
    ds_read_b64_tr_b16 v[174:175], v228 offset:16672
    v_mfma_f32_16x16x32_bf16 v[72:75], v[188:191], v[156:159], v[72:75]
    ds_read_b64_tr_b16 v[176:177], v204 offset:0
    s_add_u32 m0, m0, 4096
    v_mfma_f32_16x16x32_bf16 v[76:79], v[184:187], v[160:163], v[76:79]
    buffer_load_dwordx4 v216, s[8:11], s0 offen offset:0  lds
    ds_read_b64_tr_b16 v[178:179], v204 offset:1024
    v_mfma_f32_16x16x32_bf16 v[76:79], v[188:191], v[164:167], v[76:79]
    ds_read_b64_tr_b16 v[180:181], v204 offset:4096
    s_waitcnt lgkmcnt(7)
    v_mfma_f32_16x16x32_bf16 v[80:83], v[192:195], v[152:155], v[80:83]
    ds_read_b64_tr_b16 v[182:183], v204 offset:5120
    v_mfma_f32_16x16x32_bf16 v[80:83], v[196:199], v[156:159], v[80:83]
    ds_read_b64_tr_b16 v[184:185], v205 offset:0
    s_mul_i32 s1, s71, 1728
    v_mfma_f32_16x16x32_bf16 v[84:87], v[192:195], v[160:163], v[84:87]
    ds_read_b64_tr_b16 v[186:187], v205 offset:1024
    s_add_u32 m0, s82, 45056
    v_mfma_f32_16x16x32_bf16 v[84:87], v[196:199], v[164:167], v[84:87]
    buffer_load_dwordx4 v217, s[12:15], s1 offen offset:0  lds
    s_waitcnt lgkmcnt(6)
    v_mfma_f32_16x16x32_bf16 v[88:91], v[168:171], v[152:155], v[88:91]
    ds_read_b64_tr_b16 v[188:189], v205 offset:4096
    ds_read_b64_tr_b16 v[190:191], v205 offset:5120
    v_mfma_f32_16x16x32_bf16 v[88:91], v[172:175], v[156:159], v[88:91]
    ds_read_b64_tr_b16 v[192:193], v206 offset:0
    v_mfma_f32_16x16x32_bf16 v[92:95], v[168:171], v[160:163], v[92:95]
    ds_read_b64_tr_b16 v[194:195], v206 offset:1024
    v_mfma_f32_16x16x32_bf16 v[92:95], v[172:175], v[164:167], v[92:95]
    ds_read_b64_tr_b16 v[196:197], v206 offset:4096
    s_waitcnt lgkmcnt(7)
    v_mfma_f32_16x16x32_bf16 v[96:99], v[176:179], v[152:155], v[96:99]
    buffer_load_dwordx4 v218, s[12:15], s1 offen offset:1024  lds
    ds_read_b64_tr_b16 v[198:199], v206 offset:5120
    v_mfma_f32_16x16x32_bf16 v[96:99], v[180:183], v[156:159], v[96:99]
    ds_read_b64_tr_b16 v[168:169], v207 offset:0
    v_mfma_f32_16x16x32_bf16 v[100:103], v[176:179], v[160:163], v[100:103]
    ds_read_b64_tr_b16 v[170:171], v207 offset:1024
    v_mfma_f32_16x16x32_bf16 v[100:103], v[180:183], v[164:167], v[100:103]
    ds_read_b64_tr_b16 v[172:173], v207 offset:4096
    s_waitcnt lgkmcnt(7)
    v_mfma_f32_16x16x32_bf16 v[104:107], v[184:187], v[152:155], v[104:107]
    ds_read_b64_tr_b16 v[174:175], v207 offset:5120
    v_mfma_f32_16x16x32_bf16 v[104:107], v[188:191], v[156:159], v[104:107]
    ds_read_b128 v[176:179], v233 offset:640
    v_mfma_f32_16x16x32_bf16 v[108:111], v[184:187], v[160:163], v[108:111]
    ds_read_b128 v[180:183], v233 offset:704
    v_mfma_f32_16x16x32_bf16 v[108:111], v[188:191], v[164:167], v[108:111]
    s_waitcnt lgkmcnt(6)
    v_mfma_f32_16x16x32_bf16 v[112:115], v[192:195], v[152:155], v[112:115]
    s_waitcnt vmcnt(11) lgkmcnt(0)
    s_barrier
    ds_read_b64_tr_b16 v[184:185], v226 offset:0
    v_mfma_f32_16x16x32_bf16 v[112:115], v[196:199], v[156:159], v[112:115]
    ds_read_b64_tr_b16 v[186:187], v226 offset:1280
    s_add_u32 m0, s80, 90112
    v_mfma_f32_16x16x32_bf16 v[116:119], v[192:195], v[160:163], v[116:119]
    buffer_load_dwordx4 v208, s[4:7], s72 offen offset:0  lds
    ds_read_b64_tr_b16 v[188:189], v226 offset:5120
    v_mfma_f32_16x16x32_bf16 v[116:119], v[196:199], v[164:167], v[116:119]
    buffer_store_dwordx2 v[246:247], v245, s[16:19], s91 offen sc1
    ds_read_b64_tr_b16 v[190:191], v226 offset:6400
    v_mfma_f32_16x16x32_bf16 v[120:123], v[168:171], v[152:155], v[120:123]
    ds_read_b128 v[136:139], v220 offset:0
    v_mfma_f32_16x16x32_bf16 v[120:123], v[172:175], v[156:159], v[120:123]
    ds_read_b128 v[140:143], v221 offset:0
    v_mfma_f32_16x16x32_bf16 v[124:127], v[168:171], v[160:163], v[124:127]
    ds_read_b128 v[144:147], v220 offset:2048
    v_mfma_f32_16x16x32_bf16 v[124:127], v[172:175], v[164:167], v[124:127]
    buffer_load_dwordx4 v209, s[4:7], s72 offen offset:1024  lds
    ds_read_b128 v[148:151], v221 offset:2048
    v_mfma_f32_16x16x32_bf16 v[128:131], v[176:179], v[152:155], v[128:131]
    ds_read_b64_tr_b16 v[192:193], v226 offset:8
    ds_read_b64_tr_b16 v[194:195], v226 offset:1288
    v_mfma_f32_16x16x32_bf16 v[128:131], v[180:183], v[156:159], v[128:131]
    ds_read_b64_tr_b16 v[196:197], v226 offset:5128
    ds_read_b64_tr_b16 v[198:199], v226 offset:6408
    v_mfma_f32_16x16x32_bf16 v[132:135], v[176:179], v[160:163], v[132:135]
    ds_read_b64_tr_b16 v[168:169], v226 offset:16
    v_mfma_f32_16x16x32_bf16 v[132:135], v[180:183], v[164:167], v[132:135]
    ds_read_b64_tr_b16 v[170:171], v226 offset:1296
    s_waitcnt lgkmcnt(9)
    v_mfma_f32_16x16x32_bf16 v[16:19], v[184:187], v[136:139], v[16:19]
    buffer_load_dwordx4 v210, s[4:7], s72 offen offset:2048  lds
    s_waitcnt lgkmcnt(8)
    v_mfma_f32_16x16x32_bf16 v[16:19], v[188:191], v[140:143], v[16:19]
    ds_read_b64_tr_b16 v[172:173], v226 offset:5136
    s_waitcnt lgkmcnt(8)
    v_mfma_f32_16x16x32_bf16 v[20:23], v[184:187], v[144:147], v[20:23]
    ds_read_b64_tr_b16 v[174:175], v226 offset:6416
    s_waitcnt lgkmcnt(8)
    v_mfma_f32_16x16x32_bf16 v[20:23], v[188:191], v[148:151], v[20:23]
    ds_read_b64_tr_b16 v[176:177], v226 offset:24
    s_waitcnt lgkmcnt(5)
    v_mfma_f32_16x16x32_bf16 v[24:27], v[192:195], v[136:139], v[24:27]
    ds_read_b64_tr_b16 v[178:179], v226 offset:1304
    ds_read_b64_tr_b16 v[180:181], v226 offset:5144
    v_mfma_f32_16x16x32_bf16 v[24:27], v[196:199], v[140:143], v[24:27]
    buffer_load_dwordx4 v211, s[4:7], s72 offen offset:3072  lds
    ds_read_b64_tr_b16 v[182:183], v226 offset:6424
    v_mfma_f32_16x16x32_bf16 v[28:31], v[192:195], v[144:147], v[28:31]
    ds_read_b64_tr_b16 v[184:185], v226 offset:32
    v_mfma_f32_16x16x32_bf16 v[28:31], v[196:199], v[148:151], v[28:31]
    ds_read_b64_tr_b16 v[186:187], v226 offset:1312
    s_waitcnt lgkmcnt(6)
    v_mfma_f32_16x16x32_bf16 v[32:35], v[168:171], v[136:139], v[32:35]
    ds_read_b64_tr_b16 v[188:189], v226 offset:5152
    ds_read_b64_tr_b16 v[190:191], v226 offset:6432
    v_mfma_f32_16x16x32_bf16 v[32:35], v[172:175], v[140:143], v[32:35]
    ds_read_b64_tr_b16 v[192:193], v226 offset:10240
    s_mul_i32 s0, s72, 1920
    v_mfma_f32_16x16x32_bf16 v[36:39], v[168:171], v[144:147], v[36:39]
    ds_read_b64_tr_b16 v[194:195], v226 offset:11520
    s_add_u32 m0, s81, 90112
    v_mfma_f32_16x16x32_bf16 v[36:39], v[172:175], v[148:151], v[36:39]
    buffer_load_dwordx4 v212, s[8:11], s0 offen offset:0  lds
    s_waitcnt lgkmcnt(6)
    v_mfma_f32_16x16x32_bf16 v[40:43], v[176:179], v[136:139], v[40:43]
    ds_read_b64_tr_b16 v[196:197], v226 offset:15360
    ds_read_b64_tr_b16 v[198:199], v226 offset:16640
    v_mfma_f32_16x16x32_bf16 v[40:43], v[180:183], v[140:143], v[40:43]
    ds_read_b64_tr_b16 v[168:169], v226 offset:10248
    v_mfma_f32_16x16x32_bf16 v[44:47], v[176:179], v[144:147], v[44:47]
    ds_read_b64_tr_b16 v[170:171], v226 offset:11528
    v_mfma_f32_16x16x32_bf16 v[44:47], v[180:183], v[148:151], v[44:47]
    buffer_load_dwordx4 v213, s[8:11], s0 offen offset:1024  lds
    s_waitcnt lgkmcnt(6)
    v_mfma_f32_16x16x32_bf16 v[48:51], v[184:187], v[136:139], v[48:51]
    ds_read_b64_tr_b16 v[172:173], v226 offset:15368
    ds_read_b64_tr_b16 v[174:175], v226 offset:16648
    v_mfma_f32_16x16x32_bf16 v[48:51], v[188:191], v[140:143], v[48:51]
    ds_read_b64_tr_b16 v[176:177], v226 offset:10256
    v_mfma_f32_16x16x32_bf16 v[52:55], v[184:187], v[144:147], v[52:55]
    ds_read_b64_tr_b16 v[178:179], v226 offset:11536
    v_mfma_f32_16x16x32_bf16 v[52:55], v[188:191], v[148:151], v[52:55]
    ds_read_b64_tr_b16 v[180:181], v226 offset:15376
    s_waitcnt lgkmcnt(7)
    v_mfma_f32_16x16x32_bf16 v[56:59], v[192:195], v[136:139], v[56:59]
    buffer_load_dwordx4 v214, s[8:11], s0 offen offset:2048  lds
    ds_read_b64_tr_b16 v[182:183], v226 offset:16656
    v_mfma_f32_16x16x32_bf16 v[56:59], v[196:199], v[140:143], v[56:59]
    ds_read_b64_tr_b16 v[184:185], v226 offset:10264
    v_mfma_f32_16x16x32_bf16 v[60:63], v[192:195], v[144:147], v[60:63]
    ds_read_b64_tr_b16 v[186:187], v226 offset:11544
    v_mfma_f32_16x16x32_bf16 v[60:63], v[196:199], v[148:151], v[60:63]
    ds_read_b64_tr_b16 v[188:189], v226 offset:15384
    s_waitcnt lgkmcnt(7)
    v_mfma_f32_16x16x32_bf16 v[64:67], v[168:171], v[136:139], v[64:67]
    ds_read_b64_tr_b16 v[190:191], v226 offset:16664
    v_mfma_f32_16x16x32_bf16 v[64:67], v[172:175], v[140:143], v[64:67]
    buffer_load_dwordx4 v215, s[8:11], s0 offen offset:3072  lds
    v_mfma_f32_16x16x32_bf16 v[68:71], v[168:171], v[144:147], v[68:71]
    ds_read_b64_tr_b16 v[192:193], v226 offset:10272
    v_mfma_f32_16x16x32_bf16 v[68:71], v[172:175], v[148:151], v[68:71]
    ds_read_b64_tr_b16 v[194:195], v226 offset:11552
    s_waitcnt lgkmcnt(6)
    v_mfma_f32_16x16x32_bf16 v[72:75], v[176:179], v[136:139], v[72:75]
    ds_read_b64_tr_b16 v[196:197], v226 offset:15392
    ds_read_b64_tr_b16 v[198:199], v226 offset:16672
    v_mfma_f32_16x16x32_bf16 v[72:75], v[180:183], v[140:143], v[72:75]
    ds_read_b64_tr_b16 v[168:169], v229 offset:0
    s_add_u32 m0, m0, 4096
    v_mfma_f32_16x16x32_bf16 v[76:79], v[176:179], v[144:147], v[76:79]
    buffer_load_dwordx4 v216, s[8:11], s0 offen offset:0  lds
    ds_read_b64_tr_b16 v[170:171], v229 offset:1024
    v_mfma_f32_16x16x32_bf16 v[76:79], v[180:183], v[148:151], v[76:79]
    ds_read_b64_tr_b16 v[172:173], v229 offset:4096
    s_waitcnt lgkmcnt(7)
    v_mfma_f32_16x16x32_bf16 v[80:83], v[184:187], v[136:139], v[80:83]
    ds_read_b64_tr_b16 v[174:175], v229 offset:5120
    v_mfma_f32_16x16x32_bf16 v[80:83], v[188:191], v[140:143], v[80:83]
    ds_read_b64_tr_b16 v[176:177], v230 offset:0
    s_mul_i32 s1, s72, 1728
    v_mfma_f32_16x16x32_bf16 v[84:87], v[184:187], v[144:147], v[84:87]
    ds_read_b64_tr_b16 v[178:179], v230 offset:1024
    s_add_u32 m0, s82, 90112
    v_mfma_f32_16x16x32_bf16 v[84:87], v[188:191], v[148:151], v[84:87]
    buffer_load_dwordx4 v217, s[12:15], s1 offen offset:0  lds
    s_waitcnt lgkmcnt(6)
    v_mfma_f32_16x16x32_bf16 v[88:91], v[192:195], v[136:139], v[88:91]
    ds_read_b64_tr_b16 v[180:181], v230 offset:4096
    ds_read_b64_tr_b16 v[182:183], v230 offset:5120
    v_mfma_f32_16x16x32_bf16 v[88:91], v[196:199], v[140:143], v[88:91]
    ds_read_b64_tr_b16 v[184:185], v231 offset:0
    v_mfma_f32_16x16x32_bf16 v[92:95], v[192:195], v[144:147], v[92:95]
    ds_read_b64_tr_b16 v[186:187], v231 offset:1024
    v_mfma_f32_16x16x32_bf16 v[92:95], v[196:199], v[148:151], v[92:95]
    ds_read_b64_tr_b16 v[188:189], v231 offset:4096
    s_waitcnt lgkmcnt(7)
    v_mfma_f32_16x16x32_bf16 v[96:99], v[168:171], v[136:139], v[96:99]
    buffer_load_dwordx4 v218, s[12:15], s1 offen offset:1024  lds
    ds_read_b64_tr_b16 v[190:191], v231 offset:5120
    v_mfma_f32_16x16x32_bf16 v[96:99], v[172:175], v[140:143], v[96:99]
    ds_read_b64_tr_b16 v[192:193], v232 offset:0
    v_mfma_f32_16x16x32_bf16 v[100:103], v[168:171], v[144:147], v[100:103]
    ds_read_b64_tr_b16 v[194:195], v232 offset:1024
    v_mfma_f32_16x16x32_bf16 v[100:103], v[172:175], v[148:151], v[100:103]
    ds_read_b64_tr_b16 v[196:197], v232 offset:4096
    s_waitcnt lgkmcnt(7)
    v_mfma_f32_16x16x32_bf16 v[104:107], v[176:179], v[136:139], v[104:107]
    ds_read_b64_tr_b16 v[198:199], v232 offset:5120
    v_mfma_f32_16x16x32_bf16 v[104:107], v[180:183], v[140:143], v[104:107]
    ds_read_b128 v[168:171], v233 offset:768
    v_mfma_f32_16x16x32_bf16 v[108:111], v[176:179], v[144:147], v[108:111]
    ds_read_b128 v[172:175], v233 offset:832
    v_mfma_f32_16x16x32_bf16 v[108:111], v[180:183], v[148:151], v[108:111]
    s_waitcnt lgkmcnt(6)
    v_mfma_f32_16x16x32_bf16 v[112:115], v[184:187], v[136:139], v[112:115]
    s_waitcnt vmcnt(12) lgkmcnt(0)
    s_barrier
    ds_read_b64_tr_b16 v[176:177], v227 offset:0
    v_mfma_f32_16x16x32_bf16 v[112:115], v[188:191], v[140:143], v[112:115]
    ds_read_b64_tr_b16 v[178:179], v227 offset:1280
    s_add_u32 m0, s80, 0
    v_mfma_f32_16x16x32_bf16 v[116:119], v[184:187], v[144:147], v[116:119]
    buffer_load_dwordx4 v208, s[4:7], s73 offen offset:0  lds
    ds_read_b64_tr_b16 v[180:181], v227 offset:5120
    v_mfma_f32_16x16x32_bf16 v[116:119], v[188:191], v[148:151], v[116:119]
    ds_read_b64_tr_b16 v[182:183], v227 offset:6400
    v_mfma_f32_16x16x32_bf16 v[120:123], v[192:195], v[136:139], v[120:123]
    ds_read_b128 v[152:155], v222 offset:0
    v_mfma_f32_16x16x32_bf16 v[120:123], v[196:199], v[140:143], v[120:123]
    ds_read_b128 v[156:159], v223 offset:0
    v_mfma_f32_16x16x32_bf16 v[124:127], v[192:195], v[144:147], v[124:127]
    ds_read_b128 v[160:163], v222 offset:2048
    v_mfma_f32_16x16x32_bf16 v[124:127], v[196:199], v[148:151], v[124:127]
    buffer_load_dwordx4 v209, s[4:7], s73 offen offset:1024  lds
    ds_read_b128 v[164:167], v223 offset:2048
    v_mfma_f32_16x16x32_bf16 v[128:131], v[168:171], v[136:139], v[128:131]
    ds_read_b64_tr_b16 v[184:185], v227 offset:8
    ds_read_b64_tr_b16 v[186:187], v227 offset:1288
    v_mfma_f32_16x16x32_bf16 v[128:131], v[172:175], v[140:143], v[128:131]
    ds_read_b64_tr_b16 v[188:189], v227 offset:5128
    ds_read_b64_tr_b16 v[190:191], v227 offset:6408
    v_mfma_f32_16x16x32_bf16 v[132:135], v[168:171], v[144:147], v[132:135]
    ds_read_b64_tr_b16 v[192:193], v227 offset:16
    v_mfma_f32_16x16x32_bf16 v[132:135], v[172:175], v[148:151], v[132:135]
    ds_read_b64_tr_b16 v[194:195], v227 offset:1296
    s_waitcnt lgkmcnt(9)
    v_mfma_f32_16x16x32_bf16 v[16:19], v[176:179], v[152:155], v[16:19]
    buffer_load_dwordx4 v210, s[4:7], s73 offen offset:2048  lds
    s_waitcnt lgkmcnt(8)
    v_mfma_f32_16x16x32_bf16 v[16:19], v[180:183], v[156:159], v[16:19]
    ds_read_b64_tr_b16 v[196:197], v227 offset:5136
    s_waitcnt lgkmcnt(8)
    v_mfma_f32_16x16x32_bf16 v[20:23], v[176:179], v[160:163], v[20:23]
    ds_read_b64_tr_b16 v[198:199], v227 offset:6416
    s_waitcnt lgkmcnt(8)
    v_mfma_f32_16x16x32_bf16 v[20:23], v[180:183], v[164:167], v[20:23]
    ds_read_b64_tr_b16 v[168:169], v227 offset:24
    s_waitcnt lgkmcnt(5)
    v_mfma_f32_16x16x32_bf16 v[24:27], v[184:187], v[152:155], v[24:27]
    ds_read_b64_tr_b16 v[170:171], v227 offset:1304
    ds_read_b64_tr_b16 v[172:173], v227 offset:5144
    v_mfma_f32_16x16x32_bf16 v[24:27], v[188:191], v[156:159], v[24:27]
    buffer_load_dwordx4 v211, s[4:7], s73 offen offset:3072  lds
    ds_read_b64_tr_b16 v[174:175], v227 offset:6424
    v_mfma_f32_16x16x32_bf16 v[28:31], v[184:187], v[160:163], v[28:31]
    ds_read_b64_tr_b16 v[176:177], v227 offset:32
    v_mfma_f32_16x16x32_bf16 v[28:31], v[188:191], v[164:167], v[28:31]
    ds_read_b64_tr_b16 v[178:179], v227 offset:1312
    s_waitcnt lgkmcnt(6)
    v_mfma_f32_16x16x32_bf16 v[32:35], v[192:195], v[152:155], v[32:35]
    ds_read_b64_tr_b16 v[180:181], v227 offset:5152
    ds_read_b64_tr_b16 v[182:183], v227 offset:6432
    v_mfma_f32_16x16x32_bf16 v[32:35], v[196:199], v[156:159], v[32:35]
    ds_read_b64_tr_b16 v[184:185], v227 offset:10240
    s_mul_i32 s0, s73, 1920
    v_mfma_f32_16x16x32_bf16 v[36:39], v[192:195], v[160:163], v[36:39]
    ds_read_b64_tr_b16 v[186:187], v227 offset:11520
    s_add_u32 m0, s81, 0
    v_mfma_f32_16x16x32_bf16 v[36:39], v[196:199], v[164:167], v[36:39]
    buffer_load_dwordx4 v212, s[8:11], s0 offen offset:0  lds
    s_waitcnt lgkmcnt(6)
    v_mfma_f32_16x16x32_bf16 v[40:43], v[168:171], v[152:155], v[40:43]
    ds_read_b64_tr_b16 v[188:189], v227 offset:15360
    ds_read_b64_tr_b16 v[190:191], v227 offset:16640
    v_mfma_f32_16x16x32_bf16 v[40:43], v[172:175], v[156:159], v[40:43]
    ds_read_b64_tr_b16 v[192:193], v227 offset:10248
    v_mfma_f32_16x16x32_bf16 v[44:47], v[168:171], v[160:163], v[44:47]
    ds_read_b64_tr_b16 v[194:195], v227 offset:11528
    v_mfma_f32_16x16x32_bf16 v[44:47], v[172:175], v[164:167], v[44:47]
    buffer_load_dwordx4 v213, s[8:11], s0 offen offset:1024  lds
    s_waitcnt lgkmcnt(6)
    v_mfma_f32_16x16x32_bf16 v[48:51], v[176:179], v[152:155], v[48:51]
    ds_read_b64_tr_b16 v[196:197], v227 offset:15368
    ds_read_b64_tr_b16 v[198:199], v227 offset:16648
    v_mfma_f32_16x16x32_bf16 v[48:51], v[180:183], v[156:159], v[48:51]
    ds_read_b64_tr_b16 v[168:169], v227 offset:10256
    s_mul_i32 s74, s63, 5
    v_mfma_f32_16x16x32_bf16 v[52:55], v[176:179], v[160:163], v[52:55]
    ds_read_b64_tr_b16 v[170:171], v227 offset:11536
    s_add_u32 s75, s74, 4
    v_mfma_f32_16x16x32_bf16 v[52:55], v[180:183], v[164:167], v[52:55]
    ds_read_b64_tr_b16 v[172:173], v227 offset:15376
    s_waitcnt lgkmcnt(7)
    v_mfma_f32_16x16x32_bf16 v[56:59], v[184:187], v[152:155], v[56:59]
    ds_read_b64_tr_b16 v[174:175], v227 offset:16656
    s_lshr_b32 s74, s74, 2
    v_mfma_f32_16x16x32_bf16 v[56:59], v[188:191], v[156:159], v[56:59]
    ds_read_b64_tr_b16 v[176:177], v227 offset:10264
    s_mul_i32 s74, s74, 74
    s_lshr_b32 s74, s74, 2
    v_mfma_f32_16x16x32_bf16 v[60:63], v[184:187], v[160:163], v[60:63]
    ds_read_b64_tr_b16 v[178:179], v227 offset:11544
    s_lshr_b32 s75, s75, 2
    s_mul_i32 s75, s75, 74
    v_mfma_f32_16x16x32_bf16 v[60:63], v[188:191], v[164:167], v[60:63]
    ds_read_b64_tr_b16 v[180:181], v227 offset:15384
    s_add_u32 s75, s75, 73
    s_waitcnt lgkmcnt(7)
    v_mfma_f32_16x16x32_bf16 v[64:67], v[192:195], v[152:155], v[64:67]
    ds_read_b64_tr_b16 v[182:183], v227 offset:16664
    s_lshr_b32 s75, s75, 2
    v_add_u32 v235, s74, v0
    v_mfma_f32_16x16x32_bf16 v[64:67], v[196:199], v[156:159], v[64:67]
    ds_read_b64_tr_b16 v[184:185], v227 offset:10272
    v_min_u32 v235, s75, v235
    v_lshlrev_b32 v235, 7, v235
    v_mfma_f32_16x16x32_bf16 v[68:71], v[192:195], v[160:163], v[68:71]
    ds_read_b64_tr_b16 v[186:187], v227 offset:11552
    s_mov_b32 s74, 98304
    v_mfma_f32_16x16x32_bf16 v[68:71], v[196:199], v[164:167], v[68:71]
    buffer_load_dwordx4 v214, s[8:11], s0 offen offset:2048  lds
    s_waitcnt lgkmcnt(6)
    v_mfma_f32_16x16x32_bf16 v[72:75], v[168:171], v[152:155], v[72:75]
    buffer_load_dwordx4 v215, s[8:11], s0 offen offset:3072  lds
    ds_read_b64_tr_b16 v[188:189], v227 offset:15392
    v_mfma_f32_16x16x32_bf16 v[72:75], v[172:175], v[156:159], v[72:75]
    ds_read_b64_tr_b16 v[190:191], v227 offset:16672
    s_add_u32 m0, m0, 4096
    v_mfma_f32_16x16x32_bf16 v[76:79], v[168:171], v[160:163], v[76:79]
    buffer_load_dwordx4 v216, s[8:11], s0 offen offset:0  lds
    ds_read_b64_tr_b16 v[192:193], v229 offset:45056
    v_mfma_f32_16x16x32_bf16 v[76:79], v[172:175], v[164:167], v[76:79]
    ds_read_b64_tr_b16 v[194:195], v229 offset:46080
    s_waitcnt lgkmcnt(6)
    v_mfma_f32_16x16x32_bf16 v[80:83], v[176:179], v[152:155], v[80:83]
    ds_read_b64_tr_b16 v[196:197], v229 offset:49152
    ds_read_b64_tr_b16 v[198:199], v229 offset:50176
    v_mfma_f32_16x16x32_bf16 v[80:83], v[180:183], v[156:159], v[80:83]
    ds_read_b64_tr_b16 v[168:169], v230 offset:45056
    s_mul_i32 s1, s73, 1728
    v_mfma_f32_16x16x32_bf16 v[84:87], v[176:179], v[160:163], v[84:87]
    ds_read_b64_tr_b16 v[170:171], v230 offset:46080
    s_add_u32 m0, s82, 0
    v_mfma_f32_16x16x32_bf16 v[84:87], v[180:183], v[164:167], v[84:87]
    buffer_load_dwordx4 v217, s[12:15], s1 offen offset:0  lds
    s_waitcnt lgkmcnt(6)
    v_mfma_f32_16x16x32_bf16 v[88:91], v[184:187], v[152:155], v[88:91]
    ds_read_b64_tr_b16 v[172:173], v230 offset:49152
    ds_read_b64_tr_b16 v[174:175], v230 offset:50176
    v_mfma_f32_16x16x32_bf16 v[88:91], v[188:191], v[156:159], v[88:91]
    ds_read_b64_tr_b16 v[176:177], v231 offset:45056
    v_mfma_f32_16x16x32_bf16 v[92:95], v[184:187], v[160:163], v[92:95]
    ds_read_b64_tr_b16 v[178:179], v231 offset:46080
    v_mfma_f32_16x16x32_bf16 v[92:95], v[188:191], v[164:167], v[92:95]
    ds_read_b64_tr_b16 v[180:181], v231 offset:49152
    s_waitcnt lgkmcnt(7)
    v_mfma_f32_16x16x32_bf16 v[96:99], v[192:195], v[152:155], v[96:99]
    buffer_load_dwordx4 v218, s[12:15], s1 offen offset:1024  lds
    ds_read_b64_tr_b16 v[182:183], v231 offset:50176
    v_mfma_f32_16x16x32_bf16 v[96:99], v[196:199], v[156:159], v[96:99]
    ds_read_b64_tr_b16 v[184:185], v232 offset:45056
    v_mfma_f32_16x16x32_bf16 v[100:103], v[192:195], v[160:163], v[100:103]
    ds_read_b64_tr_b16 v[186:187], v232 offset:46080
    v_mfma_f32_16x16x32_bf16 v[100:103], v[196:199], v[164:167], v[100:103]
    ds_read_b64_tr_b16 v[188:189], v232 offset:49152
    s_waitcnt lgkmcnt(7)
    v_mfma_f32_16x16x32_bf16 v[104:107], v[168:171], v[152:155], v[104:107]
    ds_read_b64_tr_b16 v[190:191], v232 offset:50176
    v_mfma_f32_16x16x32_bf16 v[104:107], v[172:175], v[156:159], v[104:107]
    buffer_load_dwordx2 v[248:249], v235, s[16:19], s74 offen sc1
    v_mfma_f32_16x16x32_bf16 v[108:111], v[168:171], v[160:163], v[108:111]
    ds_read_b128 v[192:195], v233 offset:896
    v_mfma_f32_16x16x32_bf16 v[108:111], v[172:175], v[164:167], v[108:111]
    ds_read_b128 v[196:199], v233 offset:960
    s_waitcnt lgkmcnt(6)
    v_mfma_f32_16x16x32_bf16 v[112:115], v[176:179], v[152:155], v[112:115]
    v_mfma_f32_16x16x32_bf16 v[112:115], v[180:183], v[156:159], v[112:115]
    s_waitcnt vmcnt(12) lgkmcnt(0)
    s_barrier
    ds_read_b64_tr_b16 v[168:169], v228 offset:0
    v_mfma_f32_16x16x32_bf16 v[116:119], v[176:179], v[160:163], v[116:119]
    ds_read_b64_tr_b16 v[170:171], v228 offset:1280
    v_mfma_f32_16x16x32_bf16 v[116:119], v[180:183], v[164:167], v[116:119]
    ds_read_b64_tr_b16 v[172:173], v228 offset:5120
    v_mfma_f32_16x16x32_bf16 v[120:123], v[184:187], v[152:155], v[120:123]
    ds_read_b64_tr_b16 v[174:175], v228 offset:6400
    ds_read_b128 v[136:139], v224 offset:0
    v_mfma_f32_16x16x32_bf16 v[120:123], v[188:191], v[156:159], v[120:123]
    ds_read_b128 v[140:143], v225 offset:0
    v_mfma_f32_16x16x32_bf16 v[124:127], v[184:187], v[160:163], v[124:127]
    ds_read_b128 v[144:147], v224 offset:2048
    v_mfma_f32_16x16x32_bf16 v[124:127], v[188:191], v[164:167], v[124:127]
    ds_read_b128 v[148:151], v225 offset:2048
    v_mfma_f32_16x16x32_bf16 v[128:131], v[192:195], v[152:155], v[128:131]
    ds_read_b64_tr_b16 v[176:177], v228 offset:8
    ds_read_b64_tr_b16 v[178:179], v228 offset:1288
    v_mfma_f32_16x16x32_bf16 v[128:131], v[196:199], v[156:159], v[128:131]
    ds_read_b64_tr_b16 v[180:181], v228 offset:5128
    ds_read_b64_tr_b16 v[182:183], v228 offset:6408
    v_mfma_f32_16x16x32_bf16 v[132:135], v[192:195], v[160:163], v[132:135]
    ds_read_b64_tr_b16 v[184:185], v228 offset:16
    s_waitcnt vmcnt(0)
    v_mfma_f32_16x16x32_bf16 v[132:135], v[196:199], v[164:167], v[132:135]
    ds_read_b64_tr_b16 v[186:187], v228 offset:1296
    s_waitcnt lgkmcnt(9)
    v_mfma_f32_16x16x32_bf16 v[16:19], v[168:171], v[136:139], v[16:19]
    ds_read_b64_tr_b16 v[188:189], v228 offset:5136
    s_waitcnt lgkmcnt(9)
    v_mfma_f32_16x16x32_bf16 v[16:19], v[172:175], v[140:143], v[16:19]
    ds_read_b64_tr_b16 v[190:191], v228 offset:6416
    s_waitcnt lgkmcnt(9)
    v_mfma_f32_16x16x32_bf16 v[20:23], v[168:171], v[144:147], v[20:23]
    ds_read_b64_tr_b16 v[192:193], v228 offset:24
    s_waitcnt lgkmcnt(9)
    v_mfma_f32_16x16x32_bf16 v[20:23], v[172:175], v[148:151], v[20:23]
    ds_read_b64_tr_b16 v[194:195], v228 offset:1304
    s_waitcnt lgkmcnt(6)
    v_mfma_f32_16x16x32_bf16 v[24:27], v[176:179], v[136:139], v[24:27]
    ds_read_b64_tr_b16 v[196:197], v228 offset:5144
    ds_read_b64_tr_b16 v[198:199], v228 offset:6424
    v_cmp_ne_u64 vcc, s[58:59], v[248:249]
    v_mfma_f32_16x16x32_bf16 v[24:27], v[180:183], v[140:143], v[24:27]
    ds_read_b64_tr_b16 v[168:169], v228 offset:32
    s_nop 1
    s_cbranch_vccnz L_slow_1
L_back_2:
    v_mfma_f32_16x16x32_bf16 v[28:31], v[176:179], v[144:147], v[28:31]
    ds_read_b64_tr_b16 v[170:171], v228 offset:1312
    v_mfma_f32_16x16x32_bf16 v[28:31], v[180:183], v[148:151], v[28:31]
    ds_read_b64_tr_b16 v[172:173], v228 offset:5152
    s_waitcnt lgkmcnt(7)
    v_mfma_f32_16x16x32_bf16 v[32:35], v[184:187], v[136:139], v[32:35]
    s_add_u32 s100, s97, 0
    buffer_load_dwordx4 a[0:3], v6, s[16:19], s100 offen offset:0 sc1
    ds_read_b64_tr_b16 v[174:175], v228 offset:6432
    v_mfma_f32_16x16x32_bf16 v[32:35], v[188:191], v[140:143], v[32:35]
    ds_read_b64_tr_b16 v[176:177], v228 offset:10240
    v_mfma_f32_16x16x32_bf16 v[36:39], v[184:187], v[144:147], v[36:39]
    ds_read_b64_tr_b16 v[178:179], v228 offset:11520
    v_mfma_f32_16x16x32_bf16 v[36:39], v[188:191], v[148:151], v[36:39]
    ds_read_b64_tr_b16 v[180:181], v228 offset:15360
    s_waitcnt lgkmcnt(7)
    v_mfma_f32_16x16x32_bf16 v[40:43], v[192:195], v[136:139], v[40:43]
    buffer_load_dwordx4 a[4:7], v6, s[16:19], s100 offen offset:1024 sc1
    ds_read_b64_tr_b16 v[182:183], v228 offset:16640
    v_mfma_f32_16x16x32_bf16 v[40:43], v[196:199], v[140:143], v[40:43]
    ds_read_b64_tr_b16 v[184:185], v228 offset:10248
    v_mfma_f32_16x16x32_bf16 v[44:47], v[192:195], v[144:147], v[44:47]
    ds_read_b64_tr_b16 v[186:187], v228 offset:11528
    v_mfma_f32_16x16x32_bf16 v[44:47], v[196:199], v[148:151], v[44:47]
    ds_read_b64_tr_b16 v[188:189], v228 offset:15368
    s_waitcnt lgkmcnt(7)
    v_mfma_f32_16x16x32_bf16 v[48:51], v[168:171], v[136:139], v[48:51]
    buffer_load_dwordx4 a[8:11], v6, s[16:19], s100 offen offset:2048 sc1
    ds_read_b64_tr_b16 v[190:191], v228 offset:16648
    v_mfma_f32_16x16x32_bf16 v[48:51], v[172:175], v[140:143], v[48:51]
    ds_read_b64_tr_b16 v[192:193], v228 offset:10256
    v_mfma_f32_16x16x32_bf16 v[52:55], v[168:171], v[144:147], v[52:55]
    ds_read_b64_tr_b16 v[194:195], v228 offset:11536
    v_mfma_f32_16x16x32_bf16 v[52:55], v[172:175], v[148:151], v[52:55]
    ds_read_b64_tr_b16 v[196:197], v228 offset:15376
    s_waitcnt lgkmcnt(7)
    v_mfma_f32_16x16x32_bf16 v[56:59], v[176:179], v[136:139], v[56:59]
    buffer_load_dwordx4 a[12:15], v6, s[16:19], s100 offen offset:3072 sc1
    ds_read_b64_tr_b16 v[198:199], v228 offset:16656
    v_mfma_f32_16x16x32_bf16 v[56:59], v[180:183], v[140:143], v[56:59]
    ds_read_b64_tr_b16 v[168:169], v228 offset:10264
    v_mfma_f32_16x16x32_bf16 v[60:63], v[176:179], v[144:147], v[60:63]
    ds_read_b64_tr_b16 v[170:171], v228 offset:11544
    v_mfma_f32_16x16x32_bf16 v[60:63], v[180:183], v[148:151], v[60:63]
    ds_read_b64_tr_b16 v[172:173], v228 offset:15384
    s_waitcnt lgkmcnt(7)
    v_mfma_f32_16x16x32_bf16 v[64:67], v[184:187], v[136:139], v[64:67]
    buffer_load_dwordx4 a[16:19], v240, s[16:19], s100 offen offset:0 sc1
    ds_read_b64_tr_b16 v[174:175], v228 offset:16664
    v_mfma_f32_16x16x32_bf16 v[64:67], v[188:191], v[140:143], v[64:67]
    ds_read_b64_tr_b16 v[176:177], v228 offset:10272
    v_mfma_f32_16x16x32_bf16 v[68:71], v[184:187], v[144:147], v[68:71]
    ds_read_b64_tr_b16 v[178:179], v228 offset:11552
    v_mfma_f32_16x16x32_bf16 v[68:71], v[188:191], v[148:151], v[68:71]
    ds_read_b64_tr_b16 v[180:181], v228 offset:15392
    s_waitcnt lgkmcnt(7)
    v_mfma_f32_16x16x32_bf16 v[72:75], v[192:195], v[136:139], v[72:75]
    s_add_u32 s100, s97, 20480
    buffer_load_dwordx4 a[20:23], v6, s[16:19], s100 offen offset:0 sc1
    ds_read_b64_tr_b16 v[182:183], v228 offset:16672
    v_mfma_f32_16x16x32_bf16 v[72:75], v[196:199], v[140:143], v[72:75]
    ds_read_b64_tr_b16 v[184:185], v204 offset:0
    v_mfma_f32_16x16x32_bf16 v[76:79], v[192:195], v[144:147], v[76:79]
    ds_read_b64_tr_b16 v[186:187], v204 offset:1024
    v_mfma_f32_16x16x32_bf16 v[76:79], v[196:199], v[148:151], v[76:79]
    ds_read_b64_tr_b16 v[188:189], v204 offset:4096
    s_waitcnt lgkmcnt(7)
    v_mfma_f32_16x16x32_bf16 v[80:83], v[168:171], v[136:139], v[80:83]
    buffer_load_dwordx4 a[24:27], v6, s[16:19], s100 offen offset:1024 sc1
    ds_read_b64_tr_b16 v[190:191], v204 offset:5120
    v_mfma_f32_16x16x32_bf16 v[80:83], v[172:175], v[140:143], v[80:83]
    ds_read_b64_tr_b16 v[192:193], v205 offset:0
    v_mfma_f32_16x16x32_bf16 v[84:87], v[168:171], v[144:147], v[84:87]
    ds_read_b64_tr_b16 v[194:195], v205 offset:1024
    v_mfma_f32_16x16x32_bf16 v[84:87], v[172:175], v[148:151], v[84:87]
    ds_read_b64_tr_b16 v[196:197], v205 offset:4096
    s_waitcnt lgkmcnt(7)
    v_mfma_f32_16x16x32_bf16 v[88:91], v[176:179], v[136:139], v[88:91]
    buffer_load_dwordx4 a[28:31], v6, s[16:19], s100 offen offset:2048 sc1
    ds_read_b64_tr_b16 v[198:199], v205 offset:5120
    v_mfma_f32_16x16x32_bf16 v[88:91], v[180:183], v[140:143], v[88:91]
    ds_read_b64_tr_b16 v[168:169], v206 offset:0
    v_mfma_f32_16x16x32_bf16 v[92:95], v[176:179], v[144:147], v[92:95]
    ds_read_b64_tr_b16 v[170:171], v206 offset:1024
    v_mfma_f32_16x16x32_bf16 v[92:95], v[180:183], v[148:151], v[92:95]
    ds_read_b64_tr_b16 v[172:173], v206 offset:4096
    s_waitcnt lgkmcnt(7)
    v_mfma_f32_16x16x32_bf16 v[96:99], v[184:187], v[136:139], v[96:99]
    buffer_load_dwordx4 a[32:35], v6, s[16:19], s100 offen offset:3072 sc1
    ds_read_b64_tr_b16 v[174:175], v206 offset:5120
    v_mfma_f32_16x16x32_bf16 v[96:99], v[188:191], v[140:143], v[96:99]
    ds_read_b64_tr_b16 v[176:177], v207 offset:0
    v_mfma_f32_16x16x32_bf16 v[100:103], v[184:187], v[144:147], v[100:103]
    ds_read_b64_tr_b16 v[178:179], v207 offset:1024
    v_mfma_f32_16x16x32_bf16 v[100:103], v[188:191], v[148:151], v[100:103]
    ds_read_b64_tr_b16 v[180:181], v207 offset:4096
    s_waitcnt lgkmcnt(7)
    v_mfma_f32_16x16x32_bf16 v[104:107], v[192:195], v[136:139], v[104:107]
    buffer_load_dwordx4 a[36:39], v240, s[16:19], s100 offen offset:0 sc1
    ds_read_b64_tr_b16 v[182:183], v207 offset:5120
    v_mfma_f32_16x16x32_bf16 v[104:107], v[196:199], v[140:143], v[104:107]
    ds_read_b128 v[184:187], v233 offset:1024
    v_mfma_f32_16x16x32_bf16 v[108:111], v[192:195], v[144:147], v[108:111]
    ds_read_b128 v[188:191], v233 offset:1088
    v_mfma_f32_16x16x32_bf16 v[108:111], v[196:199], v[148:151], v[108:111]
    s_waitcnt lgkmcnt(6)
    v_mfma_f32_16x16x32_bf16 v[112:115], v[168:171], v[136:139], v[112:115]
    s_waitcnt lgkmcnt(0)
    s_barrier
    ds_read_b64_tr_b16 v[192:193], v226 offset:0
    v_mfma_f32_16x16x32_bf16 v[112:115], v[172:175], v[140:143], v[112:115]
    s_add_u32 s100, s97, 40960
    buffer_load_dwordx4 a[40:43], v6, s[16:19], s100 offen offset:0 sc1
    v_mfma_f32_16x16x32_bf16 v[116:119], v[168:171], v[144:147], v[116:119]
    ds_read_b64_tr_b16 v[194:195], v226 offset:1280
    v_mfma_f32_16x16x32_bf16 v[116:119], v[172:175], v[148:151], v[116:119]
    ds_read_b64_tr_b16 v[196:197], v226 offset:5120
    s_or_b32 s55, s2, s3
    v_mfma_f32_16x16x32_bf16 v[120:123], v[176:179], v[136:139], v[120:123]
    ds_read_b64_tr_b16 v[198:199], v226 offset:6400
    ds_read_b128 a[148:151], v220 offset:0
    v_mfma_f32_16x16x32_bf16 v[120:123], v[180:183], v[140:143], v[120:123]
    buffer_load_dwordx4 a[44:47], v6, s[16:19], s100 offen offset:1024 sc1
    ds_read_b128 a[152:155], v221 offset:0
    v_mfma_f32_16x16x32_bf16 v[124:127], v[176:179], v[144:147], v[124:127]
    ds_read_b128 a[156:159], v220 offset:2048
    s_min_u32 s55, s55, 1
    v_mfma_f32_16x16x32_bf16 v[124:127], v[180:183], v[148:151], v[124:127]
    ds_read_b128 a[160:163], v221 offset:2048
    s_mul_i32 s55, s55, 2146435072
    s_add_u32 s55, s55, 98304
    v_mfma_f32_16x16x32_bf16 v[128:131], v[184:187], v[136:139], v[128:131]
    ds_read_b64_tr_b16 v[168:169], v226 offset:8
    ds_read_b64_tr_b16 v[170:171], v226 offset:1288
    v_lshlrev_b32 v200, 7, v0
    v_mfma_f32_16x16x32_bf16 v[128:131], v[188:191], v[140:143], v[128:131]
    buffer_load_dwordx4 a[48:51], v6, s[16:19], s100 offen offset:2048 sc1
    ds_read_b64_tr_b16 v[172:173], v226 offset:5128
    v_add_u32 v201, 8192, v200
    v_mfma_f32_16x16x32_bf16 v[132:135], v[184:187], v[144:147], v[132:135]
    ds_read_b64_tr_b16 v[174:175], v226 offset:6408
    ds_read_b64_tr_b16 a[164:165], v229 offset:0
    v_add_u32 v202, 16384, v200
    v_mfma_f32_16x16x32_bf16 v[132:135], v[188:191], v[148:151], v[132:135]
    ds_read_b64_tr_b16 a[166:167], v229 offset:1024
    v_add_u32 v203, 24576, v200
    s_waitcnt lgkmcnt(9)
    v_mfma_f32_16x16x32_bf16 v[16:19], v[192:195], a[148:151], v[16:19]
    buffer_load_dwordx2 v[248:249], v200, s[16:19], s55 offen sc1
    s_waitcnt lgkmcnt(8)
    v_mfma_f32_16x16x32_bf16 v[16:19], v[196:199], a[152:155], v[16:19]
    buffer_load_dwordx2 v[250:251], v201, s[16:19], s55 offen sc1
    s_waitcnt lgkmcnt(7)
    v_mfma_f32_16x16x32_bf16 v[20:23], v[192:195], a[156:159], v[20:23]
    buffer_load_dwordx2 v[252:253], v202, s[16:19], s55 offen sc1
    ds_read_b64_tr_b16 a[168:169], v229 offset:4096
    ds_read_b64_tr_b16 a[170:171], v229 offset:5120
    s_waitcnt lgkmcnt(8)
    v_mfma_f32_16x16x32_bf16 v[20:23], v[196:199], a[160:163], v[20:23]
    buffer_load_dwordx2 v[254:255], v203, s[16:19], s55 offen sc1
    s_waitcnt lgkmcnt(4)
    v_mfma_f32_16x16x32_bf16 v[24:27], v[168:171], a[148:151], v[24:27]
    ds_read_b64_tr_b16 v[176:177], v226 offset:16
    ds_read_b64_tr_b16 v[178:179], v226 offset:1296
    ds_read_b64_tr_b16 v[180:181], v226 offset:5136
    ds_read_b64_tr_b16 v[182:183], v226 offset:6416
    v_mfma_f32_16x16x32_bf16 v[24:27], v[172:175], a[152:155], v[24:27]
    ds_read_b64_tr_b16 v[184:185], v226 offset:24
    s_waitcnt lgkmcnt(5)
    v_mfma_f32_16x16x32_bf16 v[28:31], v[168:171], a[156:159], v[28:31]
    ds_read_b64_tr_b16 v[186:187], v226 offset:1304
    ds_read_b64_tr_b16 v[188:189], v226 offset:5144
    v_mfma_f32_16x16x32_bf16 v[28:31], v[172:175], a[160:163], v[28:31]
    ds_read_b64_tr_b16 v[190:191], v226 offset:6424
    s_waitcnt lgkmcnt(4)
    v_mfma_f32_16x16x32_bf16 v[32:35], v[176:179], a[148:151], v[32:35]
    ds_read_b64_tr_b16 a[172:173], v230 offset:0
    ds_read_b64_tr_b16 a[174:175], v230 offset:1024
    ds_read_b64_tr_b16 a[176:177], v230 offset:4096
    ds_read_b64_tr_b16 a[178:179], v230 offset:5120
    v_mfma_f32_16x16x32_bf16 v[32:35], v[180:183], a[152:155], v[32:35]
    ds_read_b64_tr_b16 v[192:193], v226 offset:32
    ds_read_b64_tr_b16 v[194:195], v226 offset:1312
    v_mfma_f32_16x16x32_bf16 v[36:39], v[176:179], a[156:159], v[36:39]
    ds_read_b64_tr_b16 v[196:197], v226 offset:5152
    ds_read_b64_tr_b16 v[198:199], v226 offset:6432
    v_mfma_f32_16x16x32_bf16 v[36:39], v[180:183], a[160:163], v[36:39]
    ds_read_b64_tr_b16 a[180:181], v231 offset:0
    s_waitcnt lgkmcnt(5)
    v_mfma_f32_16x16x32_bf16 v[40:43], v[184:187], a[148:151], v[40:43]
    ds_read_b64_tr_b16 a[182:183], v231 offset:1024
    ds_read_b64_tr_b16 a[184:185], v231 offset:4096
    v_mfma_f32_16x16x32_bf16 v[40:43], v[188:191], a[152:155], v[40:43]
    ds_read_b64_tr_b16 a[186:187], v231 offset:5120
    ds_read_b64_tr_b16 v[168:169], v226 offset:10240
    v_mfma_f32_16x16x32_bf16 v[44:47], v[184:187], a[156:159], v[44:47]
    buffer_load_dwordx4 a[52:55], v6, s[16:19], s100 offen offset:3072 sc1
    ds_read_b64_tr_b16 v[170:171], v226 offset:11520
    v_mfma_f32_16x16x32_bf16 v[44:47], v[188:191], a[160:163], v[44:47]
    ds_read_b64_tr_b16 v[172:173], v226 offset:15360
    s_waitcnt lgkmcnt(7)
    v_mfma_f32_16x16x32_bf16 v[48:51], v[192:195], a[148:151], v[48:51]
    ds_read_b64_tr_b16 v[174:175], v226 offset:16640
    ds_read_b64_tr_b16 v[176:177], v226 offset:10248
    v_mfma_f32_16x16x32_bf16 v[48:51], v[196:199], a[152:155], v[48:51]
    ds_read_b64_tr_b16 v[178:179], v226 offset:11528
    s_waitcnt lgkmcnt(6)
    v_mfma_f32_16x16x32_bf16 v[52:55], v[192:195], a[156:159], v[52:55]
    buffer_load_dwordx4 a[56:59], v240, s[16:19], s100 offen offset:0 sc1
    ds_read_b64_tr_b16 v[180:181], v226 offset:15368
    v_mfma_f32_16x16x32_bf16 v[52:55], v[196:199], a[160:163], v[52:55]
    ds_read_b64_tr_b16 v[182:183], v226 offset:16648
    s_waitcnt lgkmcnt(4)
    v_mfma_f32_16x16x32_bf16 v[56:59], v[168:171], a[148:151], v[56:59]
    ds_read_b64_tr_b16 a[188:189], v232 offset:0
    ds_read_b64_tr_b16 a[190:191], v232 offset:1024
    ds_read_b64_tr_b16 a[192:193], v232 offset:4096
    ds_read_b64_tr_b16 a[194:195], v232 offset:5120
    v_mfma_f32_16x16x32_bf16 v[56:59], v[172:175], a[152:155], v[56:59]
    s_add_u32 s100, s97, 61440
    buffer_load_dwordx4 a[60:63], v6, s[16:19], s100 offen offset:0 sc1
    ds_read_b64_tr_b16 v[184:185], v226 offset:10256
    v_mfma_f32_16x16x32_bf16 v[60:63], v[168:171], a[156:159], v[60:63]
    ds_read_b64_tr_b16 v[186:187], v226 offset:11536
    ds_read_b64_tr_b16 v[188:189], v226 offset:15376
    v_mfma_f32_16x16x32_bf16 v[60:63], v[172:175], a[160:163], v[60:63]
    ds_read_b64_tr_b16 v[190:191], v226 offset:16656
    s_waitcnt lgkmcnt(4)
    v_mfma_f32_16x16x32_bf16 v[64:67], v[176:179], a[148:151], v[64:67]
    ds_read_b128 a[196:199], v233 offset:1152
    ds_read_b128 a[200:203], v233 offset:1216
    v_mfma_f32_16x16x32_bf16 v[64:67], v[180:183], a[152:155], v[64:67]
    buffer_load_dwordx4 a[64:67], v6, s[16:19], s100 offen offset:1024 sc1
    ds_read_b64_tr_b16 v[192:193], v226 offset:10264
    v_mfma_f32_16x16x32_bf16 v[68:71], v[176:179], a[156:159], v[68:71]
    ds_read_b64_tr_b16 v[194:195], v226 offset:11544
    ds_read_b64_tr_b16 v[196:197], v226 offset:15384
    v_mfma_f32_16x16x32_bf16 v[68:71], v[180:183], a[160:163], v[68:71]
    ds_read_b64_tr_b16 v[198:199], v226 offset:16664
    s_waitcnt lgkmcnt(6)
    v_mfma_f32_16x16x32_bf16 v[72:75], v[184:187], a[148:151], v[72:75]
    ds_read_b64_tr_b16 v[168:169], v226 offset:10272
    ds_read_b64_tr_b16 v[170:171], v226 offset:11552
    v_mfma_f32_16x16x32_bf16 v[72:75], v[188:191], a[152:155], v[72:75]
    buffer_load_dwordx4 a[68:71], v6, s[16:19], s100 offen offset:2048 sc1
    s_waitcnt lgkmcnt(6)
    v_mfma_f32_16x16x32_bf16 v[76:79], v[184:187], a[156:159], v[76:79]
    ds_read_b64_tr_b16 v[172:173], v226 offset:15392
    ds_read_b64_tr_b16 v[174:175], v226 offset:16672
    v_mfma_f32_16x16x32_bf16 v[76:79], v[188:191], a[160:163], v[76:79]
    s_waitcnt lgkmcnt(4)
    v_mfma_f32_16x16x32_bf16 v[80:83], v[192:195], a[148:151], v[80:83]
    v_mfma_f32_16x16x32_bf16 v[80:83], v[196:199], a[152:155], v[80:83]
    buffer_load_dwordx4 a[72:75], v6, s[16:19], s100 offen offset:3072 sc1
    v_mfma_f32_16x16x32_bf16 v[84:87], v[192:195], a[156:159], v[84:87]
    v_mfma_f32_16x16x32_bf16 v[84:87], v[196:199], a[160:163], v[84:87]
    s_waitcnt lgkmcnt(0)
    v_mfma_f32_16x16x32_bf16 v[88:91], v[168:171], a[148:151], v[88:91]
    v_mfma_f32_16x16x32_bf16 v[88:91], v[172:175], a[152:155], v[88:91]
    buffer_load_dwordx4 a[76:79], v240, s[16:19], s100 offen offset:0 sc1
    v_mfma_f32_16x16x32_bf16 v[92:95], v[168:171], a[156:159], v[92:95]
    v_mfma_f32_16x16x32_bf16 v[92:95], v[172:175], a[160:163], v[92:95]
    s_mov_b32 s24, s48
    s_and_b32 s25, s49, 0xffff
    s_mov_b32 s26, 1280
    s_mov_b32 s27, 0x20000
    s_mov_b32 s20, s52
    s_and_b32 s21, s53, 0xffff
    s_mov_b32 s22, 2621440
    s_mov_b32 s23, 0x20000
    s_mul_i32 s80, s63, 160
    s_and_b32 s81, s63, 1
    s_lshl_b32 s82, s81, 5
    s_add_u32 s82, s82, s80
    s_xor_b32 s81, s81, 1
    s_lshl_b32 s81, s81, 7
    s_add_u32 s81, s81, s80
    s_min_u32 s83, s3, 1
    s_mul_i32 s83, s83, 1280
    s_sub_u32 s26, 1280, s83
    s_lshr_b32 s85, s62, 1
    s_lshl_b32 s83, s85, 11
    s_add_u32 s83, s83, 40960
    s_add_u32 s84, s83, 1024
    v_and_b32 v235, 7, v0
    v_lshlrev_b32 v235, 7, v235
    v_lshlrev_b32 v7, 4, v2
    v_lshlrev_b32 v8, 3, v2
    buffer_load_dwordx4 v[224:227], v7, s[24:27], s82 offen
    buffer_load_dwordx4 v[228:231], v7, s[24:27], s82 offen offset:64
    buffer_load_dwordx2 v[232:233], v8, s[24:27], s81 offen
    s_waitcnt vmcnt(10)
    s_or_b32 s74, s2, s3
    s_cbranch_scc1 L_tg_3
    v_cmp_ne_u64 vcc, s[58:59], v[248:249]
    v_cmp_ne_u64 s[28:29], s[58:59], v[250:251]
    v_cmp_ne_u64 s[30:31], s[58:59], v[252:253]
    v_cmp_ne_u64 s[46:47], s[58:59], v[254:255]
    s_nop 1
    s_or_b64 vcc, vcc, s[28:29]
    s_or_b64 vcc, vcc, s[30:31]
    s_or_b64 vcc, vcc, s[46:47]
    s_cbranch_vccnz L_slow_4
L_back_5:
    buffer_store_dwordx2 v[246:247], v245, s[16:19], 0 offen sc1
L_tg_3:
    v_cvt_pk_bf16_f32 v136, v16, v17
    v_cvt_pk_bf16_f32 v137, v18, v19
    v_cvt_pk_bf16_f32 v138, v24, v25
    v_cvt_pk_bf16_f32 v139, v26, v27
    v_cvt_pk_bf16_f32 v140, v32, v33
    v_cvt_pk_bf16_f32 v141, v34, v35
    v_cvt_pk_bf16_f32 v142, v40, v41
    v_cvt_pk_bf16_f32 v143, v42, v43
    v_cvt_pk_bf16_f32 v144, v48, v49
    v_cvt_pk_bf16_f32 v145, v50, v51
    v_cvt_pk_bf16_f32 v146, v20, v21
    v_cvt_pk_bf16_f32 v147, v22, v23
    v_cvt_pk_bf16_f32 v148, v28, v29
    v_cvt_pk_bf16_f32 v149, v30, v31
    v_cvt_pk_bf16_f32 v150, v36, v37
    v_cvt_pk_bf16_f32 v151, v38, v39
    v_cvt_pk_bf16_f32 v152, v44, v45
    v_cvt_pk_bf16_f32 v153, v46, v47
    v_cvt_pk_bf16_f32 v154, v52, v53
    v_cvt_pk_bf16_f32 v155, v54, v55
    v_mfma_f32_4x4x4_16b_bf16 v[168:171], a[204:205], v[136:137], 0
    v_cvt_pk_bf16_f32 v156, v56, v57
    v_mfma_f32_4x4x4_16b_bf16 v[172:175], a[206:207], v[136:137], 0
    v_cvt_pk_bf16_f32 v157, v58, v59
    v_mfma_f32_4x4x4_16b_bf16 v[176:179], a[208:209], v[136:137], 0
    v_cvt_pk_bf16_f32 v158, v64, v65
    v_mfma_f32_4x4x4_16b_bf16 v[180:183], a[210:211], v[136:137], 0
    v_cvt_pk_bf16_f32 v159, v66, v67
    v_mfma_f32_4x4x4_16b_bf16 v[184:187], a[212:213], v[136:137], 0
    v_cvt_pk_bf16_f32 v160, v72, v73
    v_mfma_f32_4x4x4_16b_bf16 v[188:191], a[204:205], v[146:147], 0
    v_cvt_pk_bf16_f32 v161, v74, v75
    v_mfma_f32_4x4x4_16b_bf16 v[192:195], a[206:207], v[146:147], 0
    v_cvt_pk_bf16_f32 v162, v80, v81
    v_mfma_f32_4x4x4_16b_bf16 v[196:199], a[208:209], v[146:147], 0
    v_cvt_pk_bf16_f32 v163, v82, v83
    v_mfma_f32_4x4x4_16b_bf16 v[200:203], a[210:211], v[146:147], 0
    v_cvt_pk_bf16_f32 v164, v88, v89
    v_mfma_f32_4x4x4_16b_bf16 v[204:207], a[212:213], v[146:147], 0
    v_cvt_pk_bf16_f32 v165, v90, v91
    v_mfma_f32_4x4x4_16b_bf16 v[168:171], a[214:215], v[138:139], v[168:171]
    v_mul_u32_u24 v220, 224, v1
    v_mfma_f32_4x4x4_16b_bf16 v[172:175], a[216:217], v[138:139], v[172:175]
    v_mad_u32_u24 v220, v2, 48, v220
    v_mfma_f32_4x4x4_16b_bf16 v[176:179], a[218:219], v[138:139], v[176:179]
    s_mul_i32 s74, s3, 7168
    v_mfma_f32_4x4x4_16b_bf16 v[180:183], a[220:221], v[138:139], v[180:183]
    s_add_u32 s74, s74, 45056
    v_mfma_f32_4x4x4_16b_bf16 v[184:187], a[222:223], v[138:139], v[184:187]
    v_add_u32 v220, s74, v220
    v_mfma_f32_4x4x4_16b_bf16 v[188:191], a[214:215], v[148:149], v[188:191]
    v_mul_u32_u24 v221, 352, v1
    v_mfma_f32_4x4x4_16b_bf16 v[192:195], a[216:217], v[148:149], v[192:195]
    s_mov_b32 s74, 80
    v_mfma_f32_4x4x4_16b_bf16 v[196:199], a[218:219], v[148:149], v[196:199]
    v_mad_u32_u24 v221, v2, s74, v221
    v_mfma_f32_4x4x4_16b_bf16 v[200:203], a[220:221], v[148:149], v[200:203]
    s_mul_i32 s74, s3, 11264
    v_mfma_f32_4x4x4_16b_bf16 v[204:207], a[222:223], v[148:149], v[204:207]
    v_add_u32 v221, s74, v221
    v_mfma_f32_4x4x4_16b_bf16 v[168:171], a[224:225], v[140:141], v[168:171]
    v_lshl_add_u32 v8, v2, 2, v3
    v_mfma_f32_4x4x4_16b_bf16 v[172:175], a[226:227], v[140:141], v[172:175]
    v_mul_u32_u24 v222, 352, v8
    v_mfma_f32_4x4x4_16b_bf16 v[176:179], a[228:229], v[140:141], v[176:179]
    v_lshl_add_u32 v222, v4, 3, v222
    v_mfma_f32_4x4x4_16b_bf16 v[180:183], a[230:231], v[140:141], v[180:183]
    s_mul_i32 s74, s3, 80
    v_mfma_f32_4x4x4_16b_bf16 v[184:187], a[232:233], v[140:141], v[184:187]
    v_add_u32 v222, s74, v222
    v_mfma_f32_4x4x4_16b_bf16 v[188:191], a[224:225], v[150:151], v[188:191]
    v_mul_u32_u24 v223, 224, v8
    v_mfma_f32_4x4x4_16b_bf16 v[192:195], a[226:227], v[150:151], v[192:195]
    v_lshl_add_u32 v223, v4, 3, v223
    v_mfma_f32_4x4x4_16b_bf16 v[196:199], a[228:229], v[150:151], v[196:199]
    s_mul_i32 s74, s3, 48
    v_mfma_f32_4x4x4_16b_bf16 v[200:203], a[230:231], v[150:151], v[200:203]
    s_add_u32 s74, s74, 45056
    v_mfma_f32_4x4x4_16b_bf16 v[204:207], a[232:233], v[150:151], v[204:207]
    v_add_u32 v223, s74, v223
    v_mfma_f32_4x4x4_16b_bf16 v[168:171], a[234:235], v[142:143], v[168:171]
    s_lshl_b32 s74, s61, 4
    v_mfma_f32_4x4x4_16b_bf16 v[172:175], a[236:237], v[142:143], v[172:175]
    s_add_u32 s74, s74, s60
    v_mfma_f32_4x4x4_16b_bf16 v[176:179], a[238:239], v[142:143], v[176:179]
    s_mul_i32 s75, s74, 15360
    v_mfma_f32_4x4x4_16b_bf16 v[180:183], a[240:241], v[142:143], v[180:183]
    s_add_u32 s75, s75, 262144
    v_mfma_f32_4x4x4_16b_bf16 v[184:187], a[242:243], v[142:143], v[184:187]
    v_mfma_f32_4x4x4_16b_bf16 v[188:191], a[234:235], v[152:153], v[188:191]
    v_mfma_f32_4x4x4_16b_bf16 v[192:195], a[236:237], v[152:153], v[192:195]
    v_mfma_f32_4x4x4_16b_bf16 v[196:199], a[238:239], v[152:153], v[196:199]
    v_mfma_f32_4x4x4_16b_bf16 v[200:203], a[240:241], v[152:153], v[200:203]
    v_mfma_f32_4x4x4_16b_bf16 v[204:207], a[242:243], v[152:153], v[204:207]
    v_mfma_f32_4x4x4_16b_bf16 v[168:171], a[244:245], v[144:145], v[168:171]
    v_mfma_f32_4x4x4_16b_bf16 v[172:175], a[246:247], v[144:145], v[172:175]
    v_mfma_f32_4x4x4_16b_bf16 v[176:179], a[248:249], v[144:145], v[176:179]
    v_mfma_f32_4x4x4_16b_bf16 v[180:183], a[250:251], v[144:145], v[180:183]
    v_mfma_f32_4x4x4_16b_bf16 v[184:187], a[252:253], v[144:145], v[184:187]
    v_mfma_f32_4x4x4_16b_bf16 v[188:191], a[244:245], v[154:155], v[188:191]
    v_mfma_f32_4x4x4_16b_bf16 v[192:195], a[246:247], v[154:155], v[192:195]
    v_mfma_f32_4x4x4_16b_bf16 v[196:199], a[248:249], v[154:155], v[196:199]
    v_mfma_f32_4x4x4_16b_bf16 v[200:203], a[250:251], v[154:155], v[200:203]
    v_mfma_f32_4x4x4_16b_bf16 v[204:207], a[252:253], v[154:155], v[204:207]
    v_mov_b32 v166, 0x3f80
    v_mov_b32 v167, 0
    s_mov_b32 s98, 0x3fb8aa3b
    s_barrier
    ds_write_b128 v220, v[156:159] offset:0
    ds_write_b128 v220, v[160:163] offset:16
    ds_write_b128 v220, v[164:167] offset:32
    v_max3_f32 v8, v168, v169, v170
    s_add_u32 s100, s97, 81920
    buffer_load_dwordx4 a[80:83], v6, s[16:19], s100 offen offset:0 sc1
    v_min3_f32 v10, v168, v169, v170
    v_max3_f32 v8, v8, v171, v172
    v_min3_f32 v10, v10, v171, v172
    v_max3_f32 v8, v8, v173, v174
    v_min3_f32 v10, v10, v173, v174
    v_max3_f32 v8, v8, v175, v176
    v_min3_f32 v10, v10, v175, v176
    v_max3_f32 v8, v8, v177, v178
    v_min3_f32 v10, v10, v177, v178
    v_max3_f32 v8, v8, v179, v180
    v_min3_f32 v10, v10, v179, v180
    v_max3_f32 v8, v8, v181, v182
    buffer_load_dwordx4 a[84:87], v6, s[16:19], s100 offen offset:1024 sc1
    v_min3_f32 v10, v10, v181, v182
    v_max3_f32 v8, v8, v183, v184
    v_min3_f32 v10, v10, v183, v184
    v_cvt_pk_bf16_f32 v208, v60, v61
    v_cvt_pk_bf16_f32 v209, v62, v63
    v_cvt_pk_bf16_f32 v210, v68, v69
    v_cvt_pk_bf16_f32 v211, v70, v71
    v_cvt_pk_bf16_f32 v212, v76, v77
    v_cvt_pk_bf16_f32 v213, v78, v79
    v_cvt_pk_bf16_f32 v214, v84, v85
    v_cvt_pk_bf16_f32 v215, v86, v87
    v_cvt_pk_bf16_f32 v216, v92, v93
    v_cvt_pk_bf16_f32 v217, v94, v95
    v_mov_b32 v218, 0x3f80
    v_mov_b32 v219, 0
    buffer_load_dwordx4 a[88:91], v6, s[16:19], s100 offen offset:2048 sc1
    ds_write_b128 v220, v[208:211] offset:3584
    ds_write_b128 v220, v[212:215] offset:3600
    ds_write_b128 v220, v[216:219] offset:3616
    v_max3_f32 v8, v8, v185, v186
    v_min3_f32 v10, v10, v185, v186
    v_max_f32 v8, v8, v187
    v_min_f32 v10, v10, v187
    v_mul_f32_e64 v8, -v8, s98
    v_mul_f32 v10, s98, v10
    v_pk_fma_f32 v[16:17], v[168:169], s[98:99], v[8:9] op_sel_hi:[1,0,0]
    v_pk_fma_f32 v[36:37], v[168:169], s[98:99], v[10:11] op_sel_hi:[1,0,0] neg_lo:[1,0,0] neg_hi:[1,0,0]
    v_pk_fma_f32 v[18:19], v[170:171], s[98:99], v[8:9] op_sel_hi:[1,0,0]
    v_pk_fma_f32 v[38:39], v[170:171], s[98:99], v[10:11] op_sel_hi:[1,0,0] neg_lo:[1,0,0] neg_hi:[1,0,0]
    v_pk_fma_f32 v[20:21], v[172:173], s[98:99], v[8:9] op_sel_hi:[1,0,0]
    v_pk_fma_f32 v[40:41], v[172:173], s[98:99], v[10:11] op_sel_hi:[1,0,0] neg_lo:[1,0,0] neg_hi:[1,0,0]
    buffer_load_dwordx4 a[92:95], v6, s[16:19], s100 offen offset:3072 sc1
    v_pk_fma_f32 v[22:23], v[174:175], s[98:99], v[8:9] op_sel_hi:[1,0,0]
    v_pk_fma_f32 v[42:43], v[174:175], s[98:99], v[10:11] op_sel_hi:[1,0,0] neg_lo:[1,0,0] neg_hi:[1,0,0]
    v_pk_fma_f32 v[24:25], v[176:177], s[98:99], v[8:9] op_sel_hi:[1,0,0]
    v_pk_fma_f32 v[44:45], v[176:177], s[98:99], v[10:11] op_sel_hi:[1,0,0] neg_lo:[1,0,0] neg_hi:[1,0,0]
    v_pk_fma_f32 v[26:27], v[178:179], s[98:99], v[8:9] op_sel_hi:[1,0,0]
    v_pk_fma_f32 v[46:47], v[178:179], s[98:99], v[10:11] op_sel_hi:[1,0,0] neg_lo:[1,0,0] neg_hi:[1,0,0]
    v_pk_fma_f32 v[28:29], v[180:181], s[98:99], v[8:9] op_sel_hi:[1,0,0]
    v_pk_fma_f32 v[48:49], v[180:181], s[98:99], v[10:11] op_sel_hi:[1,0,0] neg_lo:[1,0,0] neg_hi:[1,0,0]
    v_pk_fma_f32 v[30:31], v[182:183], s[98:99], v[8:9] op_sel_hi:[1,0,0]
    v_pk_fma_f32 v[50:51], v[182:183], s[98:99], v[10:11] op_sel_hi:[1,0,0] neg_lo:[1,0,0] neg_hi:[1,0,0]
    v_pk_fma_f32 v[32:33], v[184:185], s[98:99], v[8:9] op_sel_hi:[1,0,0]
    v_pk_fma_f32 v[52:53], v[184:185], s[98:99], v[10:11] op_sel_hi:[1,0,0] neg_lo:[1,0,0] neg_hi:[1,0,0]
    v_pk_fma_f32 v[34:35], v[186:187], s[98:99], v[8:9] op_sel_hi:[1,0,0]
    v_pk_fma_f32 v[54:55], v[186:187], s[98:99], v[10:11] op_sel_hi:[1,0,0] neg_lo:[1,0,0] neg_hi:[1,0,0]
    v_exp_f32 v16, v16
    buffer_load_dwordx4 a[96:99], v240, s[16:19], s100 offen offset:0 sc1
    v_exp_f32 v17, v17
    v_exp_f32 v18, v18
    v_exp_f32 v19, v19
    v_exp_f32 v20, v20
    v_exp_f32 v21, v21
    v_exp_f32 v22, v22
    v_exp_f32 v23, v23
    s_add_u32 s100, s97, 102400
    buffer_load_dwordx4 a[100:103], v6, s[16:19], s100 offen offset:0 sc1
    v_exp_f32 v24, v24
    v_exp_f32 v25, v25
    v_exp_f32 v26, v26
    v_exp_f32 v27, v27
    v_exp_f32 v28, v28
    v_exp_f32 v29, v29
    v_exp_f32 v30, v30
    buffer_load_dwordx4 a[104:107], v6, s[16:19], s100 offen offset:1024 sc1
    v_exp_f32 v31, v31
    v_exp_f32 v32, v32
    v_exp_f32 v33, v33
    v_exp_f32 v34, v34
    v_exp_f32 v35, v35
    v_exp_f32 v36, v36
    v_exp_f32 v37, v37
    v_exp_f32 v38, v38
    buffer_load_dwordx4 a[108:111], v6, s[16:19], s100 offen offset:2048 sc1
    v_exp_f32 v39, v39
    v_exp_f32 v40, v40
    v_exp_f32 v41, v41
    v_exp_f32 v42, v42
    v_exp_f32 v43, v43
    v_exp_f32 v44, v44
    v_exp_f32 v45, v45
    buffer_load_dwordx4 a[112:115], v6, s[16:19], s100 offen offset:3072 sc1
    v_exp_f32 v46, v46
    v_exp_f32 v47, v47
    v_exp_f32 v48, v48
    v_exp_f32 v49, v49
    v_exp_f32 v50, v50
    v_exp_f32 v51, v51
    v_exp_f32 v52, v52
    v_exp_f32 v53, v53
    buffer_load_dwordx4 a[116:119], v240, s[16:19], s100 offen offset:0 sc1
    v_exp_f32 v54, v54
    v_exp_f32 v55, v55
    v_pk_add_f32 v[8:9], v[16:17], v[18:19]
    v_pk_add_f32 v[10:11], v[36:37], v[38:39]
    v_pk_add_f32 v[8:9], v[8:9], v[20:21]
    v_pk_add_f32 v[10:11], v[10:11], v[40:41]
    v_pk_add_f32 v[8:9], v[8:9], v[22:23]
    v_pk_add_f32 v[10:11], v[10:11], v[42:43]
    v_pk_add_f32 v[8:9], v[8:9], v[24:25]
    v_pk_add_f32 v[10:11], v[10:11], v[44:45]
    v_pk_add_f32 v[8:9], v[8:9], v[26:27]
    v_pk_add_f32 v[10:11], v[10:11], v[46:47]
    s_add_u32 s100, s97, 122880
    buffer_load_dwordx4 a[120:123], v6, s[16:19], s100 offen offset:0 sc1
    v_pk_add_f32 v[8:9], v[8:9], v[28:29]
    v_pk_add_f32 v[10:11], v[10:11], v[48:49]
    v_pk_add_f32 v[8:9], v[8:9], v[30:31]
    v_pk_add_f32 v[10:11], v[10:11], v[50:51]
    v_pk_add_f32 v[8:9], v[8:9], v[32:33]
    v_pk_add_f32 v[10:11], v[10:11], v[52:53]
    v_pk_add_f32 v[8:9], v[8:9], v[34:35]
    v_pk_add_f32 v[10:11], v[10:11], v[54:55]
    v_add_f32 v8, v8, v9
    v_add_f32 v10, v10, v11
    v_rcp_f32 v8, v8
    v_rcp_f32 v10, v10
    buffer_load_dwordx4 a[124:127], v6, s[16:19], s100 offen offset:1024 sc1
    v_pk_mul_f32 v[16:17], v[16:17], v[8:9] op_sel_hi:[1,0]
    v_pk_mul_f32 v[18:19], v[18:19], v[8:9] op_sel_hi:[1,0]
    v_pk_mul_f32 v[20:21], v[20:21], v[8:9] op_sel_hi:[1,0]
    v_pk_mul_f32 v[22:23], v[22:23], v[8:9] op_sel_hi:[1,0]
    v_pk_mul_f32 v[24:25], v[24:25], v[8:9] op_sel_hi:[1,0]
    v_pk_mul_f32 v[26:27], v[26:27], v[8:9] op_sel_hi:[1,0]
    v_pk_mul_f32 v[28:29], v[28:29], v[8:9] op_sel_hi:[1,0]
    v_pk_mul_f32 v[30:31], v[30:31], v[8:9] op_sel_hi:[1,0]
    v_pk_mul_f32 v[32:33], v[32:33], v[8:9] op_sel_hi:[1,0]
    v_pk_mul_f32 v[34:35], v[34:35], v[8:9] op_sel_hi:[1,0]
    v_pk_mul_f32 v[36:37], v[36:37], v[10:11] op_sel_hi:[1,0]
    v_pk_mul_f32 v[38:39], v[38:39], v[10:11] op_sel_hi:[1,0]
    v_pk_mul_f32 v[40:41], v[40:41], v[10:11] op_sel_hi:[1,0]
    v_pk_mul_f32 v[42:43], v[42:43], v[10:11] op_sel_hi:[1,0]
    v_pk_mul_f32 v[44:45], v[44:45], v[10:11] op_sel_hi:[1,0]
    buffer_load_dwordx4 a[128:131], v6, s[16:19], s100 offen offset:2048 sc1
    v_pk_mul_f32 v[46:47], v[46:47], v[10:11] op_sel_hi:[1,0]
    v_pk_mul_f32 v[48:49], v[48:49], v[10:11] op_sel_hi:[1,0]
    v_pk_mul_f32 v[50:51], v[50:51], v[10:11] op_sel_hi:[1,0]
    v_pk_mul_f32 v[52:53], v[52:53], v[10:11] op_sel_hi:[1,0]
    v_pk_mul_f32 v[54:55], v[54:55], v[10:11] op_sel_hi:[1,0]
    v_cvt_pk_bf16_f32 v136, v16, v17
    v_cvt_pk_bf16_f32 v137, v18, v19
    v_cvt_pk_bf16_f32 v138, v20, v21
    v_cvt_pk_bf16_f32 v139, v22, v23
    v_cvt_pk_bf16_f32 v140, v24, v25
    v_cvt_pk_bf16_f32 v141, v26, v27
    v_cvt_pk_bf16_f32 v142, v28, v29
    v_cvt_pk_bf16_f32 v143, v30, v31
    v_cvt_pk_bf16_f32 v144, v32, v33
    v_cvt_pk_bf16_f32 v145, v34, v35
    buffer_load_dwordx4 a[132:135], v6, s[16:19], s100 offen offset:3072 sc1
    v_cvt_pk_bf16_f32 v146, v36, v37
    v_cvt_pk_bf16_f32 v147, v38, v39
    v_cvt_pk_bf16_f32 v148, v40, v41
    v_cvt_pk_bf16_f32 v149, v42, v43
    v_cvt_pk_bf16_f32 v150, v44, v45
    v_cvt_pk_bf16_f32 v151, v46, v47
    v_cvt_pk_bf16_f32 v152, v48, v49
    v_cvt_pk_bf16_f32 v153, v50, v51
    v_cvt_pk_bf16_f32 v154, v52, v53
    v_cvt_pk_bf16_f32 v155, v54, v55
    v_max3_f32 v8, v188, v189, v190
    v_min3_f32 v10, v188, v189, v190
    v_max3_f32 v8, v8, v191, v192
    v_min3_f32 v10, v10, v191, v192
    v_max3_f32 v8, v8, v193, v194
    buffer_load_dwordx4 a[136:139], v240, s[16:19], s100 offen offset:0 sc1
    v_min3_f32 v10, v10, v193, v194
    v_max3_f32 v8, v8, v195, v196
    v_min3_f32 v10, v10, v195, v196
    ds_write_b128 v221, v[136:139] offset:0
    v_max3_f32 v8, v8, v197, v198
    v_min3_f32 v10, v10, v197, v198
    v_max3_f32 v8, v8, v199, v200
    v_min3_f32 v10, v10, v199, v200
    v_max3_f32 v8, v8, v201, v202
    v_min3_f32 v10, v10, v201, v202
    v_max3_f32 v8, v8, v203, v204
    v_min3_f32 v10, v10, v203, v204
    ds_write_b128 v221, v[140:143] offset:16
    v_max3_f32 v8, v8, v205, v206
    v_min3_f32 v10, v10, v205, v206
    s_add_u32 s100, s97, 143360
    buffer_load_dwordx4 a[140:143], v6, s[16:19], s100 offen offset:0 sc1
    v_max_f32 v8, v8, v207
    v_min_f32 v10, v10, v207
    v_mul_f32_e64 v8, -v8, s98
    v_mul_f32 v10, s98, v10
    v_pk_fma_f32 v[16:17], v[188:189], s[98:99], v[8:9] op_sel_hi:[1,0,0]
    v_pk_fma_f32 v[36:37], v[188:189], s[98:99], v[10:11] op_sel_hi:[1,0,0] neg_lo:[1,0,0] neg_hi:[1,0,0]
    ds_write_b128 v221, v[144:147] offset:32
    v_pk_fma_f32 v[18:19], v[190:191], s[98:99], v[8:9] op_sel_hi:[1,0,0]
    v_pk_fma_f32 v[38:39], v[190:191], s[98:99], v[10:11] op_sel_hi:[1,0,0] neg_lo:[1,0,0] neg_hi:[1,0,0]
    v_pk_fma_f32 v[20:21], v[192:193], s[98:99], v[8:9] op_sel_hi:[1,0,0]
    v_pk_fma_f32 v[40:41], v[192:193], s[98:99], v[10:11] op_sel_hi:[1,0,0] neg_lo:[1,0,0] neg_hi:[1,0,0]
    v_pk_fma_f32 v[22:23], v[194:195], s[98:99], v[8:9] op_sel_hi:[1,0,0]
    v_pk_fma_f32 v[42:43], v[194:195], s[98:99], v[10:11] op_sel_hi:[1,0,0] neg_lo:[1,0,0] neg_hi:[1,0,0]
    v_pk_fma_f32 v[24:25], v[196:197], s[98:99], v[8:9] op_sel_hi:[1,0,0]
    buffer_load_dwordx4 a[144:147], v6, s[16:19], s100 offen offset:1024 sc1
    v_pk_fma_f32 v[44:45], v[196:197], s[98:99], v[10:11] op_sel_hi:[1,0,0] neg_lo:[1,0,0] neg_hi:[1,0,0]
    ds_write_b128 v221, v[148:151] offset:48
    v_pk_fma_f32 v[26:27], v[198:199], s[98:99], v[8:9] op_sel_hi:[1,0,0]
    v_pk_fma_f32 v[46:47], v[198:199], s[98:99], v[10:11] op_sel_hi:[1,0,0] neg_lo:[1,0,0] neg_hi:[1,0,0]
    v_pk_fma_f32 v[28:29], v[200:201], s[98:99], v[8:9] op_sel_hi:[1,0,0]
    v_pk_fma_f32 v[48:49], v[200:201], s[98:99], v[10:11] op_sel_hi:[1,0,0] neg_lo:[1,0,0] neg_hi:[1,0,0]
    v_pk_fma_f32 v[30:31], v[202:203], s[98:99], v[8:9] op_sel_hi:[1,0,0]
    v_pk_fma_f32 v[50:51], v[202:203], s[98:99], v[10:11] op_sel_hi:[1,0,0] neg_lo:[1,0,0] neg_hi:[1,0,0]
    v_pk_fma_f32 v[32:33], v[204:205], s[98:99], v[8:9] op_sel_hi:[1,0,0]
    v_pk_fma_f32 v[52:53], v[204:205], s[98:99], v[10:11] op_sel_hi:[1,0,0] neg_lo:[1,0,0] neg_hi:[1,0,0]
    ds_write_b128 v221, v[152:155] offset:64
    v_pk_fma_f32 v[34:35], v[206:207], s[98:99], v[8:9] op_sel_hi:[1,0,0]
    v_pk_fma_f32 v[54:55], v[206:207], s[98:99], v[10:11] op_sel_hi:[1,0,0] neg_lo:[1,0,0] neg_hi:[1,0,0]
    v_exp_f32 v16, v16
    s_add_u32 s100, s97, 194560
    buffer_load_dwordx4 a[204:207], v6, s[16:19], s100 offen offset:1024 sc1
    v_exp_f32 v17, v17
    v_exp_f32 v18, v18
    v_exp_f32 v19, v19
    v_exp_f32 v20, v20
    v_exp_f32 v21, v21
    v_exp_f32 v22, v22
    v_exp_f32 v23, v23
    buffer_load_dwordx4 a[208:211], v6, s[16:19], s100 offen offset:2048 sc1
    v_exp_f32 v24, v24
    v_exp_f32 v25, v25
    v_exp_f32 v26, v26
    v_exp_f32 v27, v27
    v_exp_f32 v28, v28
    v_exp_f32 v29, v29
    v_exp_f32 v30, v30
    v_exp_f32 v31, v31
    buffer_load_dwordx4 a[212:215], v6, s[16:19], s100 offen offset:3072 sc1
    v_exp_f32 v32, v32
    v_exp_f32 v33, v33
    v_exp_f32 v34, v34
    v_exp_f32 v35, v35
    v_exp_f32 v36, v36
    v_exp_f32 v37, v37
    v_exp_f32 v38, v38
    buffer_load_dwordx4 a[216:219], v240, s[16:19], s100 offen offset:0 sc1
    v_exp_f32 v39, v39
    v_exp_f32 v40, v40
    v_exp_f32 v41, v41
    v_exp_f32 v42, v42
    v_exp_f32 v43, v43
    v_exp_f32 v44, v44
    v_exp_f32 v45, v45
    v_exp_f32 v46, v46
    s_add_u32 s100, s97, 215040
    buffer_load_dwordx4 a[220:223], v6, s[16:19], s100 offen offset:0 sc1
    v_exp_f32 v47, v47
    v_exp_f32 v48, v48
    v_exp_f32 v49, v49
    v_exp_f32 v50, v50
    v_exp_f32 v51, v51
    v_exp_f32 v52, v52
    v_exp_f32 v53, v53
    buffer_load_dwordx4 a[224:227], v6, s[16:19], s100 offen offset:1024 sc1
    v_exp_f32 v54, v54
    v_exp_f32 v55, v55
    v_pk_add_f32 v[8:9], v[16:17], v[18:19]
    v_pk_add_f32 v[10:11], v[36:37], v[38:39]
    v_pk_add_f32 v[8:9], v[8:9], v[20:21]
    v_pk_add_f32 v[10:11], v[10:11], v[40:41]
    v_pk_add_f32 v[8:9], v[8:9], v[22:23]
    v_pk_add_f32 v[10:11], v[10:11], v[42:43]
    v_pk_add_f32 v[8:9], v[8:9], v[24:25]
    v_pk_add_f32 v[10:11], v[10:11], v[44:45]
    v_pk_add_f32 v[8:9], v[8:9], v[26:27]
    v_pk_add_f32 v[10:11], v[10:11], v[46:47]
    buffer_load_dwordx4 a[228:231], v6, s[16:19], s100 offen offset:2048 sc1
    v_pk_add_f32 v[8:9], v[8:9], v[28:29]
    v_pk_add_f32 v[10:11], v[10:11], v[48:49]
    v_pk_add_f32 v[8:9], v[8:9], v[30:31]
    v_pk_add_f32 v[10:11], v[10:11], v[50:51]
    v_pk_add_f32 v[8:9], v[8:9], v[32:33]
    v_pk_add_f32 v[10:11], v[10:11], v[52:53]
    v_pk_add_f32 v[8:9], v[8:9], v[34:35]
    v_pk_add_f32 v[10:11], v[10:11], v[54:55]
    v_add_f32 v8, v8, v9
    v_add_f32 v10, v10, v11
    v_rcp_f32 v8, v8
    v_rcp_f32 v10, v10
    v_pk_mul_f32 v[16:17], v[16:17], v[8:9] op_sel_hi:[1,0]
    buffer_load_dwordx4 a[232:235], v6, s[16:19], s100 offen offset:3072 sc1
    v_pk_mul_f32 v[18:19], v[18:19], v[8:9] op_sel_hi:[1,0]
    v_pk_mul_f32 v[20:21], v[20:21], v[8:9] op_sel_hi:[1,0]
    v_pk_mul_f32 v[22:23], v[22:23], v[8:9] op_sel_hi:[1,0]
    v_pk_mul_f32 v[24:25], v[24:25], v[8:9] op_sel_hi:[1,0]
    v_pk_mul_f32 v[26:27], v[26:27], v[8:9] op_sel_hi:[1,0]
    v_pk_mul_f32 v[28:29], v[28:29], v[8:9] op_sel_hi:[1,0]
    v_pk_mul_f32 v[30:31], v[30:31], v[8:9] op_sel_hi:[1,0]
    v_pk_mul_f32 v[32:33], v[32:33], v[8:9] op_sel_hi:[1,0]
    v_pk_mul_f32 v[34:35], v[34:35], v[8:9] op_sel_hi:[1,0]
    v_pk_mul_f32 v[36:37], v[36:37], v[10:11] op_sel_hi:[1,0]
    v_pk_mul_f32 v[38:39], v[38:39], v[10:11] op_sel_hi:[1,0]
    v_pk_mul_f32 v[40:41], v[40:41], v[10:11] op_sel_hi:[1,0]
    v_pk_mul_f32 v[42:43], v[42:43], v[10:11] op_sel_hi:[1,0]
    v_pk_mul_f32 v[44:45], v[44:45], v[10:11] op_sel_hi:[1,0]
    v_pk_mul_f32 v[46:47], v[46:47], v[10:11] op_sel_hi:[1,0]
    buffer_load_dwordx4 a[236:239], v240, s[16:19], s100 offen offset:0 sc1
    v_pk_mul_f32 v[48:49], v[48:49], v[10:11] op_sel_hi:[1,0]
    v_pk_mul_f32 v[50:51], v[50:51], v[10:11] op_sel_hi:[1,0]
    v_pk_mul_f32 v[52:53], v[52:53], v[10:11] op_sel_hi:[1,0]
    v_pk_mul_f32 v[54:55], v[54:55], v[10:11] op_sel_hi:[1,0]
    v_cvt_pk_bf16_f32 v56, v16, v17
    v_cvt_pk_bf16_f32 v57, v18, v19
    v_cvt_pk_bf16_f32 v58, v20, v21
    v_cvt_pk_bf16_f32 v59, v22, v23
    ds_write_b128 v221, v[56:59] offset:5632
    v_cvt_pk_bf16_f32 v60, v24, v25
    v_cvt_pk_bf16_f32 v61, v26, v27
    v_cvt_pk_bf16_f32 v62, v28, v29
    v_cvt_pk_bf16_f32 v63, v30, v31
    ds_write_b128 v221, v[60:63] offset:5648
    v_cvt_pk_bf16_f32 v64, v32, v33
    v_cvt_pk_bf16_f32 v65, v34, v35
    v_cvt_pk_bf16_f32 v66, v36, v37
    v_cvt_pk_bf16_f32 v67, v38, v39
    ds_write_b128 v221, v[64:67] offset:5664
    v_cvt_pk_bf16_f32 v68, v40, v41
    v_cvt_pk_bf16_f32 v69, v42, v43
    v_cvt_pk_bf16_f32 v70, v44, v45
    v_cvt_pk_bf16_f32 v71, v46, v47
    ds_write_b128 v221, v[68:71] offset:5680
    v_cvt_pk_bf16_f32 v72, v48, v49
    v_cvt_pk_bf16_f32 v73, v50, v51
    v_cvt_pk_bf16_f32 v74, v52, v53
    v_cvt_pk_bf16_f32 v75, v54, v55
    ds_write_b128 v221, v[72:75] offset:5696
    s_waitcnt lgkmcnt(0)
    s_barrier
    ds_read_b64_tr_b16 v[28:29], v223 offset:0
    ds_read_b64_tr_b16 v[30:31], v223 offset:3584
    ds_read_b64_tr_b16 v[16:17], v222 offset:0
    ds_read_b64_tr_b16 v[18:19], v222 offset:5632
    ds_read_b64_tr_b16 v[32:33], v223 offset:32
    ds_read_b64_tr_b16 v[34:35], v223 offset:3616
    ds_read_b64_tr_b16 v[20:21], v222 offset:32
    ds_read_b64_tr_b16 v[22:23], v222 offset:5664
    ds_read_b64_tr_b16 v[24:25], v222 offset:64
    ds_read_b64_tr_b16 v[26:27], v222 offset:5696
    ds_read_b64_tr_b16 v[48:49], v223 offset:7168
    ds_read_b64_tr_b16 v[50:51], v223 offset:10752
    ds_read_b64_tr_b16 v[36:37], v222 offset:11264
    ds_read_b64_tr_b16 v[38:39], v222 offset:16896
    s_waitcnt lgkmcnt(10)
    v_mfma_f32_16x16x32_bf16 v[168:171], v[16:19], v[28:31], 0
    s_add_u32 s100, s97, 235520
    buffer_load_dwordx4 a[240:243], v6, s[16:19], s100 offen offset:0 sc1
    ds_read_b64_tr_b16 v[52:53], v223 offset:7200
    ds_read_b64_tr_b16 v[54:55], v223 offset:10784
    ds_read_b64_tr_b16 v[40:41], v222 offset:11296
    ds_read_b64_tr_b16 v[42:43], v222 offset:16928
    s_waitcnt lgkmcnt(12)
    v_mfma_f32_16x16x32_bf16 v[172:175], v[16:19], v[32:35], 0
    ds_read_b64_tr_b16 v[44:45], v222 offset:11328
    ds_read_b64_tr_b16 v[46:47], v222 offset:16960
    s_waitcnt lgkmcnt(12)
    v_mfma_f32_16x16x32_bf16 v[176:179], v[20:23], v[28:31], 0
    v_mfma_f32_16x16x32_bf16 v[180:183], v[20:23], v[32:35], 0
    buffer_load_dwordx4 a[244:247], v6, s[16:19], s100 offen offset:1024 sc1
    ds_read_b64_tr_b16 v[68:69], v223 offset:14336
    ds_read_b64_tr_b16 v[70:71], v223 offset:17920
    s_waitcnt lgkmcnt(12)
    v_mfma_f32_16x16x32_bf16 v[184:187], v[24:27], v[28:31], 0
    ds_read_b64_tr_b16 v[56:57], v222 offset:22528
    ds_read_b64_tr_b16 v[58:59], v222 offset:28160
    v_mfma_f32_16x16x32_bf16 v[188:191], v[24:27], v[32:35], 0
    s_waitcnt lgkmcnt(10)
    v_mfma_f32_16x16x32_bf16 v[168:171], v[36:39], v[48:51], v[168:171]
    ds_read_b64_tr_b16 v[72:73], v223 offset:14368
    ds_read_b64_tr_b16 v[74:75], v223 offset:17952
    ds_read_b64_tr_b16 v[60:61], v222 offset:22560
    ds_read_b64_tr_b16 v[62:63], v222 offset:28192
    s_waitcnt lgkmcnt(12)
    v_mfma_f32_16x16x32_bf16 v[172:175], v[36:39], v[52:55], v[172:175]
    buffer_load_dwordx4 a[248:251], v6, s[16:19], s100 offen offset:2048 sc1
    ds_read_b64_tr_b16 v[64:65], v222 offset:22592
    ds_read_b64_tr_b16 v[66:67], v222 offset:28224
    s_waitcnt lgkmcnt(12)
    v_mfma_f32_16x16x32_bf16 v[176:179], v[40:43], v[48:51], v[176:179]
    v_mfma_f32_16x16x32_bf16 v[180:183], v[40:43], v[52:55], v[180:183]
    ds_read_b64_tr_b16 v[88:89], v223 offset:21504
    ds_read_b64_tr_b16 v[90:91], v223 offset:25088
    s_waitcnt lgkmcnt(12)
    v_mfma_f32_16x16x32_bf16 v[184:187], v[44:47], v[48:51], v[184:187]
    ds_read_b64_tr_b16 v[76:77], v222 offset:33792
    ds_read_b64_tr_b16 v[78:79], v222 offset:39424
    v_mfma_f32_16x16x32_bf16 v[188:191], v[44:47], v[52:55], v[188:191]
    buffer_load_dwordx4 a[252:255], v6, s[16:19], s100 offen offset:3072 sc1
    s_waitcnt lgkmcnt(10)
    v_mfma_f32_16x16x32_bf16 v[168:171], v[56:59], v[68:71], v[168:171]
    ds_read_b64_tr_b16 v[92:93], v223 offset:21536
    ds_read_b64_tr_b16 v[94:95], v223 offset:25120
    ds_read_b64_tr_b16 v[80:81], v222 offset:33824
    ds_read_b64_tr_b16 v[82:83], v222 offset:39456
    s_waitcnt lgkmcnt(12)
    v_mfma_f32_16x16x32_bf16 v[172:175], v[56:59], v[72:75], v[172:175]
    ds_read_b64_tr_b16 v[84:85], v222 offset:33856
    ds_read_b64_tr_b16 v[86:87], v222 offset:39488
    s_waitcnt lgkmcnt(12)
    v_mfma_f32_16x16x32_bf16 v[176:179], v[60:63], v[68:71], v[176:179]
    v_mfma_f32_16x16x32_bf16 v[180:183], v[60:63], v[72:75], v[180:183]
    s_add_u32 m0, s88, 73728
    s_nop 0
    buffer_load_dwordx4 v240, s[16:19], s100 offen offset:0 sc1 lds
    s_waitcnt lgkmcnt(10)
    v_mfma_f32_16x16x32_bf16 v[184:187], v[64:67], v[68:71], v[184:187]
    v_mfma_f32_16x16x32_bf16 v[188:191], v[64:67], v[72:75], v[188:191]
    s_waitcnt lgkmcnt(6)
    v_mfma_f32_16x16x32_bf16 v[168:171], v[76:79], v[88:91], v[168:171]
    s_waitcnt lgkmcnt(4)
    v_mfma_f32_16x16x32_bf16 v[172:175], v[76:79], v[92:95], v[172:175]
    s_waitcnt lgkmcnt(2)
    v_mfma_f32_16x16x32_bf16 v[176:179], v[80:83], v[88:91], v[176:179]
    s_add_u32 s100, s97, 256000
    s_add_u32 m0, s88, 74752
    s_nop 0
    buffer_load_dwordx4 v6, s[16:19], s100 offen offset:0 sc1 lds
    v_mfma_f32_16x16x32_bf16 v[180:183], v[80:83], v[92:95], v[180:183]
    s_waitcnt lgkmcnt(0)
    v_mfma_f32_16x16x32_bf16 v[184:187], v[84:87], v[88:91], v[184:187]
    v_mfma_f32_16x16x32_bf16 v[188:191], v[84:87], v[92:95], v[188:191]
    s_nop 4
    v_bfi_b32 v168, s42, v246, v168
    v_bfi_b32 v169, s42, v246, v169
    v_bfi_b32 v170, s42, v246, v170
    v_bfi_b32 v171, s42, v246, v171
    buffer_store_dwordx4 v[168:171], v241, s[16:19], s75 offen offset:0 sc1
    v_bfi_b32 v172, s42, v246, v172
    v_bfi_b32 v173, s42, v246, v173
    v_bfi_b32 v174, s42, v246, v174
    v_bfi_b32 v175, s42, v246, v175
    buffer_store_dwordx4 v[172:175], v243, s[16:19], s75 offen offset:0 sc1
    v_bfi_b32 v176, s42, v246, v176
    v_bfi_b32 v177, s42, v246, v177
    v_bfi_b32 v178, s42, v246, v178
    v_bfi_b32 v179, s42, v246, v179
    buffer_store_dwordx4 v[176:179], v241, s[16:19], s75 offen offset:1024 sc1
    v_bfi_b32 v180, s42, v246, v180
    v_bfi_b32 v181, s42, v246, v181
    v_bfi_b32 v182, s42, v246, v182
    v_bfi_b32 v183, s42, v246, v183
    buffer_store_dwordx4 v[180:183], v243, s[16:19], s75 offen offset:1024 sc1
    v_bfi_b32 v184, s42, v246, v184
    v_bfi_b32 v185, s42, v246, v185
    v_bfi_b32 v186, s42, v246, v186
    v_bfi_b32 v187, s42, v246, v187
    buffer_store_dwordx4 v[184:187], v242, s[16:19], s75 offen offset:2048 sc1
    v_bfi_b32 v188, s42, v246, v188
    v_bfi_b32 v189, s42, v246, v189
    v_bfi_b32 v190, s42, v246, v190
    v_bfi_b32 v191, s42, v246, v191
    buffer_store_dwordx4 v[188:191], v244, s[16:19], s75 offen offset:2048 sc1
    v_mfma_f32_16x16x32_bf16 v[96:99], a[164:167], a[148:151], v[96:99]
    s_lshl_b32 s76, s60, 2
    v_mfma_f32_16x16x32_bf16 v[96:99], a[168:171], a[152:155], v[96:99]
    s_add_u32 s76, s76, s3
    v_mfma_f32_16x16x32_bf16 v[100:103], a[164:167], a[156:159], v[100:103]
    s_lshl_b32 s78, s60, 1
    v_mfma_f32_16x16x32_bf16 v[100:103], a[168:171], a[160:163], v[100:103]
    s_lshr_b32 s79, s3, 1
    v_mfma_f32_16x16x32_bf16 v[104:107], a[172:175], a[148:151], v[104:107]
    s_add_u32 s78, s78, s79
    v_mfma_f32_16x16x32_bf16 v[104:107], a[176:179], a[152:155], v[104:107]
    s_and_b32 s79, s3, 1
    v_mfma_f32_16x16x32_bf16 v[108:111], a[172:175], a[156:159], v[108:111]
    s_mul_i32 s74, s78, 74
    v_mfma_f32_16x16x32_bf16 v[108:111], a[176:179], a[160:163], v[108:111]
    s_lshl_b32 s89, s61, 1
    v_mfma_f32_16x16x32_bf16 v[112:115], a[180:183], a[148:151], v[112:115]
    s_add_u32 s74, s74, s89
    v_mfma_f32_16x16x32_bf16 v[112:115], a[184:187], a[152:155], v[112:115]
    s_add_u32 s74, s74, 38
    v_mfma_f32_16x16x32_bf16 v[116:119], a[180:183], a[156:159], v[116:119]
    s_lshl_b32 s74, s74, 12
    v_mfma_f32_16x16x32_bf16 v[116:119], a[184:187], a[160:163], v[116:119]
    s_lshl_b32 s79, s79, 11
    v_mfma_f32_16x16x32_bf16 v[120:123], a[188:191], a[148:151], v[120:123]
    s_add_u32 s74, s74, s79
    s_add_u32 m0, s88, 74752
    s_nop 0
    buffer_load_dwordx4 v6, s[16:19], s100 offen offset:1024 sc1 lds
    v_mfma_f32_16x16x32_bf16 v[120:123], a[192:195], a[152:155], v[120:123]
    s_add_u32 s74, s74, 6291456
    v_mfma_f32_16x16x32_bf16 v[124:127], a[188:191], a[156:159], v[124:127]
    s_lshl_b32 s89, s60, 4
    v_mfma_f32_16x16x32_bf16 v[124:127], a[192:195], a[160:163], v[124:127]
    s_add_u32 s89, s89, s61
    v_mfma_f32_16x16x32_bf16 v[128:131], a[196:199], a[148:151], v[128:131]
    s_lshl_b32 s89, s89, 7
    v_mfma_f32_16x16x32_bf16 v[128:131], a[200:203], a[152:155], v[128:131]
    s_add_u32 s89, s89, 41984
    s_add_u32 m0, s88, 74752
    s_nop 0
    buffer_load_dwordx4 v6, s[16:19], s100 offen offset:2048 sc1 lds
    v_mfma_f32_16x16x32_bf16 v[132:135], a[196:199], a[156:159], v[132:135]
    s_mul_i32 s32, s76, 240
    v_mfma_f32_16x16x32_bf16 v[132:135], a[200:203], a[160:163], v[132:135]
    s_mul_i32 s78, s61, 15360
    s_add_u32 s75, s32, s78
    s_add_u32 s75, s75, 2359296
    s_lshl_b32 s78, s78, 4
    s_add_u32 s32, s32, s78
    s_add_u32 s32, s32, 262144
    s_add_u32 s33, s32, 61440
    s_add_u32 s34, s33, 61440
    s_add_u32 s35, s34, 61440
    s_cmp_eq_u32 s3, 0
    s_cselect_b32 s89, s89, 2146435072
    v_mul_f32 v128, 0xbfb8aa3b, v128
    v_mul_f32 v132, 0xbfb8aa3b, v132
    v_exp_f32 v128, v128
    v_exp_f32 v132, v132
    s_lshl_b32 s76, s60, 2
    v_add_f32 v128, 1.0, v128
    v_add_f32 v132, 1.0, v132
    v_rcp_f32 v128, v128
    v_rcp_f32 v132, v132
    s_add_u32 s76, s76, s3
    s_lshl_b32 s77, s76, 9
    s_lshl_b32 s78, s61, 15
    s_add_u32 s77, s77, s78
    s_add_u32 s77, s77, 2621440
    v_bfi_b32 v131, s42, v246, v128
    v_bfi_b32 v130, s42, v246, v128
    v_bfi_b32 v129, s42, v246, v128
    v_bfi_b32 v128, s42, v246, v128
    buffer_store_dwordx4 v[128:131], v234, s[16:19], s77 offen offset:0 sc1
    v_bfi_b32 v135, s42, v246, v132
    v_bfi_b32 v134, s42, v246, v132
    v_bfi_b32 v133, s42, v246, v132
    v_bfi_b32 v132, s42, v246, v132
    buffer_store_dwordx4 v[132:135], v234, s[16:19], s77 offen offset:256 sc1
    s_mov_b32 s98, 0xc0135761
    v_mov_b32 v14, 0xbdd2d3e8
    v_pk_mul_f32 v[136:137], v[96:97], v[96:97]
    v_pk_mul_f32 v[138:139], v[98:99], v[98:99]
    v_pk_mul_f32 v[140:141], v[104:105], v[104:105]
    v_pk_mul_f32 v[142:143], v[106:107], v[106:107]
    v_pk_fma_f32 v[136:137], v[136:137], v[14:15], s[98:99] op_sel_hi:[1,0,0]
    v_pk_fma_f32 v[138:139], v[138:139], v[14:15], s[98:99] op_sel_hi:[1,0,0]
    v_pk_fma_f32 v[140:141], v[140:141], v[14:15], s[98:99] op_sel_hi:[1,0,0]
    v_pk_fma_f32 v[142:143], v[142:143], v[14:15], s[98:99] op_sel_hi:[1,0,0]
    v_pk_mul_f32 v[136:137], v[136:137], v[96:97]
    v_pk_mul_f32 v[138:139], v[138:139], v[98:99]
    v_pk_mul_f32 v[140:141], v[140:141], v[104:105]
    v_pk_mul_f32 v[142:143], v[142:143], v[106:107]
    v_exp_f32 v136, v136
    v_exp_f32 v137, v137
    v_exp_f32 v138, v138
    v_exp_f32 v139, v139
    v_exp_f32 v140, v140
    s_add_u32 s100, s97, 143360
    buffer_load_dwordx4 a[148:151], v6, s[16:19], s100 offen offset:2048 sc1
    v_exp_f32 v141, v141
    v_exp_f32 v142, v142
    v_exp_f32 v143, v143
    v_pk_add_f32 v[136:137], v[136:137], 1.0 op_sel_hi:[1,0]
    v_pk_add_f32 v[138:139], v[138:139], 1.0 op_sel_hi:[1,0]
    v_pk_add_f32 v[140:141], v[140:141], 1.0 op_sel_hi:[1,0]
    v_pk_add_f32 v[142:143], v[142:143], 1.0 op_sel_hi:[1,0]
    v_rcp_f32 v136, v136
    v_rcp_f32 v137, v137
    buffer_load_dwordx4 a[152:155], v6, s[16:19], s100 offen offset:3072 sc1
    v_rcp_f32 v138, v138
    v_rcp_f32 v139, v139
    v_rcp_f32 v140, v140
    v_rcp_f32 v141, v141
    v_rcp_f32 v142, v142
    v_rcp_f32 v143, v143
    v_pk_mul_f32 v[136:137], v[136:137], v[96:97]
    v_pk_mul_f32 v[138:139], v[138:139], v[98:99]
    buffer_load_dwordx4 a[156:159], v240, s[16:19], s100 offen offset:0 sc1
    v_pk_mul_f32 v[140:141], v[140:141], v[104:105]
    v_pk_mul_f32 v[142:143], v[142:143], v[106:107]
    v_cvt_pk_bf16_f32 v152, v136, v137
    v_cvt_pk_bf16_f32 v153, v138, v139
    v_cvt_pk_bf16_f32 v154, v140, v141
    v_cvt_pk_bf16_f32 v155, v142, v143
    v_pk_mul_f32 v[144:145], v[100:101], v[100:101]
    v_pk_mul_f32 v[146:147], v[102:103], v[102:103]
    v_pk_mul_f32 v[148:149], v[108:109], v[108:109]
    v_pk_mul_f32 v[150:151], v[110:111], v[110:111]
    v_pk_fma_f32 v[144:145], v[144:145], v[14:15], s[98:99] op_sel_hi:[1,0,0]
    v_pk_fma_f32 v[146:147], v[146:147], v[14:15], s[98:99] op_sel_hi:[1,0,0]
    v_pk_fma_f32 v[148:149], v[148:149], v[14:15], s[98:99] op_sel_hi:[1,0,0]
    v_pk_fma_f32 v[150:151], v[150:151], v[14:15], s[98:99] op_sel_hi:[1,0,0]
    v_pk_mul_f32 v[144:145], v[144:145], v[100:101]
    s_add_u32 s100, s97, 163840
    buffer_load_dwordx4 a[160:163], v6, s[16:19], s100 offen offset:0 sc1
    v_pk_mul_f32 v[146:147], v[146:147], v[102:103]
    v_pk_mul_f32 v[148:149], v[148:149], v[108:109]
    v_pk_mul_f32 v[150:151], v[150:151], v[110:111]
    v_exp_f32 v144, v144
    v_exp_f32 v145, v145
    v_exp_f32 v146, v146
    v_exp_f32 v147, v147
    v_exp_f32 v148, v148
    v_exp_f32 v149, v149
    buffer_load_dwordx4 a[164:167], v6, s[16:19], s100 offen offset:1024 sc1
    v_exp_f32 v150, v150
    v_exp_f32 v151, v151
    v_pk_add_f32 v[144:145], v[144:145], 1.0 op_sel_hi:[1,0]
    v_pk_add_f32 v[146:147], v[146:147], 1.0 op_sel_hi:[1,0]
    v_pk_add_f32 v[148:149], v[148:149], 1.0 op_sel_hi:[1,0]
    v_pk_add_f32 v[150:151], v[150:151], 1.0 op_sel_hi:[1,0]
    v_rcp_f32 v144, v144
    v_rcp_f32 v145, v145
    v_rcp_f32 v146, v146
    buffer_load_dwordx4 a[168:171], v6, s[16:19], s100 offen offset:2048 sc1
    v_rcp_f32 v147, v147
    v_rcp_f32 v148, v148
    v_rcp_f32 v149, v149
    v_rcp_f32 v150, v150
    v_rcp_f32 v151, v151
    v_pk_mul_f32 v[144:145], v[144:145], v[100:101]
    v_pk_mul_f32 v[146:147], v[146:147], v[102:103]
    v_pk_mul_f32 v[148:149], v[148:149], v[108:109]
    v_pk_mul_f32 v[150:151], v[150:151], v[110:111]
    v_cvt_pk_bf16_f32 v156, v144, v145
    buffer_load_dwordx4 a[172:175], v6, s[16:19], s100 offen offset:3072 sc1
    v_cvt_pk_bf16_f32 v157, v146, v147
    v_cvt_pk_bf16_f32 v158, v148, v149
    v_cvt_pk_bf16_f32 v159, v150, v151
    v_pk_mul_f32 v[136:137], v[112:113], v[112:113]
    v_pk_mul_f32 v[138:139], v[114:115], v[114:115]
    v_pk_mul_f32 v[140:141], v[120:121], v[120:121]
    v_pk_mul_f32 v[142:143], v[122:123], v[122:123]
    v_pk_fma_f32 v[136:137], v[136:137], v[14:15], s[98:99] op_sel_hi:[1,0,0]
    v_pk_fma_f32 v[138:139], v[138:139], v[14:15], s[98:99] op_sel_hi:[1,0,0]
    v_pk_fma_f32 v[140:141], v[140:141], v[14:15], s[98:99] op_sel_hi:[1,0,0]
    v_pk_fma_f32 v[142:143], v[142:143], v[14:15], s[98:99] op_sel_hi:[1,0,0]
    v_pk_mul_f32 v[136:137], v[136:137], v[112:113]
    v_pk_mul_f32 v[138:139], v[138:139], v[114:115]
    v_pk_mul_f32 v[140:141], v[140:141], v[120:121]
    v_pk_mul_f32 v[142:143], v[142:143], v[122:123]
    buffer_load_dwordx4 a[176:179], v240, s[16:19], s100 offen offset:0 sc1
    v_exp_f32 v136, v136
    v_exp_f32 v137, v137
    v_exp_f32 v138, v138
    v_exp_f32 v139, v139
    v_exp_f32 v140, v140
    v_exp_f32 v141, v141
    v_exp_f32 v142, v142
    v_exp_f32 v143, v143
    s_mov_b32 s100, s86
    buffer_load_dwordx4 a[180:183], v6, s[16:19], s100 offen offset:0 sc1
    v_pk_add_f32 v[136:137], v[136:137], 1.0 op_sel_hi:[1,0]
    v_pk_add_f32 v[138:139], v[138:139], 1.0 op_sel_hi:[1,0]
    v_pk_add_f32 v[140:141], v[140:141], 1.0 op_sel_hi:[1,0]
    v_pk_add_f32 v[142:143], v[142:143], 1.0 op_sel_hi:[1,0]
    v_rcp_f32 v136, v136
    v_rcp_f32 v137, v137
    v_rcp_f32 v138, v138
    v_rcp_f32 v139, v139
    v_rcp_f32 v140, v140
    buffer_load_dwordx4 a[184:187], v6, s[16:19], s100 offen offset:1024 sc1
    v_rcp_f32 v141, v141
    v_rcp_f32 v142, v142
    v_rcp_f32 v143, v143
    v_pk_mul_f32 v[136:137], v[136:137], v[112:113]
    v_pk_mul_f32 v[138:139], v[138:139], v[114:115]
    v_pk_mul_f32 v[140:141], v[140:141], v[120:121]
    v_pk_mul_f32 v[142:143], v[142:143], v[122:123]
    v_cvt_pk_bf16_f32 v160, v136, v137
    v_cvt_pk_bf16_f32 v161, v138, v139
    v_cvt_pk_bf16_f32 v162, v140, v141
    v_cvt_pk_bf16_f32 v163, v142, v143
    buffer_load_dwordx4 a[188:191], v6, s[16:19], s100 offen offset:2048 sc1
    buffer_load_dwordx4 v[16:19], v12, s[16:19], s32 offen sc1
    buffer_load_dwordx4 v[20:23], v12, s[16:19], s33 offen sc1
    buffer_load_dwordx4 v[24:27], v12, s[16:19], s34 offen sc1
    buffer_load_dwordx4 v[28:31], v12, s[16:19], s35 offen sc1
    v_pk_mul_f32 v[144:145], v[116:117], v[116:117]
    v_pk_mul_f32 v[146:147], v[118:119], v[118:119]
    v_pk_mul_f32 v[148:149], v[124:125], v[124:125]
    v_pk_mul_f32 v[150:151], v[126:127], v[126:127]
    v_pk_fma_f32 v[144:145], v[144:145], v[14:15], s[98:99] op_sel_hi:[1,0,0]
    v_pk_fma_f32 v[146:147], v[146:147], v[14:15], s[98:99] op_sel_hi:[1,0,0]
    v_pk_fma_f32 v[148:149], v[148:149], v[14:15], s[98:99] op_sel_hi:[1,0,0]
    v_pk_fma_f32 v[150:151], v[150:151], v[14:15], s[98:99] op_sel_hi:[1,0,0]
    v_pk_mul_f32 v[144:145], v[144:145], v[116:117]
    v_pk_mul_f32 v[146:147], v[146:147], v[118:119]
    v_pk_mul_f32 v[148:149], v[148:149], v[124:125]
    v_pk_mul_f32 v[150:151], v[150:151], v[126:127]
    v_exp_f32 v144, v144
    v_exp_f32 v145, v145
    v_exp_f32 v146, v146
    v_exp_f32 v147, v147
    v_exp_f32 v148, v148
    v_exp_f32 v149, v149
    v_exp_f32 v150, v150
    v_exp_f32 v151, v151
    v_pk_add_f32 v[144:145], v[144:145], 1.0 op_sel_hi:[1,0]
    v_pk_add_f32 v[146:147], v[146:147], 1.0 op_sel_hi:[1,0]
    v_pk_add_f32 v[148:149], v[148:149], 1.0 op_sel_hi:[1,0]
    v_pk_add_f32 v[150:151], v[150:151], 1.0 op_sel_hi:[1,0]
    v_rcp_f32 v144, v144
    v_rcp_f32 v145, v145
    v_rcp_f32 v146, v146
    v_rcp_f32 v147, v147
    v_rcp_f32 v148, v148
    v_rcp_f32 v149, v149
    buffer_load_dwordx4 a[192:195], v6, s[16:19], s100 offen offset:3072 sc1
    v_rcp_f32 v150, v150
    v_rcp_f32 v151, v151
    v_pk_mul_f32 v[144:145], v[144:145], v[116:117]
    v_pk_mul_f32 v[146:147], v[146:147], v[118:119]
    v_pk_mul_f32 v[148:149], v[148:149], v[124:125]
    v_pk_mul_f32 v[150:151], v[150:151], v[126:127]
    v_cvt_pk_bf16_f32 v164, v144, v145
    v_cvt_pk_bf16_f32 v165, v146, v147
    v_cvt_pk_bf16_f32 v166, v148, v149
    v_cvt_pk_bf16_f32 v167, v150, v151
    buffer_store_dwordx4 v[152:155], v6, s[16:19], s74 offen offset:0 sc1
    buffer_store_dwordx4 v[156:159], v6, s[16:19], s74 offen offset:1024 sc1
    buffer_store_dwordx4 v[160:163], v240, s[16:19], s74 offen offset:0 sc1
    buffer_store_dwordx4 v[164:167], v240, s[16:19], s74 offen offset:1024 sc1
    buffer_load_dwordx4 a[196:199], v240, s[16:19], s100 offen offset:0 sc1
    s_add_u32 s100, s97, 194560
    buffer_load_dwordx4 a[200:203], v6, s[16:19], s100 offen offset:0 sc1
    s_add_u32 s100, s97, 256000
    s_add_u32 m0, s88, 74752
    s_nop 0
    buffer_load_dwordx4 v6, s[16:19], s100 offen offset:3072 sc1 lds
    s_add_u32 m0, s88, 78848
    s_nop 0
    buffer_load_dwordx4 v240, s[16:19], s100 offen offset:0 sc1 lds
    s_add_u32 s100, s97, 276480
    s_add_u32 m0, s88, 79872
    s_nop 0
    buffer_load_dwordx4 v6, s[16:19], s100 offen offset:0 sc1 lds
    s_add_u32 m0, s88, 79872
    s_nop 0
    buffer_load_dwordx4 v6, s[16:19], s100 offen offset:1024 sc1 lds
    s_waitcnt vmcnt(11)
    v_xor_b32 v9, s58, v16
    v_bitop3_b32 v9, v17, s58, v9 bitop3:0xbe
    v_bitop3_b32 v9, v18, s58, v9 bitop3:0xbe
    v_bitop3_b32 v9, v19, s58, v9 bitop3:0xbe
    v_bitop3_b32 v9, v20, s58, v9 bitop3:0xbe
    v_bitop3_b32 v9, v21, s58, v9 bitop3:0xbe
    v_bitop3_b32 v9, v22, s58, v9 bitop3:0xbe
    v_bitop3_b32 v9, v23, s58, v9 bitop3:0xbe
    v_bitop3_b32 v9, v24, s58, v9 bitop3:0xbe
    v_bitop3_b32 v9, v25, s58, v9 bitop3:0xbe
    v_bitop3_b32 v9, v26, s58, v9 bitop3:0xbe
    v_bitop3_b32 v9, v27, s58, v9 bitop3:0xbe
    v_bitop3_b32 v9, v28, s58, v9 bitop3:0xbe
    v_bitop3_b32 v9, v29, s58, v9 bitop3:0xbe
    v_bitop3_b32 v9, v30, s58, v9 bitop3:0xbe
    v_bitop3_b32 v9, v31, s58, v9 bitop3:0xbe
    v_and_b32 v9, 1023, v9
    v_cmp_ne_u32 vcc, 0, v9
    s_nop 3
    s_cbranch_vccnz L_slow_6
L_back_7:
    v_and_b32 v16, 0xfffffc00, v16
    v_and_b32 v17, 0xfffffc00, v17
    v_and_b32 v18, 0xfffffc00, v18
    v_and_b32 v19, 0xfffffc00, v19
    v_and_b32 v20, 0xfffffc00, v20
    v_and_b32 v21, 0xfffffc00, v21
    v_and_b32 v22, 0xfffffc00, v22
    v_and_b32 v23, 0xfffffc00, v23
    v_and_b32 v24, 0xfffffc00, v24
    v_and_b32 v25, 0xfffffc00, v25
    v_and_b32 v26, 0xfffffc00, v26
    v_and_b32 v27, 0xfffffc00, v27
    v_and_b32 v28, 0xfffffc00, v28
    v_and_b32 v29, 0xfffffc00, v29
    v_and_b32 v30, 0xfffffc00, v30
    v_and_b32 v31, 0xfffffc00, v31
    v_add_f32 v16, v16, v20
    v_add_f32 v17, v17, v21
    v_add_f32 v18, v18, v22
    v_add_f32 v19, v19, v23
    v_add_f32 v24, v24, v28
    v_add_f32 v25, v25, v29
    v_add_f32 v26, v26, v30
    v_add_f32 v27, v27, v31
    v_add_f32 v16, v16, v24
    v_add_f32 v17, v17, v25
    v_add_f32 v18, v18, v26
    v_add_f32 v19, v19, v27
    v_mov_b32 v20, v16
    v_mov_b32 v21, v17
    v_mov_b32 v22, v18
    v_mov_b32 v23, v19
    v_permlane32_swap_b32 v16, v20
    v_permlane32_swap_b32 v17, v21
    v_permlane32_swap_b32 v18, v22
    v_permlane32_swap_b32 v19, v23
    v_add_f32 v16, v16, v20
    v_add_f32 v17, v17, v21
    v_add_f32 v18, v18, v22
    v_add_f32 v19, v19, v23
    v_mov_b32 v20, v16
    v_mov_b32 v21, v17
    v_mov_b32 v22, v18
    v_mov_b32 v23, v19
    v_permlane16_swap_b32 v16, v20
    v_permlane16_swap_b32 v17, v21
    v_permlane16_swap_b32 v18, v22
    v_permlane16_swap_b32 v19, v23
    v_add_f32 v16, v16, v20
    v_add_f32 v17, v17, v21
    v_add_f32 v18, v18, v22
    v_add_f32 v19, v19, v23
    v_bfi_b32 v16, s42, v246, v16
    v_bfi_b32 v17, s42, v246, v17
    v_bfi_b32 v18, s42, v246, v18
    v_bfi_b32 v19, s42, v246, v19
    buffer_store_dwordx4 v[16:19], v13, s[16:19], s75 offen sc1
    s_waitcnt vmcnt(7)
    s_barrier
    buffer_store_dwordx2 v[246:247], v245, s[16:19], s89 offen sc1
    buffer_load_dwordx2 v[252:253], v235, s[16:19], s83 offen sc1
    s_add_u32 m0, s88, 79872
    s_nop 0
    buffer_load_dwordx4 v6, s[16:19], s100 offen offset:2048 sc1 lds
    s_add_u32 m0, s88, 79872
    s_nop 0
    buffer_load_dwordx4 v6, s[16:19], s100 offen offset:3072 sc1 lds
    s_add_u32 m0, s88, 83968
    s_nop 0
    buffer_load_dwordx4 v240, s[16:19], s100 offen offset:0 sc1 lds
    s_add_u32 s100, s97, 296960
    s_add_u32 m0, s88, 84992
    s_nop 0
    buffer_load_dwordx4 v6, s[16:19], s100 offen offset:0 sc1 lds
    s_add_u32 m0, s88, 84992
    s_nop 0
    buffer_load_dwordx4 v6, s[16:19], s100 offen offset:1024 sc1 lds
    s_add_u32 m0, s88, 84992
    s_nop 0
    buffer_load_dwordx4 v6, s[16:19], s100 offen offset:2048 sc1 lds
    s_add_u32 m0, s88, 84992
    s_nop 0
    buffer_load_dwordx4 v6, s[16:19], s100 offen offset:3072 sc1 lds
    s_add_u32 m0, s88, 89088
    s_nop 0
    buffer_load_dwordx4 v240, s[16:19], s100 offen offset:0 sc1 lds
    s_add_u32 s100, s97, 317440
    s_add_u32 m0, s88, 90112
    s_nop 0
    buffer_load_dwordx4 v6, s[16:19], s100 offen offset:0 sc1 lds
    s_add_u32 m0, s88, 90112
    s_nop 0
    buffer_load_dwordx4 v6, s[16:19], s100 offen offset:1024 sc1 lds
    s_waitcnt vmcnt(10)
    v_cmp_ne_u64 vcc, s[58:59], v[252:253]
    s_nop 3
    s_cbranch_vccnz L_slow_8
L_back_9:
    s_add_u32 s101, s96, 0
    buffer_load_dwordx4 v[168:171], v236, s[16:19], s101 offen sc1
    s_add_u32 s55, s96, 16384
    buffer_load_dwordx4 v[172:175], v236, s[16:19], s55 offen sc1
    buffer_load_dwordx4 v[176:179], v237, s[16:19], s101 offen sc1
    buffer_load_dwordx4 v[180:183], v237, s[16:19], s55 offen sc1
    buffer_load_dwordx4 v[184:187], v238, s[16:19], s101 offen sc1
    buffer_load_dwordx4 v[188:191], v238, s[16:19], s55 offen sc1
    v_lshlrev_b32 v96, 16, v224
    v_and_b32 v97, 0xffff0000, v224
    v_lshlrev_b32 v98, 16, v225
    v_and_b32 v99, 0xffff0000, v225
    v_lshlrev_b32 v100, 16, v226
    v_and_b32 v101, 0xffff0000, v226
    v_lshlrev_b32 v102, 16, v227
    v_and_b32 v103, 0xffff0000, v227
    v_lshlrev_b32 v104, 16, v228
    v_and_b32 v105, 0xffff0000, v228
    v_lshlrev_b32 v106, 16, v229
    v_and_b32 v107, 0xffff0000, v229
    v_lshlrev_b32 v108, 16, v230
    v_and_b32 v109, 0xffff0000, v230
    v_lshlrev_b32 v110, 16, v231
    v_and_b32 v111, 0xffff0000, v231
    v_lshlrev_b32 v112, 16, v232
    v_and_b32 v113, 0xffff0000, v232
    v_lshlrev_b32 v114, 16, v233
    v_and_b32 v115, 0xffff0000, v233
    s_add_u32 s74, s88, 73728
    v_add_u32 v234, s74, v6
    s_waitcnt vmcnt(5)
    v_mfma_f32_16x16x32_bf16 v[16:19], a[0:3], v[168:171], v[96:99]
    s_waitcnt vmcnt(4)
    v_mfma_f32_16x16x32_bf16 v[16:19], a[20:23], v[172:175], v[16:19]
    v_mfma_f32_16x16x32_bf16 v[20:23], a[4:7], v[168:171], v[100:103]
    buffer_load_dwordx4 v[192:195], v239, s[16:19], s101 offen sc1
    v_mfma_f32_16x16x32_bf16 v[20:23], a[24:27], v[172:175], v[20:23]
    v_mfma_f32_16x16x32_bf16 v[24:27], a[8:11], v[168:171], v[104:107]
    v_mfma_f32_16x16x32_bf16 v[24:27], a[28:31], v[172:175], v[24:27]
    v_mfma_f32_16x16x32_bf16 v[28:31], a[12:15], v[168:171], v[108:111]
    buffer_load_dwordx4 v[196:199], v239, s[16:19], s55 offen sc1
    v_mfma_f32_16x16x32_bf16 v[28:31], a[32:35], v[172:175], v[28:31]
    v_mfma_f32_16x16x32_bf16 v[32:35], a[16:19], v[168:171], v[112:115]
    v_mfma_f32_16x16x32_bf16 v[32:35], a[36:39], v[172:175], v[32:35]
    s_waitcnt vmcnt(5)
    v_mfma_f32_16x16x32_bf16 v[36:39], a[0:3], v[176:179], v[96:99]
    s_add_u32 s101, s96, 32768
    buffer_load_dwordx4 v[200:203], v236, s[16:19], s101 offen sc1
    s_waitcnt vmcnt(5)
    v_mfma_f32_16x16x32_bf16 v[36:39], a[20:23], v[180:183], v[36:39]
    v_mfma_f32_16x16x32_bf16 v[40:43], a[4:7], v[176:179], v[100:103]
    v_mfma_f32_16x16x32_bf16 v[40:43], a[24:27], v[180:183], v[40:43]
    v_mfma_f32_16x16x32_bf16 v[44:47], a[8:11], v[176:179], v[104:107]
    s_add_u32 s55, s96, 49152
    buffer_load_dwordx4 v[204:207], v236, s[16:19], s55 offen sc1
    v_mfma_f32_16x16x32_bf16 v[44:47], a[28:31], v[180:183], v[44:47]
    v_mfma_f32_16x16x32_bf16 v[48:51], a[12:15], v[176:179], v[108:111]
    v_mfma_f32_16x16x32_bf16 v[48:51], a[32:35], v[180:183], v[48:51]
    v_mfma_f32_16x16x32_bf16 v[52:55], a[16:19], v[176:179], v[112:115]
    buffer_load_dwordx4 v[208:211], v237, s[16:19], s101 offen sc1
    v_mfma_f32_16x16x32_bf16 v[52:55], a[36:39], v[180:183], v[52:55]
    s_waitcnt vmcnt(6)
    v_mfma_f32_16x16x32_bf16 v[56:59], a[0:3], v[184:187], v[96:99]
    s_waitcnt vmcnt(5)
    v_mfma_f32_16x16x32_bf16 v[56:59], a[20:23], v[188:191], v[56:59]
    v_mfma_f32_16x16x32_bf16 v[60:63], a[4:7], v[184:187], v[100:103]
    buffer_load_dwordx4 v[212:215], v237, s[16:19], s55 offen sc1
    v_mfma_f32_16x16x32_bf16 v[60:63], a[24:27], v[188:191], v[60:63]
    v_mfma_f32_16x16x32_bf16 v[64:67], a[8:11], v[184:187], v[104:107]
    v_mfma_f32_16x16x32_bf16 v[64:67], a[28:31], v[188:191], v[64:67]
    v_mfma_f32_16x16x32_bf16 v[68:71], a[12:15], v[184:187], v[108:111]
    buffer_load_dwordx4 v[216:219], v238, s[16:19], s101 offen sc1
    v_mfma_f32_16x16x32_bf16 v[68:71], a[32:35], v[188:191], v[68:71]
    v_mfma_f32_16x16x32_bf16 v[72:75], a[16:19], v[184:187], v[112:115]
    v_mfma_f32_16x16x32_bf16 v[72:75], a[36:39], v[188:191], v[72:75]
    s_waitcnt vmcnt(6)
    v_mfma_f32_16x16x32_bf16 v[76:79], a[0:3], v[192:195], v[96:99]
    buffer_load_dwordx4 v[220:223], v238, s[16:19], s55 offen sc1
    s_waitcnt vmcnt(6)
    v_mfma_f32_16x16x32_bf16 v[76:79], a[20:23], v[196:199], v[76:79]
    v_mfma_f32_16x16x32_bf16 v[80:83], a[4:7], v[192:195], v[100:103]
    v_mfma_f32_16x16x32_bf16 v[80:83], a[24:27], v[196:199], v[80:83]
    v_mfma_f32_16x16x32_bf16 v[84:87], a[8:11], v[192:195], v[104:107]
    buffer_load_dwordx4 v[116:119], v239, s[16:19], s101 offen sc1
    v_mfma_f32_16x16x32_bf16 v[84:87], a[28:31], v[196:199], v[84:87]
    v_mfma_f32_16x16x32_bf16 v[88:91], a[12:15], v[192:195], v[108:111]
    v_mfma_f32_16x16x32_bf16 v[88:91], a[32:35], v[196:199], v[88:91]
    v_mfma_f32_16x16x32_bf16 v[92:95], a[16:19], v[192:195], v[112:115]
    buffer_load_dwordx4 v[120:123], v239, s[16:19], s55 offen sc1
    v_mfma_f32_16x16x32_bf16 v[92:95], a[36:39], v[196:199], v[92:95]
    s_waitcnt vmcnt(7)
    v_mfma_f32_16x16x32_bf16 v[16:19], a[40:43], v[200:203], v[16:19]
    s_waitcnt vmcnt(6)
    v_mfma_f32_16x16x32_bf16 v[16:19], a[60:63], v[204:207], v[16:19]
    v_mfma_f32_16x16x32_bf16 v[20:23], a[44:47], v[200:203], v[20:23]
    s_add_u32 s101, s96, 65536
    buffer_load_dwordx4 v[124:127], v236, s[16:19], s101 offen sc1
    v_mfma_f32_16x16x32_bf16 v[20:23], a[64:67], v[204:207], v[20:23]
    v_mfma_f32_16x16x32_bf16 v[24:27], a[48:51], v[200:203], v[24:27]
    v_mfma_f32_16x16x32_bf16 v[24:27], a[68:71], v[204:207], v[24:27]
    v_mfma_f32_16x16x32_bf16 v[28:31], a[52:55], v[200:203], v[28:31]
    s_add_u32 s55, s96, 81920
    buffer_load_dwordx4 v[128:131], v236, s[16:19], s55 offen sc1
    v_mfma_f32_16x16x32_bf16 v[28:31], a[72:75], v[204:207], v[28:31]
    v_mfma_f32_16x16x32_bf16 v[32:35], a[56:59], v[200:203], v[32:35]
    v_mfma_f32_16x16x32_bf16 v[32:35], a[76:79], v[204:207], v[32:35]
    s_waitcnt vmcnt(7)
    v_mfma_f32_16x16x32_bf16 v[36:39], a[40:43], v[208:211], v[36:39]
    buffer_load_dwordx4 v[132:135], v237, s[16:19], s101 offen sc1
    s_waitcnt vmcnt(7)
    v_mfma_f32_16x16x32_bf16 v[36:39], a[60:63], v[212:215], v[36:39]
    v_mfma_f32_16x16x32_bf16 v[40:43], a[44:47], v[208:211], v[40:43]
    v_mfma_f32_16x16x32_bf16 v[40:43], a[64:67], v[212:215], v[40:43]
    v_mfma_f32_16x16x32_bf16 v[44:47], a[48:51], v[208:211], v[44:47]
    buffer_load_dwordx4 v[136:139], v237, s[16:19], s55 offen sc1
    v_mfma_f32_16x16x32_bf16 v[44:47], a[68:71], v[212:215], v[44:47]
    v_mfma_f32_16x16x32_bf16 v[48:51], a[52:55], v[208:211], v[48:51]
    v_mfma_f32_16x16x32_bf16 v[48:51], a[72:75], v[212:215], v[48:51]
    v_mfma_f32_16x16x32_bf16 v[52:55], a[56:59], v[208:211], v[52:55]
    buffer_load_dwordx4 v[140:143], v238, s[16:19], s101 offen sc1
    v_mfma_f32_16x16x32_bf16 v[52:55], a[76:79], v[212:215], v[52:55]
    s_waitcnt vmcnt(8)
    v_mfma_f32_16x16x32_bf16 v[56:59], a[40:43], v[216:219], v[56:59]
    s_waitcnt vmcnt(7)
    v_mfma_f32_16x16x32_bf16 v[56:59], a[60:63], v[220:223], v[56:59]
    v_mfma_f32_16x16x32_bf16 v[60:63], a[44:47], v[216:219], v[60:63]
    buffer_load_dwordx4 v[144:147], v238, s[16:19], s55 offen sc1
    v_mfma_f32_16x16x32_bf16 v[60:63], a[64:67], v[220:223], v[60:63]
    v_mfma_f32_16x16x32_bf16 v[64:67], a[48:51], v[216:219], v[64:67]
    v_mfma_f32_16x16x32_bf16 v[64:67], a[68:71], v[220:223], v[64:67]
    v_mfma_f32_16x16x32_bf16 v[68:71], a[52:55], v[216:219], v[68:71]
    buffer_load_dwordx4 v[148:151], v239, s[16:19], s101 offen sc1
    v_mfma_f32_16x16x32_bf16 v[68:71], a[72:75], v[220:223], v[68:71]
    v_mfma_f32_16x16x32_bf16 v[72:75], a[56:59], v[216:219], v[72:75]
    v_mfma_f32_16x16x32_bf16 v[72:75], a[76:79], v[220:223], v[72:75]
    s_waitcnt vmcnt(8)
    v_mfma_f32_16x16x32_bf16 v[76:79], a[40:43], v[116:119], v[76:79]
    buffer_load_dwordx4 v[152:155], v239, s[16:19], s55 offen sc1
    s_waitcnt vmcnt(8)
    v_mfma_f32_16x16x32_bf16 v[76:79], a[60:63], v[120:123], v[76:79]
    v_mfma_f32_16x16x32_bf16 v[80:83], a[44:47], v[116:119], v[80:83]
    v_mfma_f32_16x16x32_bf16 v[80:83], a[64:67], v[120:123], v[80:83]
    v_mfma_f32_16x16x32_bf16 v[84:87], a[48:51], v[116:119], v[84:87]
    s_add_u32 s101, s96, 98304
    buffer_load_dwordx4 v[156:159], v236, s[16:19], s101 offen sc1
    v_mfma_f32_16x16x32_bf16 v[84:87], a[68:71], v[120:123], v[84:87]
    v_mfma_f32_16x16x32_bf16 v[88:91], a[52:55], v[116:119], v[88:91]
    v_mfma_f32_16x16x32_bf16 v[88:91], a[72:75], v[120:123], v[88:91]
    v_mfma_f32_16x16x32_bf16 v[92:95], a[56:59], v[116:119], v[92:95]
    s_add_u32 s55, s96, 114688
    buffer_load_dwordx4 v[160:163], v236, s[16:19], s55 offen sc1
    v_mfma_f32_16x16x32_bf16 v[92:95], a[76:79], v[120:123], v[92:95]
    s_waitcnt vmcnt(9)
    v_mfma_f32_16x16x32_bf16 v[16:19], a[80:83], v[124:127], v[16:19]
    s_waitcnt vmcnt(8)
    v_mfma_f32_16x16x32_bf16 v[16:19], a[100:103], v[128:131], v[16:19]
    v_mfma_f32_16x16x32_bf16 v[20:23], a[84:87], v[124:127], v[20:23]
    buffer_load_dwordx4 v[164:167], v237, s[16:19], s101 offen sc1
    v_mfma_f32_16x16x32_bf16 v[20:23], a[104:107], v[128:131], v[20:23]
    v_mfma_f32_16x16x32_bf16 v[24:27], a[88:91], v[124:127], v[24:27]
    v_mfma_f32_16x16x32_bf16 v[24:27], a[108:111], v[128:131], v[24:27]
    v_mfma_f32_16x16x32_bf16 v[28:31], a[92:95], v[124:127], v[28:31]
    buffer_load_dwordx4 v[224:227], v237, s[16:19], s55 offen sc1
    v_mfma_f32_16x16x32_bf16 v[28:31], a[112:115], v[128:131], v[28:31]
    v_mfma_f32_16x16x32_bf16 v[32:35], a[96:99], v[124:127], v[32:35]
    v_mfma_f32_16x16x32_bf16 v[32:35], a[116:119], v[128:131], v[32:35]
    s_waitcnt vmcnt(9)
    v_mfma_f32_16x16x32_bf16 v[36:39], a[80:83], v[132:135], v[36:39]
    s_waitcnt vmcnt(8)
    v_mfma_f32_16x16x32_bf16 v[36:39], a[100:103], v[136:139], v[36:39]
    buffer_load_dwordx4 v[228:231], v238, s[16:19], s101 offen sc1
    v_mfma_f32_16x16x32_bf16 v[40:43], a[84:87], v[132:135], v[40:43]
    v_mfma_f32_16x16x32_bf16 v[40:43], a[104:107], v[136:139], v[40:43]
    v_mfma_f32_16x16x32_bf16 v[44:47], a[88:91], v[132:135], v[44:47]
    buffer_load_dwordx4 v[168:171], v238, s[16:19], s55 offen sc1
    v_mfma_f32_16x16x32_bf16 v[44:47], a[108:111], v[136:139], v[44:47]
    v_mfma_f32_16x16x32_bf16 v[48:51], a[92:95], v[132:135], v[48:51]
    v_mfma_f32_16x16x32_bf16 v[48:51], a[112:115], v[136:139], v[48:51]
    v_mfma_f32_16x16x32_bf16 v[52:55], a[96:99], v[132:135], v[52:55]
    v_mfma_f32_16x16x32_bf16 v[52:55], a[116:119], v[136:139], v[52:55]
    buffer_load_dwordx4 v[172:175], v239, s[16:19], s101 offen sc1
    s_waitcnt vmcnt(10)
    v_mfma_f32_16x16x32_bf16 v[56:59], a[80:83], v[140:143], v[56:59]
    s_waitcnt vmcnt(9)
    v_mfma_f32_16x16x32_bf16 v[56:59], a[100:103], v[144:147], v[56:59]
    v_mfma_f32_16x16x32_bf16 v[60:63], a[84:87], v[140:143], v[60:63]
    buffer_load_dwordx4 v[176:179], v239, s[16:19], s55 offen sc1
    v_mfma_f32_16x16x32_bf16 v[60:63], a[104:107], v[144:147], v[60:63]
    v_mfma_f32_16x16x32_bf16 v[64:67], a[88:91], v[140:143], v[64:67]
    v_mfma_f32_16x16x32_bf16 v[64:67], a[108:111], v[144:147], v[64:67]
    v_mfma_f32_16x16x32_bf16 v[68:71], a[92:95], v[140:143], v[68:71]
    v_mfma_f32_16x16x32_bf16 v[68:71], a[112:115], v[144:147], v[68:71]
    s_add_u32 s101, s96, 131072
    buffer_load_dwordx4 v[180:183], v236, s[16:19], s101 offen sc1
    v_mfma_f32_16x16x32_bf16 v[72:75], a[96:99], v[140:143], v[72:75]
    v_mfma_f32_16x16x32_bf16 v[72:75], a[116:119], v[144:147], v[72:75]
    s_waitcnt vmcnt(10)
    v_mfma_f32_16x16x32_bf16 v[76:79], a[80:83], v[148:151], v[76:79]
    s_waitcnt vmcnt(9)
    v_mfma_f32_16x16x32_bf16 v[76:79], a[100:103], v[152:155], v[76:79]
    s_mov_b32 s55, s87
    buffer_load_dwordx4 v[184:187], v236, s[16:19], s55 offen sc1
    v_mfma_f32_16x16x32_bf16 v[80:83], a[84:87], v[148:151], v[80:83]
    v_mfma_f32_16x16x32_bf16 v[80:83], a[104:107], v[152:155], v[80:83]
    v_mfma_f32_16x16x32_bf16 v[84:87], a[88:91], v[148:151], v[84:87]
    v_mfma_f32_16x16x32_bf16 v[84:87], a[108:111], v[152:155], v[84:87]
    buffer_load_dwordx4 v[188:191], v237, s[16:19], s101 offen sc1
    v_mfma_f32_16x16x32_bf16 v[88:91], a[92:95], v[148:151], v[88:91]
    v_mfma_f32_16x16x32_bf16 v[88:91], a[112:115], v[152:155], v[88:91]
    v_mfma_f32_16x16x32_bf16 v[92:95], a[96:99], v[148:151], v[92:95]
    v_mfma_f32_16x16x32_bf16 v[92:95], a[116:119], v[152:155], v[92:95]
    buffer_load_dwordx4 a[0:3], v237, s[16:19], s55 offen sc1
    s_waitcnt vmcnt(11)
    v_mfma_f32_16x16x32_bf16 v[16:19], a[120:123], v[156:159], v[16:19]
    s_waitcnt vmcnt(10)
    v_mfma_f32_16x16x32_bf16 v[16:19], a[140:143], v[160:163], v[16:19]
    v_mfma_f32_16x16x32_bf16 v[20:23], a[124:127], v[156:159], v[20:23]
    v_mfma_f32_16x16x32_bf16 v[20:23], a[144:147], v[160:163], v[20:23]
    buffer_load_dwordx4 a[20:23], v238, s[16:19], s101 offen sc1
    v_mfma_f32_16x16x32_bf16 v[24:27], a[128:131], v[156:159], v[24:27]
    v_mfma_f32_16x16x32_bf16 v[24:27], a[148:151], v[160:163], v[24:27]
    v_mfma_f32_16x16x32_bf16 v[28:31], a[132:135], v[156:159], v[28:31]
    v_mfma_f32_16x16x32_bf16 v[28:31], a[152:155], v[160:163], v[28:31]
    buffer_load_dwordx4 a[4:7], v238, s[16:19], s55 offen sc1
    v_mfma_f32_16x16x32_bf16 v[32:35], a[136:139], v[156:159], v[32:35]
    v_mfma_f32_16x16x32_bf16 v[32:35], a[156:159], v[160:163], v[32:35]
    s_waitcnt vmcnt(11)
    v_mfma_f32_16x16x32_bf16 v[36:39], a[120:123], v[164:167], v[36:39]
    s_waitcnt vmcnt(10)
    v_mfma_f32_16x16x32_bf16 v[36:39], a[140:143], v[224:227], v[36:39]
    buffer_load_dwordx4 a[24:27], v239, s[16:19], s101 offen sc1
    v_mfma_f32_16x16x32_bf16 v[40:43], a[124:127], v[164:167], v[40:43]
    v_mfma_f32_16x16x32_bf16 v[40:43], a[144:147], v[224:227], v[40:43]
    v_mfma_f32_16x16x32_bf16 v[44:47], a[128:131], v[164:167], v[44:47]
    v_mfma_f32_16x16x32_bf16 v[44:47], a[148:151], v[224:227], v[44:47]
    buffer_load_dwordx4 a[8:11], v239, s[16:19], s55 offen sc1
    v_mfma_f32_16x16x32_bf16 v[48:51], a[132:135], v[164:167], v[48:51]
    v_mfma_f32_16x16x32_bf16 v[48:51], a[152:155], v[224:227], v[48:51]
    v_mfma_f32_16x16x32_bf16 v[52:55], a[136:139], v[164:167], v[52:55]
    v_mfma_f32_16x16x32_bf16 v[52:55], a[156:159], v[224:227], v[52:55]
    s_add_u32 s100, s97, 337920
    buffer_load_dwordx4 a[28:31], v6, s[16:19], s100 offen offset:0 sc1
    s_waitcnt vmcnt(12)
    v_mfma_f32_16x16x32_bf16 v[56:59], a[120:123], v[228:231], v[56:59]
    buffer_load_dwordx2 v[252:253], v235, s[16:19], s84 offen sc1
    s_waitcnt vmcnt(12)
    v_mfma_f32_16x16x32_bf16 v[56:59], a[140:143], v[168:171], v[56:59]
    v_mfma_f32_16x16x32_bf16 v[60:63], a[124:127], v[228:231], v[60:63]
    v_mfma_f32_16x16x32_bf16 v[60:63], a[144:147], v[168:171], v[60:63]
    v_mfma_f32_16x16x32_bf16 v[64:67], a[128:131], v[228:231], v[64:67]
    v_mfma_f32_16x16x32_bf16 v[64:67], a[148:151], v[168:171], v[64:67]
    v_mfma_f32_16x16x32_bf16 v[68:71], a[132:135], v[228:231], v[68:71]
    v_mfma_f32_16x16x32_bf16 v[68:71], a[152:155], v[168:171], v[68:71]
    s_add_u32 s100, s97, 358400
    buffer_load_dwordx4 a[12:15], v6, s[16:19], s100 offen offset:0 sc1
    v_mfma_f32_16x16x32_bf16 v[72:75], a[136:139], v[228:231], v[72:75]
    v_mfma_f32_16x16x32_bf16 v[72:75], a[156:159], v[168:171], v[72:75]
    s_waitcnt vmcnt(12)
    v_mfma_f32_16x16x32_bf16 v[76:79], a[120:123], v[172:175], v[76:79]
    s_waitcnt vmcnt(11)
    v_mfma_f32_16x16x32_bf16 v[76:79], a[140:143], v[176:179], v[76:79]
    s_add_u32 s100, s97, 337920
    buffer_load_dwordx4 a[32:35], v6, s[16:19], s100 offen offset:1024 sc1
    v_mfma_f32_16x16x32_bf16 v[80:83], a[124:127], v[172:175], v[80:83]
    v_mfma_f32_16x16x32_bf16 v[80:83], a[144:147], v[176:179], v[80:83]
    v_mfma_f32_16x16x32_bf16 v[84:87], a[128:131], v[172:175], v[84:87]
    v_mfma_f32_16x16x32_bf16 v[84:87], a[148:151], v[176:179], v[84:87]
    s_add_u32 s100, s97, 358400
    buffer_load_dwordx4 a[16:19], v6, s[16:19], s100 offen offset:1024 sc1
    v_mfma_f32_16x16x32_bf16 v[88:91], a[132:135], v[172:175], v[88:91]
    v_mfma_f32_16x16x32_bf16 v[88:91], a[152:155], v[176:179], v[88:91]
    v_mfma_f32_16x16x32_bf16 v[92:95], a[136:139], v[172:175], v[92:95]
    v_mfma_f32_16x16x32_bf16 v[92:95], a[156:159], v[176:179], v[92:95]
    s_add_u32 s100, s97, 317440
    buffer_load_dwordx4 a[36:39], v6, s[16:19], s100 offen offset:2048 sc1
    s_waitcnt vmcnt(13)
    v_mfma_f32_16x16x32_bf16 v[16:19], a[160:163], v[180:183], v[16:19]
    s_waitcnt vmcnt(12)
    v_mfma_f32_16x16x32_bf16 v[16:19], a[180:183], v[184:187], v[16:19]
    v_mfma_f32_16x16x32_bf16 v[20:23], a[164:167], v[180:183], v[20:23]
    v_mfma_f32_16x16x32_bf16 v[20:23], a[184:187], v[184:187], v[20:23]
    s_add_u32 s100, s97, 337920
    buffer_load_dwordx4 a[40:43], v6, s[16:19], s100 offen offset:2048 sc1
    v_mfma_f32_16x16x32_bf16 v[24:27], a[168:171], v[180:183], v[24:27]
    v_mfma_f32_16x16x32_bf16 v[24:27], a[188:191], v[184:187], v[24:27]
    s_waitcnt vmcnt(5)
    v_cmp_ne_u64 vcc, s[58:59], v[252:253]
    s_nop 3
    s_cbranch_vccnz L_slow_10
L_back_11:
    s_lshl_b32 s74, s62, 10
    s_add_u32 s74, s74, 2621440
    v_lshlrev_b32 v7, 4, v1
    v_subrev_u32 v8, v6, v236
    v_lshrrev_b32 v8, 2, v8
    v_add_u32 v8, v8, v7
    buffer_load_dword v241, v8, s[16:19], s74 offen sc1
    v_subrev_u32 v8, v6, v237
    v_lshrrev_b32 v8, 2, v8
    v_add_u32 v8, v8, v7
    buffer_load_dword v242, v8, s[16:19], s74 offen sc1
    v_subrev_u32 v8, v6, v238
    v_lshrrev_b32 v8, 2, v8
    v_add_u32 v8, v8, v7
    buffer_load_dword v243, v8, s[16:19], s74 offen sc1
    v_subrev_u32 v8, v6, v239
    v_lshrrev_b32 v8, 2, v8
    v_add_u32 v8, v8, v7
    buffer_load_dword v244, v8, s[16:19], s74 offen sc1
    s_add_u32 s101, s96, 155648
    buffer_load_dwordx4 a[60:63], v236, s[16:19], s101 offen sc1
    s_add_u32 s55, s96, 172032
    buffer_load_dwordx4 a[44:47], v236, s[16:19], s55 offen sc1
    buffer_load_dwordx4 a[64:67], v237, s[16:19], s101 offen sc1
    buffer_load_dwordx4 a[48:51], v237, s[16:19], s55 offen sc1
    v_mfma_f32_16x16x32_bf16 v[28:31], a[172:175], v[180:183], v[28:31]
    v_mfma_f32_16x16x32_bf16 v[28:31], a[192:195], v[184:187], v[28:31]
    v_mfma_f32_16x16x32_bf16 v[32:35], a[176:179], v[180:183], v[32:35]
    v_mfma_f32_16x16x32_bf16 v[32:35], a[196:199], v[184:187], v[32:35]
    v_mfma_f32_16x16x32_bf16 v[36:39], a[160:163], v[188:191], v[36:39]
    v_mfma_f32_16x16x32_bf16 v[36:39], a[180:183], a[0:3], v[36:39]
    v_mfma_f32_16x16x32_bf16 v[40:43], a[164:167], v[188:191], v[40:43]
    v_mfma_f32_16x16x32_bf16 v[40:43], a[184:187], a[0:3], v[40:43]
    v_mfma_f32_16x16x32_bf16 v[44:47], a[168:171], v[188:191], v[44:47]
    buffer_load_dwordx4 a[68:71], v238, s[16:19], s101 offen sc1
    v_mfma_f32_16x16x32_bf16 v[44:47], a[188:191], a[0:3], v[44:47]
    v_mfma_f32_16x16x32_bf16 v[48:51], a[172:175], v[188:191], v[48:51]
    v_mfma_f32_16x16x32_bf16 v[48:51], a[192:195], a[0:3], v[48:51]
    v_mfma_f32_16x16x32_bf16 v[52:55], a[176:179], v[188:191], v[52:55]
    buffer_load_dwordx4 a[52:55], v238, s[16:19], s55 offen sc1
    v_mfma_f32_16x16x32_bf16 v[52:55], a[196:199], a[0:3], v[52:55]
    v_mfma_f32_16x16x32_bf16 v[56:59], a[160:163], a[20:23], v[56:59]
    v_mfma_f32_16x16x32_bf16 v[56:59], a[180:183], a[4:7], v[56:59]
    v_mfma_f32_16x16x32_bf16 v[60:63], a[164:167], a[20:23], v[60:63]
    buffer_load_dwordx4 a[72:75], v239, s[16:19], s101 offen sc1
    v_mfma_f32_16x16x32_bf16 v[60:63], a[184:187], a[4:7], v[60:63]
    v_mfma_f32_16x16x32_bf16 v[64:67], a[168:171], a[20:23], v[64:67]
    v_mfma_f32_16x16x32_bf16 v[64:67], a[188:191], a[4:7], v[64:67]
    v_mfma_f32_16x16x32_bf16 v[68:71], a[172:175], a[20:23], v[68:71]
    buffer_load_dwordx4 a[56:59], v239, s[16:19], s55 offen sc1
    v_mfma_f32_16x16x32_bf16 v[68:71], a[192:195], a[4:7], v[68:71]
    v_mfma_f32_16x16x32_bf16 v[72:75], a[176:179], a[20:23], v[72:75]
    v_mfma_f32_16x16x32_bf16 v[72:75], a[196:199], a[4:7], v[72:75]
    v_mfma_f32_16x16x32_bf16 v[76:79], a[160:163], a[24:27], v[76:79]
    v_mfma_f32_16x16x32_bf16 v[76:79], a[180:183], a[8:11], v[76:79]
    s_add_u32 s101, s96, 188416
    buffer_load_dwordx4 a[76:79], v237, s[16:19], s101 offen sc1
    v_mfma_f32_16x16x32_bf16 v[80:83], a[164:167], a[24:27], v[80:83]
    v_mfma_f32_16x16x32_bf16 v[80:83], a[184:187], a[8:11], v[80:83]
    v_mfma_f32_16x16x32_bf16 v[84:87], a[168:171], a[24:27], v[84:87]
    s_add_u32 s55, s96, 204800
    buffer_load_dwordx4 a[80:83], v237, s[16:19], s55 offen sc1
    v_mfma_f32_16x16x32_bf16 v[84:87], a[188:191], a[8:11], v[84:87]
    v_mfma_f32_16x16x32_bf16 v[88:91], a[172:175], a[24:27], v[88:91]
    v_mfma_f32_16x16x32_bf16 v[88:91], a[192:195], a[8:11], v[88:91]
    v_mfma_f32_16x16x32_bf16 v[92:95], a[176:179], a[24:27], v[92:95]
    v_mfma_f32_16x16x32_bf16 v[92:95], a[196:199], a[8:11], v[92:95]
    buffer_load_dwordx4 a[100:103], v238, s[16:19], s101 offen sc1
    s_waitcnt vmcnt(10)
    v_mfma_f32_16x16x32_bf16 v[16:19], a[200:203], a[60:63], v[16:19]
    s_waitcnt vmcnt(9)
    v_mfma_f32_16x16x32_bf16 v[16:19], a[220:223], a[44:47], v[16:19]
    v_mfma_f32_16x16x32_bf16 v[20:23], a[204:207], a[60:63], v[20:23]
    buffer_load_dwordx4 a[84:87], v238, s[16:19], s55 offen sc1
    v_mfma_f32_16x16x32_bf16 v[20:23], a[224:227], a[44:47], v[20:23]
    v_mfma_f32_16x16x32_bf16 v[24:27], a[208:211], a[60:63], v[24:27]
    v_mfma_f32_16x16x32_bf16 v[24:27], a[228:231], a[44:47], v[24:27]
    s_add_u32 s74, s3, 1
    s_and_b32 s74, s74, 3
    v_mfma_f32_16x16x32_bf16 v[28:31], a[212:215], a[60:63], v[28:31]
    s_mul_i32 s74, s74, 15360
    s_add_u32 s74, s74, 0
    v_mfma_f32_16x16x32_bf16 v[28:31], a[232:235], a[44:47], v[28:31]
    buffer_load_dwordx4 a[104:107], v239, s[16:19], s101 offen sc1
    v_add_u32 v9, s74, v6
    v_mfma_f32_16x16x32_bf16 v[32:35], a[216:219], a[60:63], v[32:35]
    s_add_u32 s74, s3, 2
    s_and_b32 s74, s74, 3
    v_mfma_f32_16x16x32_bf16 v[32:35], a[236:239], a[44:47], v[32:35]
    s_mul_i32 s74, s74, 15360
    s_add_u32 s74, s74, 5120
    s_waitcnt vmcnt(10)
    v_mfma_f32_16x16x32_bf16 v[36:39], a[200:203], a[64:67], v[36:39]
    v_add_u32 v10, s74, v6
    s_add_u32 s74, s3, 3
    s_waitcnt vmcnt(9)
    v_mfma_f32_16x16x32_bf16 v[36:39], a[220:223], a[48:51], v[36:39]
    buffer_load_dwordx4 a[88:91], v239, s[16:19], s55 offen sc1
    s_and_b32 s74, s74, 3
    v_mfma_f32_16x16x32_bf16 v[40:43], a[204:207], a[64:67], v[40:43]
    s_mul_i32 s74, s74, 15360
    s_add_u32 s74, s74, 10240
    v_mfma_f32_16x16x32_bf16 v[40:43], a[224:227], a[48:51], v[40:43]
    v_add_u32 v11, s74, v6
    s_mul_i32 s74, s3, 15360
    v_mfma_f32_16x16x32_bf16 v[44:47], a[208:211], a[64:67], v[44:47]
    s_add_u32 s74, s74, 0
    v_add_u32 v8, s74, v6
    v_mfma_f32_16x16x32_bf16 v[44:47], a[228:231], a[48:51], v[44:47]
    buffer_load_dwordx4 a[108:111], v236, s[16:19], s101 offen sc1
    s_lshl_b32 s74, s62, 2
    v_mfma_f32_16x16x32_bf16 v[48:51], a[212:215], a[64:67], v[48:51]
    s_add_u32 s74, s74, s3
    s_mul_i32 s74, s74, 20480
    v_mfma_f32_16x16x32_bf16 v[48:51], a[232:235], a[48:51], v[48:51]
    ds_read_b128 a[92:95], v234 offset:1024
    s_add_u32 s77, s74, s82
    v_mfma_f32_16x16x32_bf16 v[52:55], a[216:219], a[64:67], v[52:55]
    s_add_u32 s76, s74, s81
    v_mul_u32_u24 v12, 1280, v1
    v_mfma_f32_16x16x32_bf16 v[52:55], a[236:239], a[48:51], v[52:55]
    ds_read_b128 a[112:115], v234 offset:2048
    v_lshl_add_u32 v13, v2, 3, v12
    s_waitcnt vmcnt(10)
    v_mfma_f32_16x16x32_bf16 v[56:59], a[200:203], a[68:71], v[56:59]
    buffer_load_dwordx4 a[96:99], v236, s[16:19], s55 offen sc1
    v_lshl_add_u32 v12, v2, 4, v12
    s_waitcnt vmcnt(10)
    v_mfma_f32_16x16x32_bf16 v[56:59], a[220:223], a[52:55], v[56:59]
    ds_read_b128 a[116:119], v234 offset:3072
    v_mfma_f32_16x16x32_bf16 v[60:63], a[204:207], a[68:71], v[60:63]
    s_add_u32 s100, s97, 358400
    buffer_load_dwordx4 a[120:123], v6, s[16:19], s100 offen offset:2048 sc1
    v_mfma_f32_16x16x32_bf16 v[60:63], a[224:227], a[52:55], v[60:63]
    ds_read_b128 a[140:143], v234 offset:4096
    v_mfma_f32_16x16x32_bf16 v[64:67], a[208:211], a[68:71], v[64:67]
    ds_read_b128 a[124:127], v234 offset:0
    v_mfma_f32_16x16x32_bf16 v[64:67], a[228:231], a[52:55], v[64:67]
    ds_read_b128 a[144:147], v234 offset:5120
    v_mfma_f32_16x16x32_bf16 v[68:71], a[212:215], a[68:71], v[68:71]
    s_add_u32 s101, s96, 221184
    buffer_load_dwordx4 v[192:195], v237, s[16:19], s101 offen sc1
    v_mfma_f32_16x16x32_bf16 v[68:71], a[232:235], a[52:55], v[68:71]
    v_mfma_f32_16x16x32_bf16 v[72:75], a[216:219], a[68:71], v[72:75]
    v_mfma_f32_16x16x32_bf16 v[72:75], a[236:239], a[52:55], v[72:75]
    s_add_u32 s55, s96, 237568
    buffer_load_dwordx4 v[196:199], v237, s[16:19], s55 offen sc1
    s_waitcnt vmcnt(12)
    v_mfma_f32_16x16x32_bf16 v[76:79], a[200:203], a[72:75], v[76:79]
    s_waitcnt vmcnt(11)
    v_mfma_f32_16x16x32_bf16 v[76:79], a[220:223], a[56:59], v[76:79]
    v_and_b32 v241, 0xfffffc00, v241
    v_and_b32 v242, 0xfffffc00, v242
    v_mfma_f32_16x16x32_bf16 v[80:83], a[204:207], a[72:75], v[80:83]
    v_and_b32 v243, 0xfffffc00, v243
    v_and_b32 v244, 0xfffffc00, v244
    v_mfma_f32_16x16x32_bf16 v[80:83], a[224:227], a[56:59], v[80:83]
    v_sub_f32 v241, 1.0, v241
    v_sub_f32 v242, 1.0, v242
    v_mfma_f32_16x16x32_bf16 v[84:87], a[208:211], a[72:75], v[84:87]
    buffer_load_dwordx4 v[96:99], v238, s[16:19], s101 offen sc1
    v_sub_f32 v243, 1.0, v243
    v_mfma_f32_16x16x32_bf16 v[84:87], a[228:231], a[56:59], v[84:87]
    v_sub_f32 v244, 1.0, v244
    v_mfma_f32_16x16x32_bf16 v[88:91], a[212:215], a[72:75], v[88:91]
    v_mfma_f32_16x16x32_bf16 v[88:91], a[232:235], a[56:59], v[88:91]
    buffer_load_dwordx4 v[100:103], v238, s[16:19], s55 offen sc1
    v_mfma_f32_16x16x32_bf16 v[92:95], a[216:219], a[72:75], v[92:95]
    v_mfma_f32_16x16x32_bf16 v[92:95], a[236:239], a[56:59], v[92:95]
    s_waitcnt vmcnt(12)
    v_mfma_f32_16x16x32_bf16 v[36:39], a[240:243], a[76:79], v[36:39]
    s_waitcnt vmcnt(11) lgkmcnt(5)
    v_mfma_f32_16x16x32_bf16 v[36:39], a[92:95], a[80:83], v[36:39]
    v_mfma_f32_16x16x32_bf16 v[40:43], a[244:247], a[76:79], v[40:43]
    buffer_load_dwordx4 v[104:107], v239, s[16:19], s101 offen sc1
    s_waitcnt lgkmcnt(4)
    v_mfma_f32_16x16x32_bf16 v[40:43], a[112:115], a[80:83], v[40:43]
    v_mfma_f32_16x16x32_bf16 v[44:47], a[248:251], a[76:79], v[44:47]
    s_nop 2
    v_mul_f32 v36, v242, v36
    v_mul_f32 v37, v242, v37
    s_waitcnt lgkmcnt(3)
    v_mfma_f32_16x16x32_bf16 v[44:47], a[116:119], a[80:83], v[44:47]
    buffer_load_dwordx4 v[108:111], v239, s[16:19], s55 offen sc1
    v_mul_f32 v38, v242, v38
    v_mfma_f32_16x16x32_bf16 v[48:51], a[252:255], a[76:79], v[48:51]
    v_mul_f32 v39, v242, v39
    v_mul_f32 v40, v242, v40
    s_waitcnt lgkmcnt(2)
    v_mfma_f32_16x16x32_bf16 v[48:51], a[140:143], a[80:83], v[48:51]
    v_mul_f32 v41, v242, v41
    v_mul_f32 v42, v242, v42
    s_waitcnt lgkmcnt(1)
    v_mfma_f32_16x16x32_bf16 v[52:55], a[124:127], a[76:79], v[52:55]
    v_mul_f32 v43, v242, v43
    v_mul_f32 v44, v242, v44
    s_waitcnt lgkmcnt(0)
    v_mfma_f32_16x16x32_bf16 v[52:55], a[144:147], a[80:83], v[52:55]
    buffer_load_dwordx4 v[112:115], v236, s[16:19], s101 offen sc1
    v_mul_f32 v45, v242, v45
    s_waitcnt vmcnt(13)
    v_mfma_f32_16x16x32_bf16 v[56:59], a[240:243], a[100:103], v[56:59]
    v_mul_f32 v46, v242, v46
    v_mul_f32 v47, v242, v47
    s_waitcnt vmcnt(12)
    v_mfma_f32_16x16x32_bf16 v[56:59], a[92:95], a[84:87], v[56:59]
    v_mul_f32 v48, v242, v48
    v_mul_f32 v49, v242, v49
    v_mfma_f32_16x16x32_bf16 v[60:63], a[244:247], a[100:103], v[60:63]
    v_mul_f32 v50, v242, v50
    v_mul_f32 v51, v242, v51
    v_mfma_f32_16x16x32_bf16 v[60:63], a[112:115], a[84:87], v[60:63]
    buffer_load_dwordx4 v[200:203], v236, s[16:19], s55 offen sc1
    v_mul_f32 v52, v242, v52
    v_mfma_f32_16x16x32_bf16 v[64:67], a[248:251], a[100:103], v[64:67]
    v_mul_f32 v53, v242, v53
    v_mul_f32 v54, v242, v54
    v_mfma_f32_16x16x32_bf16 v[64:67], a[116:119], a[84:87], v[64:67]
    v_mul_f32 v55, v242, v55
    v_mul_f32 v56, v243, v56
    v_mfma_f32_16x16x32_bf16 v[68:71], a[252:255], a[100:103], v[68:71]
    ds_read_b128 a[128:131], v234 offset:6144
    v_mul_f32 v57, v243, v57
    v_mfma_f32_16x16x32_bf16 v[68:71], a[140:143], a[84:87], v[68:71]
    ds_read_b128 a[148:151], v234 offset:11264
    v_mul_f32 v58, v243, v58
    v_mfma_f32_16x16x32_bf16 v[72:75], a[124:127], a[100:103], v[72:75]
    ds_read_b128 a[132:135], v234 offset:7168
    v_mul_f32 v59, v243, v59
    v_mfma_f32_16x16x32_bf16 v[72:75], a[144:147], a[84:87], v[72:75]
    ds_read_b128 a[152:155], v234 offset:12288
    v_mul_f32 v60, v243, v60
    s_waitcnt vmcnt(12)
    v_mfma_f32_16x16x32_bf16 v[76:79], a[240:243], a[104:107], v[76:79]
    ds_read_b128 a[136:139], v234 offset:8192
    v_mul_f32 v61, v243, v61
    s_waitcnt vmcnt(11)
    v_mfma_f32_16x16x32_bf16 v[76:79], a[92:95], a[88:91], v[76:79]
    ds_read_b128 a[156:159], v234 offset:13312
    v_mul_f32 v62, v243, v62
    v_mfma_f32_16x16x32_bf16 v[80:83], a[244:247], a[104:107], v[80:83]
    ds_read_b128 a[0:3], v234 offset:9216
    v_mul_f32 v63, v243, v63
    v_mfma_f32_16x16x32_bf16 v[80:83], a[112:115], a[88:91], v[80:83]
    ds_read_b128 a[20:23], v234 offset:14336
    v_mul_f32 v64, v243, v64
    v_mfma_f32_16x16x32_bf16 v[84:87], a[248:251], a[104:107], v[84:87]
    ds_read_b128 a[4:7], v234 offset:10240
    v_mul_f32 v65, v243, v65
    v_mfma_f32_16x16x32_bf16 v[84:87], a[116:119], a[88:91], v[84:87]
    ds_read_b128 a[160:163], v234 offset:15360
    v_mul_f32 v66, v243, v66
    v_mfma_f32_16x16x32_bf16 v[88:91], a[252:255], a[104:107], v[88:91]
    s_add_u32 s101, s96, 253952
    buffer_load_dwordx4 v[204:207], v237, s[16:19], s101 offen sc1
    v_mfma_f32_16x16x32_bf16 v[88:91], a[140:143], a[88:91], v[88:91]
    s_add_u32 s55, s96, 270336
    buffer_load_dwordx4 v[208:211], v237, s[16:19], s55 offen sc1
    v_mfma_f32_16x16x32_bf16 v[92:95], a[124:127], a[104:107], v[92:95]
    v_mul_f32 v67, v243, v67
    v_mul_f32 v68, v243, v68
    v_mfma_f32_16x16x32_bf16 v[92:95], a[144:147], a[88:91], v[92:95]
    v_mul_f32 v69, v243, v69
    v_mul_f32 v70, v243, v70
    s_waitcnt vmcnt(12)
    v_mfma_f32_16x16x32_bf16 v[16:19], a[240:243], a[108:111], v[16:19]
    v_mul_f32 v71, v243, v71
    v_mul_f32 v72, v243, v72
    s_waitcnt vmcnt(11)
    v_mfma_f32_16x16x32_bf16 v[16:19], a[92:95], a[96:99], v[16:19]
    s_add_u32 s101, s96, 286720
    buffer_load_dwordx4 v[212:215], v237, s[16:19], s101 offen sc1
    v_mfma_f32_16x16x32_bf16 v[20:23], a[244:247], a[108:111], v[20:23]
    v_mul_f32 v73, v243, v73
    v_mul_f32 v74, v243, v74
    v_mfma_f32_16x16x32_bf16 v[20:23], a[112:115], a[96:99], v[20:23]
    s_waitcnt vmcnt(9)
    v_max3_u32 v7, v192, v193, v194
    v_mfma_f32_16x16x32_bf16 v[24:27], a[248:251], a[108:111], v[24:27]
    v_max3_u32 v7, v7, v195, v196
    v_max3_u32 v7, v7, v197, v198
    v_mfma_f32_16x16x32_bf16 v[24:27], a[116:119], a[96:99], v[24:27]
    v_max3_u32 v7, v7, v199, v199
    v_cmp_eq_u32 vcc, -1, v7
    v_mfma_f32_16x16x32_bf16 v[28:31], a[252:255], a[108:111], v[28:31]
    s_add_u32 s101, s96, 253952
    buffer_load_dwordx4 v[216:219], v238, s[16:19], s101 offen sc1
    v_mfma_f32_16x16x32_bf16 v[28:31], a[140:143], a[96:99], v[28:31]
    s_cbranch_vccnz L_slow_12
L_back_13:
    v_mfma_f32_16x16x32_bf16 v[32:35], a[124:127], a[108:111], v[32:35]
    v_mul_f32 v75, v243, v75
    v_mul_f32 v76, v244, v76
    v_mfma_f32_16x16x32_bf16 v[32:35], a[144:147], a[96:99], v[32:35]
    buffer_load_dwordx4 v[220:223], v238, s[16:19], s55 offen sc1
    v_mul_f32 v77, v244, v77
    s_waitcnt lgkmcnt(9)
    v_mfma_f32_16x16x32_bf16 v[36:39], a[128:131], v[192:195], v[36:39]
    v_mul_f32 v78, v244, v78
    v_mul_f32 v79, v244, v79
    s_waitcnt lgkmcnt(8)
    v_mfma_f32_16x16x32_bf16 v[36:39], a[148:151], v[196:199], v[36:39]
    v_mul_f32 v80, v244, v80
    v_mul_f32 v81, v244, v81
    s_waitcnt lgkmcnt(7)
    v_mfma_f32_16x16x32_bf16 v[40:43], a[132:135], v[192:195], v[40:43]
    s_add_u32 s101, s96, 286720
    buffer_load_dwordx4 v[116:119], v238, s[16:19], s101 offen sc1
    s_waitcnt lgkmcnt(6)
    v_mfma_f32_16x16x32_bf16 v[40:43], a[152:155], v[196:199], v[40:43]
    s_waitcnt vmcnt(10)
    v_max3_u32 v7, v96, v97, v98
    s_waitcnt lgkmcnt(5)
    v_mfma_f32_16x16x32_bf16 v[44:47], a[136:139], v[192:195], v[44:47]
    v_max3_u32 v7, v7, v99, v100
    v_max3_u32 v7, v7, v101, v102
    s_waitcnt lgkmcnt(4)
    v_mfma_f32_16x16x32_bf16 v[44:47], a[156:159], v[196:199], v[44:47]
    s_add_u32 s100, s97, 317440
    buffer_load_dwordx4 a[180:183], v6, s[16:19], s100 offen offset:3072 sc1
    s_waitcnt lgkmcnt(3)
    v_mfma_f32_16x16x32_bf16 v[48:51], a[0:3], v[192:195], v[48:51]
    v_max3_u32 v7, v7, v103, v103
    v_cmp_eq_u32 vcc, -1, v7
    s_waitcnt lgkmcnt(2)
    v_mfma_f32_16x16x32_bf16 v[48:51], a[20:23], v[196:199], v[48:51]
    s_nop 1
    s_cbranch_vccnz L_slow_14
L_back_15:
    s_waitcnt lgkmcnt(1)
    v_mfma_f32_16x16x32_bf16 v[52:55], a[4:7], v[192:195], v[52:55]
    s_add_u32 s100, s97, 337920
    buffer_load_dwordx4 a[164:167], v6, s[16:19], s100 offen offset:3072 sc1
    s_waitcnt lgkmcnt(0)
    v_mfma_f32_16x16x32_bf16 v[52:55], a[160:163], v[196:199], v[52:55]
    v_mul_f32 v82, v244, v82
    v_mul_f32 v83, v244, v83
    v_mfma_f32_16x16x32_bf16 v[56:59], a[128:131], v[96:99], v[56:59]
    v_mul_f32 v84, v244, v84
    v_mul_f32 v85, v244, v85
    v_mfma_f32_16x16x32_bf16 v[56:59], a[148:151], v[100:103], v[56:59]
    v_mul_f32 v86, v244, v86
    v_mul_f32 v87, v244, v87
    v_mfma_f32_16x16x32_bf16 v[60:63], a[132:135], v[96:99], v[60:63]
    s_add_u32 s100, s97, 358400
    buffer_load_dwordx4 a[184:187], v6, s[16:19], s100 offen offset:3072 sc1
    v_mfma_f32_16x16x32_bf16 v[60:63], a[152:155], v[100:103], v[60:63]
    s_waitcnt vmcnt(11)
    v_max3_u32 v7, v104, v105, v106
    v_mfma_f32_16x16x32_bf16 v[64:67], a[136:139], v[96:99], v[64:67]
    v_max3_u32 v7, v7, v107, v108
    v_max3_u32 v7, v7, v109, v110
    v_mfma_f32_16x16x32_bf16 v[64:67], a[156:159], v[100:103], v[64:67]
    v_max3_u32 v7, v7, v111, v111
    v_cmp_eq_u32 vcc, -1, v7
    v_mfma_f32_16x16x32_bf16 v[68:71], a[0:3], v[96:99], v[68:71]
    ds_read_b128 a[168:171], v234 offset:16384
    s_nop 1
    s_cbranch_vccnz L_slow_16
L_back_17:
    v_mfma_f32_16x16x32_bf16 v[68:71], a[20:23], v[100:103], v[68:71]
    s_add_u32 s100, s97, 317440
    buffer_load_dwordx4 a[188:191], v240, s[16:19], s100 offen offset:0 sc1
    v_mfma_f32_16x16x32_bf16 v[72:75], a[4:7], v[96:99], v[72:75]
    v_mul_f32 v88, v244, v88
    v_mul_f32 v89, v244, v89
    v_mfma_f32_16x16x32_bf16 v[72:75], a[160:163], v[100:103], v[72:75]
    ds_read_b128 a[172:175], v234 offset:17408
    v_mul_f32 v90, v244, v90
    v_mfma_f32_16x16x32_bf16 v[76:79], a[128:131], v[104:107], v[76:79]
    s_add_u32 s100, s97, 337920
    buffer_load_dwordx4 a[192:195], v240, s[16:19], s100 offen offset:0 sc1
    v_mfma_f32_16x16x32_bf16 v[76:79], a[148:151], v[108:111], v[76:79]
    v_mul_f32 v91, v244, v91
    v_mul_f32 v92, v244, v92
    v_mfma_f32_16x16x32_bf16 v[80:83], a[132:135], v[104:107], v[80:83]
    v_mul_f32 v93, v244, v93
    v_mul_f32 v94, v244, v94
    v_mfma_f32_16x16x32_bf16 v[80:83], a[152:155], v[108:111], v[80:83]
    v_mul_f32 v95, v244, v95
    v_mul_f32 v16, v241, v16
    v_mfma_f32_16x16x32_bf16 v[84:87], a[136:139], v[104:107], v[84:87]
    s_add_u32 s100, s97, 358400
    buffer_load_dwordx4 a[24:27], v240, s[16:19], s100 offen offset:0 sc1
    v_mul_f32 v17, v241, v17
    v_mul_f32 v18, v241, v18
    v_mfma_f32_16x16x32_bf16 v[84:87], a[156:159], v[108:111], v[84:87]
    v_mul_f32 v19, v241, v19
    s_waitcnt vmcnt(12)
    v_mfma_f32_16x16x32_bf16 v[88:91], a[0:3], v[104:107], v[88:91]
    v_max3_u32 v7, v112, v113, v114
    v_max3_u32 v7, v7, v115, v200
    v_mfma_f32_16x16x32_bf16 v[88:91], a[20:23], v[108:111], v[88:91]
    v_max3_u32 v7, v7, v201, v202
    v_max3_u32 v7, v7, v203, v203
    v_mfma_f32_16x16x32_bf16 v[92:95], a[4:7], v[104:107], v[92:95]
    s_add_u32 s101, s96, 253952
    buffer_load_dwordx4 v[120:123], v239, s[16:19], s101 offen sc1
    v_cmp_eq_u32 vcc, -1, v7
    s_nop 3
    s_cbranch_vccnz L_slow_18
L_back_19:
    v_mfma_f32_16x16x32_bf16 v[92:95], a[160:163], v[108:111], v[92:95]
    v_mul_f32 v20, v241, v20
    v_mul_f32 v21, v241, v21
    v_mfma_f32_16x16x32_bf16 v[16:19], a[128:131], v[112:115], v[16:19]
    v_mul_f32 v22, v241, v22
    v_mul_f32 v23, v241, v23
    v_mfma_f32_16x16x32_bf16 v[16:19], a[148:151], v[200:203], v[16:19]
    buffer_load_dwordx4 v[124:127], v239, s[16:19], s55 offen sc1
    v_mul_f32 v24, v241, v24
    v_mul_f32 v25, v241, v25
    v_mfma_f32_16x16x32_bf16 v[20:23], a[132:135], v[112:115], v[20:23]
    v_mul_f32 v26, v241, v26
    v_mul_f32 v27, v241, v27
    v_mfma_f32_16x16x32_bf16 v[20:23], a[152:155], v[200:203], v[20:23]
    v_mul_f32 v28, v241, v28
    v_mul_f32 v29, v241, v29
    v_mul_f32 v30, v241, v30
    v_mul_f32 v31, v241, v31
    v_mul_f32 v32, v241, v32
    v_mfma_f32_16x16x32_bf16 v[24:27], a[136:139], v[112:115], v[24:27]
    s_add_u32 s101, s96, 286720
    buffer_load_dwordx4 v[128:131], v239, s[16:19], s101 offen sc1
    v_mul_f32 v33, v241, v33
    v_mul_f32 v34, v241, v34
    v_mfma_f32_16x16x32_bf16 v[24:27], a[156:159], v[200:203], v[24:27]
    v_mul_f32 v35, v241, v35
    s_waitcnt vmcnt(12)
    v_mfma_f32_16x16x32_bf16 v[28:31], a[0:3], v[112:115], v[28:31]
    v_max3_u32 v7, v204, v205, v206
    v_max3_u32 v7, v7, v207, v208
    v_mfma_f32_16x16x32_bf16 v[28:31], a[20:23], v[200:203], v[28:31]
    v_max3_u32 v7, v7, v209, v210
    v_max3_u32 v7, v7, v211, v212
    v_mfma_f32_16x16x32_bf16 v[32:35], a[4:7], v[112:115], v[32:35]
    s_add_u32 s101, s96, 253952
    buffer_load_dwordx4 v[132:135], v236, s[16:19], s101 offen sc1
    v_max3_u32 v7, v7, v213, v214
    v_max3_u32 v7, v7, v215, v215
    v_mfma_f32_16x16x32_bf16 v[32:35], a[160:163], v[200:203], v[32:35]
    v_cmp_eq_u32 vcc, -1, v7
    s_nop 3
    s_cbranch_vccnz L_slow_20
L_back_21:
    s_waitcnt lgkmcnt(1)
    v_mfma_f32_16x16x32_bf16 v[36:39], a[168:171], v[204:207], v[36:39]
    v_mfma_f32_16x16x32_bf16 v[36:39], a[28:31], v[208:211], v[36:39]
    buffer_load_dwordx4 v[136:139], v236, s[16:19], s55 offen sc1
    v_mfma_f32_16x16x32_bf16 v[36:39], a[12:15], v[212:215], v[36:39]
    s_waitcnt lgkmcnt(0)
    v_mfma_f32_16x16x32_bf16 v[40:43], a[172:175], v[204:207], v[40:43]
    v_mfma_f32_16x16x32_bf16 v[40:43], a[32:35], v[208:211], v[40:43]
    v_mfma_f32_16x16x32_bf16 v[40:43], a[16:19], v[212:215], v[40:43]
    s_add_u32 s101, s96, 286720
    buffer_load_dwordx4 v[140:143], v236, s[16:19], s101 offen sc1
    v_mfma_f32_16x16x32_bf16 v[44:47], a[36:39], v[204:207], v[44:47]
    s_nop 0
    ds_write_b128 v9, v[36:39] offset:0
    v_mfma_f32_16x16x32_bf16 v[44:47], a[40:43], v[208:211], v[44:47]
    v_mfma_f32_16x16x32_bf16 v[44:47], a[120:123], v[212:215], v[44:47]
    s_waitcnt vmcnt(12)
    v_max3_u32 v7, v216, v217, v218
    s_waitcnt vmcnt(11)
    v_mfma_f32_16x16x32_bf16 v[48:51], a[180:183], v[204:207], v[48:51]
    v_max3_u32 v7, v7, v219, v220
    v_max3_u32 v7, v7, v221, v222
    s_waitcnt vmcnt(10)
    v_mfma_f32_16x16x32_bf16 v[48:51], a[164:167], v[208:211], v[48:51]
    v_max3_u32 v7, v7, v223, v116
    v_max3_u32 v7, v7, v117, v118
    s_waitcnt vmcnt(9)
    v_mfma_f32_16x16x32_bf16 v[48:51], a[184:187], v[212:215], v[48:51]
    v_max3_u32 v7, v7, v119, v119
    v_cmp_eq_u32 vcc, -1, v7
    s_waitcnt vmcnt(8)
    v_mfma_f32_16x16x32_bf16 v[52:55], a[188:191], v[204:207], v[52:55]
    s_nop 1
    s_cbranch_vccnz L_slow_22
L_back_23:
    s_waitcnt vmcnt(7)
    v_mfma_f32_16x16x32_bf16 v[52:55], a[192:195], v[208:211], v[52:55]
    ds_write_b128 v9, v[40:43] offset:1024
    s_waitcnt vmcnt(6)
    v_mfma_f32_16x16x32_bf16 v[52:55], a[24:27], v[212:215], v[52:55]
    ds_write_b128 v9, v[44:47] offset:2048
    v_mfma_f32_16x16x32_bf16 v[56:59], a[168:171], v[216:219], v[56:59]
    ds_write_b128 v9, v[48:51] offset:3072
    v_mfma_f32_16x16x32_bf16 v[56:59], a[28:31], v[220:223], v[56:59]
    v_mfma_f32_16x16x32_bf16 v[56:59], a[12:15], v[116:119], v[56:59]
    s_nop 2
    ds_write_b128 v9, v[52:55] offset:4096
    v_mfma_f32_16x16x32_bf16 v[60:63], a[172:175], v[216:219], v[60:63]
    v_mfma_f32_16x16x32_bf16 v[60:63], a[32:35], v[220:223], v[60:63]
    v_mfma_f32_16x16x32_bf16 v[60:63], a[16:19], v[116:119], v[60:63]
    s_nop 0
    ds_write_b128 v10, v[56:59] offset:0
    v_mfma_f32_16x16x32_bf16 v[64:67], a[36:39], v[216:219], v[64:67]
    v_mfma_f32_16x16x32_bf16 v[64:67], a[40:43], v[220:223], v[64:67]
    v_mfma_f32_16x16x32_bf16 v[64:67], a[120:123], v[116:119], v[64:67]
    s_waitcnt vmcnt(3)
    v_max3_u32 v7, v120, v121, v122
    v_mfma_f32_16x16x32_bf16 v[68:71], a[180:183], v[216:219], v[68:71]
    v_max3_u32 v7, v7, v123, v124
    v_max3_u32 v7, v7, v125, v126
    v_mfma_f32_16x16x32_bf16 v[68:71], a[164:167], v[220:223], v[68:71]
    v_max3_u32 v7, v7, v127, v128
    v_max3_u32 v7, v7, v129, v130
    v_mfma_f32_16x16x32_bf16 v[68:71], a[184:187], v[116:119], v[68:71]
    v_max3_u32 v7, v7, v131, v131
    v_cmp_eq_u32 vcc, -1, v7
    v_mfma_f32_16x16x32_bf16 v[72:75], a[188:191], v[216:219], v[72:75]
    s_nop 2
    s_cbranch_vccnz L_slow_24
L_back_25:
    v_mfma_f32_16x16x32_bf16 v[72:75], a[192:195], v[220:223], v[72:75]
    ds_write_b128 v10, v[60:63] offset:1024
    v_mfma_f32_16x16x32_bf16 v[72:75], a[24:27], v[116:119], v[72:75]
    ds_write_b128 v10, v[64:67] offset:2048
    v_mfma_f32_16x16x32_bf16 v[76:79], a[168:171], v[120:123], v[76:79]
    ds_write_b128 v10, v[68:71] offset:3072
    v_mfma_f32_16x16x32_bf16 v[76:79], a[28:31], v[124:127], v[76:79]
    v_mfma_f32_16x16x32_bf16 v[76:79], a[12:15], v[128:131], v[76:79]
    s_nop 2
    ds_write_b128 v10, v[72:75] offset:4096
    v_mfma_f32_16x16x32_bf16 v[80:83], a[172:175], v[120:123], v[80:83]
    v_mfma_f32_16x16x32_bf16 v[80:83], a[32:35], v[124:127], v[80:83]
    v_mfma_f32_16x16x32_bf16 v[80:83], a[16:19], v[128:131], v[80:83]
    s_nop 0
    ds_write_b128 v11, v[76:79] offset:0
    v_mfma_f32_16x16x32_bf16 v[84:87], a[36:39], v[120:123], v[84:87]
    v_mfma_f32_16x16x32_bf16 v[84:87], a[40:43], v[124:127], v[84:87]
    v_mfma_f32_16x16x32_bf16 v[84:87], a[120:123], v[128:131], v[84:87]
    s_waitcnt vmcnt(0)
    v_max3_u32 v7, v132, v133, v134
    v_mfma_f32_16x16x32_bf16 v[88:91], a[180:183], v[120:123], v[88:91]
    v_max3_u32 v7, v7, v135, v136
    v_max3_u32 v7, v7, v137, v138
    v_mfma_f32_16x16x32_bf16 v[88:91], a[164:167], v[124:127], v[88:91]
    v_max3_u32 v7, v7, v139, v140
    v_max3_u32 v7, v7, v141, v142
    v_mfma_f32_16x16x32_bf16 v[88:91], a[184:187], v[128:131], v[88:91]
    v_max3_u32 v7, v7, v143, v143
    v_cmp_eq_u32 vcc, -1, v7
    v_mfma_f32_16x16x32_bf16 v[92:95], a[188:191], v[120:123], v[92:95]
    s_nop 2
    s_cbranch_vccnz L_slow_26
L_back_27:
    v_mfma_f32_16x16x32_bf16 v[92:95], a[192:195], v[124:127], v[92:95]
    ds_write_b128 v11, v[80:83] offset:1024
    v_mfma_f32_16x16x32_bf16 v[92:95], a[24:27], v[128:131], v[92:95]
    ds_write_b128 v11, v[84:87] offset:2048
    v_mfma_f32_16x16x32_bf16 v[16:19], a[168:171], v[132:135], v[16:19]
    ds_write_b128 v11, v[88:91] offset:3072
    v_mfma_f32_16x16x32_bf16 v[16:19], a[28:31], v[136:139], v[16:19]
    v_mfma_f32_16x16x32_bf16 v[16:19], a[12:15], v[140:143], v[16:19]
    s_nop 2
    ds_write_b128 v11, v[92:95] offset:4096
    v_mfma_f32_16x16x32_bf16 v[20:23], a[172:175], v[132:135], v[20:23]
    v_mfma_f32_16x16x32_bf16 v[20:23], a[32:35], v[136:139], v[20:23]
    v_mfma_f32_16x16x32_bf16 v[20:23], a[16:19], v[140:143], v[20:23]
    v_mfma_f32_16x16x32_bf16 v[24:27], a[36:39], v[132:135], v[24:27]
    v_mfma_f32_16x16x32_bf16 v[24:27], a[40:43], v[136:139], v[24:27]
    s_waitcnt lgkmcnt(0)
    s_barrier
    v_mfma_f32_16x16x32_bf16 v[24:27], a[120:123], v[140:143], v[24:27]
    ds_read_b128 v[36:39], v8 offset:0
    v_mfma_f32_16x16x32_bf16 v[28:31], a[180:183], v[132:135], v[28:31]
    ds_read_b128 v[40:43], v8 offset:5120
    v_mfma_f32_16x16x32_bf16 v[28:31], a[164:167], v[136:139], v[28:31]
    ds_read_b128 v[44:47], v8 offset:10240
    v_mfma_f32_16x16x32_bf16 v[28:31], a[184:187], v[140:143], v[28:31]
    ds_read_b128 v[48:51], v8 offset:1024
    v_mfma_f32_16x16x32_bf16 v[32:35], a[188:191], v[132:135], v[32:35]
    ds_read_b128 v[52:55], v8 offset:6144
    v_mfma_f32_16x16x32_bf16 v[32:35], a[192:195], v[136:139], v[32:35]
    ds_read_b128 v[56:59], v8 offset:11264
    v_mfma_f32_16x16x32_bf16 v[32:35], a[24:27], v[140:143], v[32:35]
    ds_read_b128 v[60:63], v8 offset:2048
    ds_read_b128 v[64:67], v8 offset:7168
    ds_read_b128 v[68:71], v8 offset:12288
    ds_read_b128 v[72:75], v8 offset:3072
    ds_read_b128 v[76:79], v8 offset:8192
    ds_read_b128 v[80:83], v8 offset:13312
    ds_read_b128 v[84:87], v8 offset:4096
    ds_read_b128 v[88:91], v8 offset:9216
    ds_read_b128 v[92:95], v8 offset:14336
    s_waitcnt lgkmcnt(12)
    v_pk_add_f32 v[16:17], v[16:17], v[36:37]
    v_pk_add_f32 v[18:19], v[18:19], v[38:39]
    v_pk_add_f32 v[40:41], v[40:41], v[44:45]
    v_pk_add_f32 v[42:43], v[42:43], v[46:47]
    v_pk_add_f32 v[16:17], v[16:17], v[40:41]
    v_pk_add_f32 v[18:19], v[18:19], v[42:43]
    v_cvt_pk_bf16_f32 v96, v16, v17
    v_cvt_pk_bf16_f32 v97, v18, v19
    s_waitcnt lgkmcnt(9)
    v_pk_add_f32 v[20:21], v[20:21], v[48:49]
    v_pk_add_f32 v[22:23], v[22:23], v[50:51]
    v_pk_add_f32 v[52:53], v[52:53], v[56:57]
    v_pk_add_f32 v[54:55], v[54:55], v[58:59]
    v_pk_add_f32 v[20:21], v[20:21], v[52:53]
    v_pk_add_f32 v[22:23], v[22:23], v[54:55]
    v_cvt_pk_bf16_f32 v98, v20, v21
    v_cvt_pk_bf16_f32 v99, v22, v23
    buffer_store_dwordx4 v[96:99], v12, s[20:23], s77 offen sc1 nt
    s_waitcnt lgkmcnt(6)
    v_pk_add_f32 v[24:25], v[24:25], v[60:61]
    v_pk_add_f32 v[26:27], v[26:27], v[62:63]
    v_pk_add_f32 v[64:65], v[64:65], v[68:69]
    v_pk_add_f32 v[66:67], v[66:67], v[70:71]
    v_pk_add_f32 v[24:25], v[24:25], v[64:65]
    v_pk_add_f32 v[26:27], v[26:27], v[66:67]
    v_cvt_pk_bf16_f32 v100, v24, v25
    v_cvt_pk_bf16_f32 v101, v26, v27
    s_waitcnt lgkmcnt(3)
    v_pk_add_f32 v[28:29], v[28:29], v[72:73]
    v_pk_add_f32 v[30:31], v[30:31], v[74:75]
    v_pk_add_f32 v[76:77], v[76:77], v[80:81]
    v_pk_add_f32 v[78:79], v[78:79], v[82:83]
    v_pk_add_f32 v[28:29], v[28:29], v[76:77]
    v_pk_add_f32 v[30:31], v[30:31], v[78:79]
    v_cvt_pk_bf16_f32 v102, v28, v29
    v_cvt_pk_bf16_f32 v103, v30, v31
    buffer_store_dwordx4 v[100:103], v12, s[20:23], s77 offen offset:64 sc1 nt
    s_waitcnt lgkmcnt(0)
    v_pk_add_f32 v[32:33], v[32:33], v[84:85]
    v_pk_add_f32 v[34:35], v[34:35], v[86:87]
    v_pk_add_f32 v[88:89], v[88:89], v[92:93]
    v_pk_add_f32 v[90:91], v[90:91], v[94:95]
    v_pk_add_f32 v[32:33], v[32:33], v[88:89]
    v_pk_add_f32 v[34:35], v[34:35], v[90:91]
    v_cvt_pk_bf16_f32 v104, v32, v33
    v_cvt_pk_bf16_f32 v105, v34, v35
    buffer_store_dwordx2 v[104:105], v13, s[20:23], s76 offen sc1 nt
    s_endpgm
L_QH:
    s_mul_i32 s89, s61, 320
    s_lshl_b32 s74, s61, 8
    s_add_u32 s74, s74, 384
    s_cmp_lt_u32 s61, 6
    s_cselect_b32 s89, s89, s74
    s_cselect_b32 s90, 20, 16
    s_mul_i32 s76, s3, 320
    s_waitcnt lgkmcnt(0)
    s_load_dwordx2 s[58:59], s[56:57], 0
    s_mov_b32 s4, s32
    s_and_b32 s5, s33, 0xffff
    s_mov_b32 s24, s44
    s_and_b32 s25, s45, 0xffff
    s_mov_b32 s8, s34
    s_and_b32 s9, s35, 0xffff
    s_mov_b32 s12, s42
    s_and_b32 s13, s43, 0xffff
    s_add_u32 m0, s80, 0
    s_nop 0
    buffer_load_dwordx4 v208, s[4:7], s64 offen offset:0  lds
    buffer_load_dwordx4 v209, s[4:7], s64 offen offset:1024  lds
    buffer_load_dwordx4 v210, s[4:7], s64 offen offset:2048  lds
    buffer_load_dwordx4 v211, s[4:7], s64 offen offset:3072  lds
    s_add_u32 m0, s76, 160896
    s_mov_b64 exec, 0xfffff
    buffer_load_dwordx4 v6, s[24:27], s89 offen lds
    s_mov_b64 exec, -1
    s_mul_i32 s74, s3, 3
    s_lshl_b32 s75, s3, 1
    s_add_u32 s75, s75, 2
    s_cmp_lt_u32 s3, 2
    s_cselect_b32 s74, s74, s75
    s_lshl_b32 s81, s74, 10
    s_add_u32 s81, s81, 16384
    s_add_u32 s83, s81, 2048
    s_cmp_lt_u32 s3, 2
    s_cselect_b32 s83, s83, 162304
    s_add_u32 s84, s81, 49152
    s_cmp_lt_u32 s3, 2
    s_cselect_b32 s84, s84, 162304
    s_add_u32 s85, s81, 96256
    s_cmp_lt_u32 s3, 2
    s_cselect_b32 s85, s85, 162304
    s_lshl_b32 s74, s74, 6
    s_mul_i32 s75, s61, 160
    s_mul_i32 s82, s3, 5120
    s_add_u32 s82, s82, 26624
    v_add_u32 v9, 0, v0
    v_add_u32 v9, s74, v9
    v_mul_u32_u24 v10, 6554, v9
    v_lshrrev_b32 v10, 16, v10
    v_mad_i32_i24 v11, v10, -10, v9
    v_lshrrev_b32 v12, 1, v10
    v_xor_b32 v12, v12, v10
    v_and_b32 v12, 4, v12
    v_mul_u32_u24 v12, 3, v12
    v_xor_b32 v10, v10, v12
    v_mul_u32_u24 v10, 3840, v10
    v_lshl_add_u32 v10, v11, 4, v10
    v_add_u32 v212, s75, v10
    s_mul_i32 s0, s64, 1920
    s_add_u32 m0, s81, 0
    s_nop 0
    buffer_load_dwordx4 v212, s[8:11], s0 offen offset:0  lds
    v_add_u32 v9, 64, v0
    v_add_u32 v9, s74, v9
    v_mul_u32_u24 v10, 6554, v9
    v_lshrrev_b32 v10, 16, v10
    v_mad_i32_i24 v11, v10, -10, v9
    v_lshrrev_b32 v12, 1, v10
    v_xor_b32 v12, v12, v10
    v_and_b32 v12, 4, v12
    v_mul_u32_u24 v12, 3, v12
    v_xor_b32 v10, v10, v12
    v_mul_u32_u24 v10, 3840, v10
    v_lshl_add_u32 v10, v11, 4, v10
    v_add_u32 v213, s75, v10
    v_subrev_u32 v213, 1024, v213
    buffer_load_dwordx4 v213, s[8:11], s0 offen offset:1024  lds
    v_add_u32 v9, 128, v0
    v_add_u32 v9, s74, v9
    v_mul_u32_u24 v10, 6554, v9
    v_lshrrev_b32 v10, 16, v10
    v_mad_i32_i24 v11, v10, -10, v9
    v_lshrrev_b32 v12, 1, v10
    v_xor_b32 v12, v12, v10
    v_and_b32 v12, 4, v12
    v_mul_u32_u24 v12, 3, v12
    v_xor_b32 v10, v10, v12
    v_mul_u32_u24 v10, 3840, v10
    v_lshl_add_u32 v10, v11, 4, v10
    v_add_u32 v214, s75, v10
    s_cmp_lt_u32 s3, 2
    s_cselect_b32 s78, 0, 2146435072
    v_add_u32 v214, s78, v214
    s_mov_b32 m0, s83
    s_nop 0
    buffer_load_dwordx4 v214, s[8:11], s0 offen offset:0  lds
    s_mul_i32 s74, s3, 320
    v_mov_b32 v14, 2146435072
    v_add_u32 v9, 0, v0
    v_add_u32 v9, s74, v9
    v_mul_u32_u24 v10, 3277, v9
    v_lshrrev_b32 v10, 16, v10
    v_mul_u32_u24 v11, 20, v10
    v_sub_u32 v11, v9, v11
    v_bfe_u32 v13, v10, 2, 1
    v_lshlrev_b32 v13, 1, v13
    v_xor_b32 v11, v11, v13
    v_cmp_gt_u32 vcc, s90, v11
    v_lshrrev_b32 v12, 1, v10
    v_xor_b32 v12, v12, v10
    v_and_b32 v12, 4, v12
    v_mul_u32_u24 v12, 3, v12
    v_xor_b32 v10, v10, v12
    v_mul_u32_u24 v10, 3456, v10
    v_lshl_add_u32 v10, v11, 4, v10
    v_add_u32 v10, s89, v10
    v_subrev_u32 v10, 0, v10
    v_cndmask_b32 v215, v14, v10, vcc
    s_mul_i32 s1, s64, 1728
    s_add_u32 m0, s82, 0
    s_nop 0
    buffer_load_dwordx4 v215, s[12:15], s1 offen offset:0  lds
    v_add_u32 v9, 64, v0
    v_add_u32 v9, s74, v9
    v_mul_u32_u24 v10, 3277, v9
    v_lshrrev_b32 v10, 16, v10
    v_mul_u32_u24 v11, 20, v10
    v_sub_u32 v11, v9, v11
    v_bfe_u32 v13, v10, 2, 1
    v_lshlrev_b32 v13, 1, v13
    v_xor_b32 v11, v11, v13
    v_cmp_gt_u32 vcc, s90, v11
    v_lshrrev_b32 v12, 1, v10
    v_xor_b32 v12, v12, v10
    v_and_b32 v12, 4, v12
    v_mul_u32_u24 v12, 3, v12
    v_xor_b32 v10, v10, v12
    v_mul_u32_u24 v10, 3456, v10
    v_lshl_add_u32 v10, v11, 4, v10
    v_add_u32 v10, s89, v10
    v_subrev_u32 v10, 1024, v10
    v_cndmask_b32 v216, v14, v10, vcc
    buffer_load_dwordx4 v216, s[12:15], s1 offen offset:1024  lds
    v_add_u32 v9, 128, v0
    v_add_u32 v9, s74, v9
    v_mul_u32_u24 v10, 3277, v9
    v_lshrrev_b32 v10, 16, v10
    v_mul_u32_u24 v11, 20, v10
    v_sub_u32 v11, v9, v11
    v_bfe_u32 v13, v10, 2, 1
    v_lshlrev_b32 v13, 1, v13
    v_xor_b32 v11, v11, v13
    v_cmp_gt_u32 vcc, s90, v11
    v_lshrrev_b32 v12, 1, v10
    v_xor_b32 v12, v12, v10
    v_and_b32 v12, 4, v12
    v_mul_u32_u24 v12, 3, v12
    v_xor_b32 v10, v10, v12
    v_mul_u32_u24 v10, 3456, v10
    v_lshl_add_u32 v10, v11, 4, v10
    v_add_u32 v10, s89, v10
    v_subrev_u32 v10, 2048, v10
    v_cndmask_b32 v217, v14, v10, vcc
    buffer_load_dwordx4 v217, s[12:15], s1 offen offset:2048  lds
    v_add_u32 v9, 192, v0
    v_add_u32 v9, s74, v9
    v_mul_u32_u24 v10, 3277, v9
    v_lshrrev_b32 v10, 16, v10
    v_mul_u32_u24 v11, 20, v10
    v_sub_u32 v11, v9, v11
    v_bfe_u32 v13, v10, 2, 1
    v_lshlrev_b32 v13, 1, v13
    v_xor_b32 v11, v11, v13
    v_cmp_gt_u32 vcc, s90, v11
    v_lshrrev_b32 v12, 1, v10
    v_xor_b32 v12, v12, v10
    v_and_b32 v12, 4, v12
    v_mul_u32_u24 v12, 3, v12
    v_xor_b32 v10, v10, v12
    v_mul_u32_u24 v10, 3456, v10
    v_lshl_add_u32 v10, v11, 4, v10
    v_add_u32 v10, s89, v10
    v_subrev_u32 v10, 3072, v10
    v_cndmask_b32 v218, v14, v10, vcc
    buffer_load_dwordx4 v218, s[12:15], s1 offen offset:3072  lds
    v_add_u32 v9, 256, v0
    v_add_u32 v9, s74, v9
    v_mul_u32_u24 v10, 3277, v9
    v_lshrrev_b32 v10, 16, v10
    v_mul_u32_u24 v11, 20, v10
    v_sub_u32 v11, v9, v11
    v_bfe_u32 v13, v10, 2, 1
    v_lshlrev_b32 v13, 1, v13
    v_xor_b32 v11, v11, v13
    v_cmp_gt_u32 vcc, s90, v11
    v_lshrrev_b32 v12, 1, v10
    v_xor_b32 v12, v12, v10
    v_and_b32 v12, 4, v12
    v_mul_u32_u24 v12, 3, v12
    v_xor_b32 v10, v10, v12
    v_mul_u32_u24 v10, 3456, v10
    v_lshl_add_u32 v10, v11, 4, v10
    v_add_u32 v10, s89, v10
    v_subrev_u32 v10, 0, v10
    v_cndmask_b32 v219, v14, v10, vcc
    s_add_u32 m0, m0, 4096
    s_nop 0
    buffer_load_dwordx4 v219, s[12:15], s1 offen offset:0  lds
    s_cmp_eq_u32 s3, 0
    s_cselect_b64 s[28:29], s[4:5], s[12:13]
    s_cselect_b32 s30, s6, s14
    s_cselect_b32 s74, 12, 0
    s_add_u32 s74, s74, 68
    s_cmp_eq_u32 s3, 1
    s_cselect_b64 s[28:29], s[8:9], s[28:29]
    s_cselect_b32 s30, s10, s30
    s_cselect_b32 s74, 75, s74
    s_lshl_b32 s75, 1, s3
    s_and_b32 s75, s75, 7
    s_cselect_b32 s30, s30, 0
    s_mov_b32 s31, 0x20000
    s_mul_i32 s75, s74, s2
    s_lshl_b32 s75, s75, 7
    v_lshlrev_b32 v10, 7, v0
    v_add_u32 v11, 64, v0
    v_cmp_gt_u32 vcc, s74, v11
    v_lshlrev_b32 v11, 7, v11
    v_mov_b32 v14, 2146435072
    v_cndmask_b32 v11, v14, v11, vcc
    buffer_load_dword v255, v10, s[28:31], s75 offen
    buffer_load_dword v255, v11, s[28:31], s75 offen
    v_lshrrev_b32 v9, 1, v1
    v_xor_b32 v9, v9, v2
    v_lshlrev_b32 v9, 4, v9
    v_lshl_add_u32 v9, v1, 7, v9
    v_add_u32 v220, s80, v9
    v_xor_b32 v221, 64, v220
    v_add_u32 v222, 47104, v220
    v_add_u32 v223, 47104, v221
    v_add_u32 v224, 94208, v220
    v_add_u32 v225, 94208, v221
    v_lshrrev_b32 v8, 1, v2
    v_lshl_add_u32 v8, v8, 4, v3
    v_and_b32 v7, 1, v2
    v_lshl_add_u32 v8, v7, 2, v8
    v_mul_u32_u24 v9, 160, v8
    v_mad_u32_u24 v9, v4, 40, v9
    v_add_u32 v226, 16384, v9
    v_mul_u32_u24 v9, 320, v8
    v_lshl_add_u32 v9, v4, 3, v9
    v_add_u32 v9, 26624, v9
    v_lshl_add_u32 v229, v7, 5, v9
    v_xor_b32 v7, 1, v7
    v_lshl_add_u32 v232, v7, 5, v9
    v_add_u32 v227, 47104, v226
    v_add_u32 v230, 47104, v229
    v_add_u32 v233, 47104, v232
    v_add_u32 v228, 94208, v226
    v_add_u32 v231, 94208, v229
    v_add_u32 v234, 94208, v232
    s_and_b32 s74, s2, 7
    s_lshr_b32 s75, s2, 3
    s_lshr_b32 s76, s74, 1
    s_and_b32 s77, s75, 3
    s_lshr_b32 s78, s75, 2
    s_lshr_b32 s79, s75, 2
    s_and_b32 s79, s79, 4
    s_xor_b32 s79, s79, s75
    s_and_b32 s62, s79, 7
    s_bfe_u32 s79, s75, 0x20002
    s_lshl_b32 s76, s76, 3
    s_add_u32 s62, s62, s76
    s_and_b32 s63, s74, 1
    s_lshl_b32 s63, s63, 2
    s_add_u32 s63, s63, s79
    s_mov_b32 s16, s56
    s_and_b32 s17, s57, 0xffff
    s_mov_b32 s18, 268435456
    s_mov_b32 s19, 0x20000
    s_mov_b32 s24, s36
    s_and_b32 s25, s37, 0xffff
    s_mov_b32 s26, 25600
    s_mov_b32 s27, 0x20000
    s_lshl_b32 s77, s61, 2
    s_add_u32 s77, s77, s3
    s_mul_i32 s36, s77, 800
    s_mul_i32 s37, s3, 800
    s_add_u32 s37, s37, 157696
    s_add_u32 s66, s64, 256
    s_add_u32 s67, s65, 256
    s_add_u32 s68, s66, 256
    s_add_u32 s69, s67, 256
    s_add_u32 s70, s68, 256
    s_add_u32 s71, s69, 256
    s_add_u32 s72, s70, 256
    s_add_u32 s73, s71, 256
    s_mul_i32 s97, s63, 74
    s_add_u32 s97, s97, s3
    s_mul_i32 s97, s97, 5120
    s_add_u32 s97, s97, 3145728
    s_mul_i32 s96, s62, 74
    s_add_u32 s96, s96, s3
    s_lshl_b32 s96, s96, 12
    s_add_u32 s96, s96, 6291456
    s_add_u32 s86, s97, 184320
    s_add_u32 s87, s96, 147456
    s_cmp_lt_u32 s3, 2
    s_cselect_b32 s86, s86, 2146435072
    s_cselect_b32 s87, s87, 2146435072
    s_mul_i32 s88, s3, 18432
    v_add_u32 v240, 4096, v6
    s_add_u32 s77, s3, 0
    s_and_b32 s77, s77, 3
    s_lshl_b32 s77, s77, 10
    v_add_u32 v236, s77, v6
    s_add_u32 s77, s3, 1
    s_and_b32 s77, s77, 3
    s_lshl_b32 s77, s77, 10
    v_add_u32 v237, s77, v6
    s_add_u32 s77, s3, 2
    s_and_b32 s77, s77, 3
    s_lshl_b32 s77, s77, 10
    v_add_u32 v238, s77, v6
    s_add_u32 s77, s3, 3
    s_and_b32 s77, s77, 3
    s_lshl_b32 s77, s77, 10
    v_add_u32 v239, s77, v6
    s_lshl_b32 s91, s2, 7
    s_add_u32 s91, s91, 98304
    s_cmp_eq_u32 s3, 0
    s_cselect_b32 s91, s91, 2146435072
    v_mov_b32 v245, 2146435072
    v_cmp_eq_u32 vcc, 0, v0
    s_nop 1
    v_cndmask_b32 v245, v245, 0, vcc
    s_lshl_b32 s74, s2, 2
    s_add_u32 s74, s74, s3
    s_mul_i32 s76, s74, 886
    s_lshr_b32 s76, s76, 16
    s_mul_i32 s75, s76, 74
    s_sub_u32 s75, s74, s75
    s_sub_u32 s77, s75, 54
    s_and_b32 s77, s77, 63
    s_mul_i32 s78, s77, 52
    s_lshr_b32 s78, s78, 8
    s_mul_i32 s79, s78, 5
    s_sub_u32 s79, s77, s79
    s_mul_i32 s100, s78, 160
    s_lshr_b32 s101, s79, 1
    s_mul_i32 s101, s101, 80
    s_and_b32 s77, s79, 1
    s_lshl_b32 s77, s77, 3
    s_add_u32 s101, s101, s77
    s_cmp_eq_u32 s79, 4
    s_cselect_b32 s101, 16, s101
    s_cselect_b32 s77, 80, 4
    s_add_u32 s100, s100, s101
    s_lshl_b32 s101, s75, 5
    s_cmp_lt_u32 s75, 54
    s_cselect_b32 s100, s101, s100
    s_cselect_b32 s77, 16, s77
    s_mov_b32 s78, 24576
    s_cselect_b32 s78, 4096, s78
    s_mov_b32 s22, 819200
    s_cselect_b32 s22, 2211840, s22
    s_mov_b32 s23, 0x20000
    s_cmp_lt_u32 s74, 740
    s_cselect_b32 s22, s22, 0
    s_mul_i32 s100, s100, 1280
    s_lshl_b32 s101, s76, 7
    s_add_u32 s32, s100, s101
    s_add_u32 s33, s32, s78
    s_add_u32 s34, s33, s78
    s_add_u32 s35, s34, s78
    v_lshrrev_b32 v9, 5, v0
    v_mul_lo_u32 v9, v9, s77
    v_and_b32 v10, 3, v5
    v_add_u32 v9, v9, v10
    v_mul_u32_u24 v9, 1280, v9
    v_and_b32 v10, 7, v0
    v_lshl_add_u32 v252, v10, 4, v9
    v_lshlrev_b32 v9, 10, v2
    v_lshl_add_u32 v9, v3, 7, v9
    v_add_u32 v9, s80, v9
    v_add_u32 v9, 141312, v9
    s_lshl_b32 s77, s76, 1
    s_add_u32 s77, s77, 0
    s_mul_i32 s78, s77, 52
    s_lshr_b32 s78, s78, 8
    s_mul_i32 s79, s78, 5
    s_sub_u32 s79, s77, s79
    s_cmp_eq_u32 s79, 2
    s_cselect_b32 s77, 3, 4
    s_cselect_b32 s101, 32, 8
    v_lshlrev_b32 v10, s77, v4
    v_add_u32 v200, v9, v10
    v_add_u32 v201, s101, v200
    s_mul_i32 s78, s78, 740
    s_mul_i32 s101, s75, 5
    s_add_u32 s78, s78, s101
    s_lshl_b32 s77, s79, 1
    s_add_u32 s77, s77, 0
    s_add_u32 s92, s77, 364
    s_cmp_eq_u32 s77, 5
    s_cselect_b32 s92, 374, s92
    s_cmp_lt_u32 s77, 5
    s_cselect_b32 s92, s77, s92
    s_add_u32 s92, s92, s78
    s_lshl_b32 s92, s92, 10
    s_add_u32 s92, s92, 3145728
    s_cmp_lt_u32 s74, 740
    s_cselect_b32 s92, s92, 2146435072
    s_lshl_b32 s77, s79, 1
    s_add_u32 s77, s77, 1
    s_add_u32 s93, s77, 364
    s_cmp_eq_u32 s77, 5
    s_cselect_b32 s93, 374, s93
    s_cmp_lt_u32 s77, 5
    s_cselect_b32 s93, s77, s93
    s_add_u32 s93, s93, s78
    s_lshl_b32 s93, s93, 10
    s_add_u32 s93, s93, 3145728
    s_cmp_lt_u32 s74, 740
    s_cselect_b32 s93, s93, 2146435072
    s_lshl_b32 s77, s76, 1
    s_add_u32 s77, s77, 1
    s_mul_i32 s78, s77, 52
    s_lshr_b32 s78, s78, 8
    s_mul_i32 s79, s78, 5
    s_sub_u32 s79, s77, s79
    s_cmp_eq_u32 s79, 2
    s_cselect_b32 s77, 3, 4
    s_cselect_b32 s101, 32, 8
    v_lshlrev_b32 v10, s77, v4
    v_add_u32 v202, v9, v10
    v_add_u32 v203, s101, v202
    s_mul_i32 s78, s78, 740
    s_mul_i32 s101, s75, 5
    s_add_u32 s78, s78, s101
    s_lshl_b32 s77, s79, 1
    s_add_u32 s77, s77, 0
    s_add_u32 s94, s77, 364
    s_cmp_eq_u32 s77, 5
    s_cselect_b32 s94, 374, s94
    s_cmp_lt_u32 s77, 5
    s_cselect_b32 s94, s77, s94
    s_add_u32 s94, s94, s78
    s_lshl_b32 s94, s94, 10
    s_add_u32 s94, s94, 3145728
    s_cmp_lt_u32 s74, 740
    s_cselect_b32 s94, s94, 2146435072
    s_lshl_b32 s77, s79, 1
    s_add_u32 s77, s77, 1
    s_add_u32 s95, s77, 364
    s_cmp_eq_u32 s77, 5
    s_cselect_b32 s95, 374, s95
    s_cmp_lt_u32 s77, 5
    s_cselect_b32 s95, s77, s95
    s_add_u32 s95, s95, s78
    s_lshl_b32 s95, s95, 10
    s_add_u32 s95, s95, 3145728
    s_cmp_lt_u32 s74, 740
    s_cselect_b32 s95, s95, 2146435072
    s_cmp_lt_u32 s75, 54
    s_cselect_b32 s20, s46, s38
    s_cselect_b32 s21, s47, s39
    s_and_b32 s21, s21, 0xffff
    s_mul_i32 s75, s3, 320
    s_add_u32 s75, s75, 160896
    v_lshl_add_u32 v13, v2, 3, s75
    s_lshl_b32 s74, s60, 1
    s_lshr_b32 s75, s3, 1
    s_add_u32 s74, s74, s75
    s_and_b32 s75, s3, 1
    s_mul_i32 s76, s74, 74
    s_lshl_b32 s76, s76, 12
    s_lshl_b32 s77, s75, 11
    s_add_u32 s76, s76, s77
    s_add_u32 s76, s76, 6291456
    s_lshr_b32 s78, s61, 1
    s_mul_i32 s78, s78, 5
    s_add_u32 s78, s78, 54
    s_lshl_b32 s78, s78, 12
    s_add_u32 s78, s78, s76
    s_and_b32 s79, s61, 1
    s_lshl_b32 s38, s79, 13
    s_add_u32 s38, s38, s78
    s_add_u32 s39, s78, 16384
    s_lshl_b32 s79, s79, 3
    s_add_u32 s39, s39, s79
    s_lshl_b32 s74, s61, 4
    s_add_u32 s74, s74, s60
    s_lshl_b32 s74, s74, 2
    s_add_u32 s74, s74, s3
    s_lshl_b32 s74, s74, 9
    s_add_u32 s43, s74, 2621440
    v_mov_b32 v204, -1
    v_mov_b32 v205, -1
    v_mov_b32 v206, -1
    v_mov_b32 v207, -1
    s_waitcnt lgkmcnt(0)
    s_add_u32 s58, s58, 1
    v_mov_b32 v247, s59
    v_mov_b32 v246, s58
    s_movk_i32 s42, 1023
    s_waitcnt vmcnt(10)
    ds_read_b64 v[136:137], v13 offset:0
    ds_read_b64 v[138:139], v13 offset:32
    ds_read_b64 v[140:141], v13 offset:64
    ds_read_b64 v[142:143], v13 offset:96
    ds_read_b64 v[144:145], v13 offset:128
    ds_read_b64 v[146:147], v13 offset:160
    ds_read_b64 v[148:149], v13 offset:192
    ds_read_b64 v[150:151], v13 offset:224
    ds_read_b64 v[152:153], v13 offset:256
    ds_read_b64 v[154:155], v13 offset:288
    s_waitcnt lgkmcnt(9)
    v_lshlrev_b32 v56, 16, v136
    v_and_b32 v57, 0xffff0000, v136
    v_lshlrev_b32 v58, 16, v137
    v_and_b32 v59, 0xffff0000, v137
    s_waitcnt lgkmcnt(8)
    v_lshlrev_b32 v64, 16, v138
    v_and_b32 v65, 0xffff0000, v138
    v_lshlrev_b32 v66, 16, v139
    v_and_b32 v67, 0xffff0000, v139
    s_waitcnt lgkmcnt(7)
    v_lshlrev_b32 v72, 16, v140
    v_and_b32 v73, 0xffff0000, v140
    v_lshlrev_b32 v74, 16, v141
    v_and_b32 v75, 0xffff0000, v141
    s_waitcnt lgkmcnt(6)
    v_lshlrev_b32 v80, 16, v142
    v_and_b32 v81, 0xffff0000, v142
    v_lshlrev_b32 v82, 16, v143
    v_and_b32 v83, 0xffff0000, v143
    s_waitcnt lgkmcnt(5)
    v_lshlrev_b32 v88, 16, v144
    v_and_b32 v89, 0xffff0000, v144
    v_lshlrev_b32 v90, 16, v145
    v_and_b32 v91, 0xffff0000, v145
    s_waitcnt lgkmcnt(4)
    v_lshlrev_b32 v96, 16, v146
    v_and_b32 v97, 0xffff0000, v146
    v_lshlrev_b32 v98, 16, v147
    v_and_b32 v99, 0xffff0000, v147
    s_waitcnt lgkmcnt(3)
    v_lshlrev_b32 v104, 16, v148
    v_and_b32 v105, 0xffff0000, v148
    v_lshlrev_b32 v106, 16, v149
    v_and_b32 v107, 0xffff0000, v149
    s_waitcnt lgkmcnt(2)
    v_lshlrev_b32 v112, 16, v150
    v_and_b32 v113, 0xffff0000, v150
    v_lshlrev_b32 v114, 16, v151
    v_and_b32 v115, 0xffff0000, v151
    s_waitcnt lgkmcnt(1)
    v_lshlrev_b32 v120, 16, v152
    v_and_b32 v121, 0xffff0000, v152
    v_lshlrev_b32 v122, 16, v153
    v_and_b32 v123, 0xffff0000, v153
    s_waitcnt lgkmcnt(0)
    v_lshlrev_b32 v128, 16, v154
    v_and_b32 v129, 0xffff0000, v154
    v_lshlrev_b32 v130, 16, v155
    v_and_b32 v131, 0xffff0000, v155
    v_mul_u32_u24 v254, 800, v2
    v_mad_u32_u24 v254, v3, 40, v254
    v_add_u32 v254, 157696, v254
    s_waitcnt vmcnt(2)
    s_barrier
    ds_read_b64_tr_b16 v[168:169], v226 offset:0
    ds_read_b64_tr_b16 v[170:171], v226 offset:1280
    ds_read_b64_tr_b16 v[172:173], v226 offset:5120
    ds_read_b64_tr_b16 v[174:175], v226 offset:6400
    ds_read_b128 v[144:147], v220 offset:2048
    ds_read_b128 v[148:151], v221 offset:2048
    ds_read_b128 v[136:139], v220 offset:0
    ds_read_b128 v[140:143], v221 offset:0
    ds_read_b64_tr_b16 v[176:177], v226 offset:8
    ds_read_b64_tr_b16 v[178:179], v226 offset:1288
    ds_read_b64_tr_b16 v[180:181], v226 offset:5128
    ds_read_b64_tr_b16 v[182:183], v226 offset:6408
    s_waitcnt lgkmcnt(7)
    v_mfma_f32_16x16x32_bf16 v[20:23], v[168:171], v[144:147], 0
    ds_read_b64_tr_b16 v[184:185], v226 offset:16
    s_waitcnt lgkmcnt(7)
    v_mfma_f32_16x16x32_bf16 v[20:23], v[172:175], v[148:151], v[20:23]
    ds_read_b64_tr_b16 v[186:187], v226 offset:1296
    s_waitcnt lgkmcnt(7)
    v_mfma_f32_16x16x32_bf16 v[16:19], v[168:171], v[136:139], 0
    ds_read_b64_tr_b16 v[188:189], v226 offset:5136
    s_add_u32 m0, s80, 47104
    s_waitcnt lgkmcnt(7)
    v_mfma_f32_16x16x32_bf16 v[16:19], v[172:175], v[140:143], v[16:19]
    buffer_load_dwordx4 v208, s[4:7], s65 offen offset:0  lds
    s_waitcnt lgkmcnt(3)
    v_mfma_f32_16x16x32_bf16 v[28:31], v[176:179], v[144:147], 0
    buffer_load_dwordx4 v209, s[4:7], s65 offen offset:1024  lds
    ds_read_b64_tr_b16 v[190:191], v226 offset:6416
    v_mfma_f32_16x16x32_bf16 v[28:31], v[180:183], v[148:151], v[28:31]
    ds_read_b64_tr_b16 v[192:193], v226 offset:24
    ds_read_b64_tr_b16 v[194:195], v226 offset:1304
    v_mfma_f32_16x16x32_bf16 v[24:27], v[176:179], v[136:139], 0
    buffer_load_dwordx4 v210, s[4:7], s65 offen offset:2048  lds
    ds_read_b64_tr_b16 v[196:197], v226 offset:5144
    v_mfma_f32_16x16x32_bf16 v[24:27], v[180:183], v[140:143], v[24:27]
    ds_read_b64_tr_b16 v[198:199], v226 offset:6424
    s_waitcnt lgkmcnt(4)
    v_mfma_f32_16x16x32_bf16 v[36:39], v[184:187], v[144:147], 0
    buffer_load_dwordx4 v211, s[4:7], s65 offen offset:3072  lds
    ds_read_b64_tr_b16 v[168:169], v226 offset:32
    v_mfma_f32_16x16x32_bf16 v[36:39], v[188:191], v[148:151], v[36:39]
    ds_read_b64_tr_b16 v[170:171], v226 offset:1312
    ds_read_b64_tr_b16 v[172:173], v226 offset:5152
    v_mfma_f32_16x16x32_bf16 v[32:35], v[184:187], v[136:139], 0
    ds_read_b64_tr_b16 v[174:175], v226 offset:6432
    s_mul_i32 s0, s65, 1920
    v_mfma_f32_16x16x32_bf16 v[32:35], v[188:191], v[140:143], v[32:35]
    ds_read_b64_tr_b16 v[176:177], v229 offset:0
    s_waitcnt lgkmcnt(5)
    v_mfma_f32_16x16x32_bf16 v[44:47], v[192:195], v[144:147], 0
    ds_read_b64_tr_b16 v[178:179], v229 offset:2560
    ds_read_b64_tr_b16 v[180:181], v229 offset:10240
    v_mfma_f32_16x16x32_bf16 v[44:47], v[196:199], v[148:151], v[44:47]
    ds_read_b64_tr_b16 v[182:183], v229 offset:12800
    s_add_u32 m0, s81, 47104
    v_mfma_f32_16x16x32_bf16 v[40:43], v[192:195], v[136:139], 0
    buffer_load_dwordx4 v212, s[8:11], s0 offen offset:0  lds
    ds_read_b64_tr_b16 v[184:185], v232 offset:0
    v_mfma_f32_16x16x32_bf16 v[40:43], v[196:199], v[140:143], v[40:43]
    buffer_load_dwordx4 v213, s[8:11], s0 offen offset:1024  lds
    s_waitcnt lgkmcnt(5)
    v_mfma_f32_16x16x32_bf16 v[52:55], v[168:171], v[144:147], 0
    ds_read_b64_tr_b16 v[186:187], v232 offset:2560
    ds_read_b64_tr_b16 v[188:189], v232 offset:10240
    v_mfma_f32_16x16x32_bf16 v[52:55], v[172:175], v[148:151], v[52:55]
    ds_read_b64_tr_b16 v[190:191], v232 offset:12800
    s_mov_b32 m0, s84
    v_mfma_f32_16x16x32_bf16 v[48:51], v[168:171], v[136:139], 0
    buffer_load_dwordx4 v214, s[8:11], s0 offen offset:0  lds
    ds_read_b64_tr_b16 v[192:193], v229 offset:64
    v_mfma_f32_16x16x32_bf16 v[48:51], v[172:175], v[140:143], v[48:51]
    ds_read_b64_tr_b16 v[194:195], v229 offset:2624
    s_waitcnt lgkmcnt(6)
    v_mfma_f32_16x16x32_bf16 v[60:63], v[176:179], v[144:147], v[56:59]
    ds_read_b64_tr_b16 v[196:197], v229 offset:10304
    ds_read_b64_tr_b16 v[198:199], v229 offset:12864
    v_mfma_f32_16x16x32_bf16 v[60:63], v[180:183], v[148:151], v[60:63]
    ds_read_b64_tr_b16 v[168:169], v232 offset:64
    s_mul_i32 s1, s65, 1728
    v_mfma_f32_16x16x32_bf16 v[56:59], v[176:179], v[136:139], v[56:59]
    ds_read_b64_tr_b16 v[170:171], v232 offset:2624
    s_add_u32 m0, s82, 47104
    v_mfma_f32_16x16x32_bf16 v[56:59], v[180:183], v[140:143], v[56:59]
    buffer_load_dwordx4 v215, s[12:15], s1 offen offset:0  lds
    s_waitcnt lgkmcnt(6)
    v_mfma_f32_16x16x32_bf16 v[68:71], v[184:187], v[144:147], v[64:67]
    buffer_load_dwordx4 v216, s[12:15], s1 offen offset:1024  lds
    ds_read_b64_tr_b16 v[172:173], v232 offset:10304
    v_mfma_f32_16x16x32_bf16 v[68:71], v[188:191], v[148:151], v[68:71]
    buffer_load_dwordx4 v217, s[12:15], s1 offen offset:2048  lds
    ds_read_b64_tr_b16 v[174:175], v232 offset:12864
    v_mfma_f32_16x16x32_bf16 v[64:67], v[184:187], v[136:139], v[64:67]
    ds_read_b64_tr_b16 v[176:177], v229 offset:128
    v_mfma_f32_16x16x32_bf16 v[64:67], v[188:191], v[140:143], v[64:67]
    ds_read_b64_tr_b16 v[178:179], v229 offset:2688
    s_waitcnt lgkmcnt(6)
    v_mfma_f32_16x16x32_bf16 v[76:79], v[192:195], v[144:147], v[72:75]
    buffer_load_dwordx4 v218, s[12:15], s1 offen offset:3072  lds
    ds_read_b64_tr_b16 v[180:181], v229 offset:10368
    v_mfma_f32_16x16x32_bf16 v[76:79], v[196:199], v[148:151], v[76:79]
    ds_read_b64_tr_b16 v[182:183], v229 offset:12928
    s_add_u32 m0, m0, 4096
    v_mfma_f32_16x16x32_bf16 v[72:75], v[192:195], v[136:139], v[72:75]
    ds_read_b64_tr_b16 v[184:185], v232 offset:128
    v_mfma_f32_16x16x32_bf16 v[72:75], v[196:199], v[140:143], v[72:75]
    buffer_load_dwordx4 v219, s[12:15], s1 offen offset:0  lds
    s_waitcnt lgkmcnt(5)
    v_mfma_f32_16x16x32_bf16 v[84:87], v[168:171], v[144:147], v[80:83]
    ds_read_b64_tr_b16 v[186:187], v232 offset:2688
    ds_read_b64_tr_b16 v[188:189], v232 offset:10368
    v_mfma_f32_16x16x32_bf16 v[84:87], v[172:175], v[148:151], v[84:87]
    ds_read_b64_tr_b16 v[190:191], v232 offset:12928
    v_mfma_f32_16x16x32_bf16 v[80:83], v[168:171], v[136:139], v[80:83]
    s_mov_b32 m0, s37
    s_mov_b32 exec_hi, 0x3ffff
    buffer_load_dwordx4 v6, s[24:27], s36 offen lds
    s_mov_b64 exec, -1
    ds_read_b64_tr_b16 v[192:193], v229 offset:192
    v_mfma_f32_16x16x32_bf16 v[80:83], v[172:175], v[140:143], v[80:83]
    ds_read_b64_tr_b16 v[194:195], v229 offset:2752
    s_waitcnt lgkmcnt(6)
    v_mfma_f32_16x16x32_bf16 v[92:95], v[176:179], v[144:147], v[88:91]
    ds_read_b64_tr_b16 v[196:197], v229 offset:10432
    ds_read_b64_tr_b16 v[198:199], v229 offset:12992
    v_mfma_f32_16x16x32_bf16 v[92:95], v[180:183], v[148:151], v[92:95]
    ds_read_b64_tr_b16 v[168:169], v232 offset:192
    s_add_u32 m0, s80, 94208
    v_mfma_f32_16x16x32_bf16 v[88:91], v[176:179], v[136:139], v[88:91]
    buffer_load_dwordx4 v208, s[4:7], s66 offen offset:0  lds
    ds_read_b64_tr_b16 v[170:171], v232 offset:2752
    v_mfma_f32_16x16x32_bf16 v[88:91], v[180:183], v[140:143], v[88:91]
    buffer_load_dwordx4 v209, s[4:7], s66 offen offset:1024  lds
    s_waitcnt lgkmcnt(6)
    v_mfma_f32_16x16x32_bf16 v[100:103], v[184:187], v[144:147], v[96:99]
    ds_read_b64_tr_b16 v[172:173], v232 offset:10432
    ds_read_b64_tr_b16 v[174:175], v232 offset:12992
    v_mfma_f32_16x16x32_bf16 v[100:103], v[188:191], v[148:151], v[100:103]
    ds_read_b64_tr_b16 v[176:177], v229 offset:256
    v_mfma_f32_16x16x32_bf16 v[96:99], v[184:187], v[136:139], v[96:99]
    buffer_load_dwordx4 v210, s[4:7], s66 offen offset:2048  lds
    ds_read_b64_tr_b16 v[178:179], v229 offset:2816
    v_mfma_f32_16x16x32_bf16 v[96:99], v[188:191], v[140:143], v[96:99]
    ds_read_b64_tr_b16 v[180:181], v229 offset:10496
    s_waitcnt lgkmcnt(7)
    v_mfma_f32_16x16x32_bf16 v[108:111], v[192:195], v[144:147], v[104:107]
    ds_read_b64_tr_b16 v[182:183], v229 offset:13056
    v_mfma_f32_16x16x32_bf16 v[108:111], v[196:199], v[148:151], v[108:111]
    buffer_load_dwordx4 v211, s[4:7], s66 offen offset:3072  lds
    v_mfma_f32_16x16x32_bf16 v[104:107], v[192:195], v[136:139], v[104:107]
    ds_read_b64_tr_b16 v[184:185], v232 offset:256
    s_mul_i32 s0, s66, 1920
    v_mfma_f32_16x16x32_bf16 v[104:107], v[196:199], v[140:143], v[104:107]
    ds_read_b64_tr_b16 v[186:187], v232 offset:2816
    s_waitcnt lgkmcnt(6)
    v_mfma_f32_16x16x32_bf16 v[116:119], v[168:171], v[144:147], v[112:115]
    ds_read_b64_tr_b16 v[188:189], v232 offset:10496
    ds_read_b64_tr_b16 v[190:191], v232 offset:13056
    v_mfma_f32_16x16x32_bf16 v[116:119], v[172:175], v[148:151], v[116:119]
    s_add_u32 m0, s81, 94208
    v_mfma_f32_16x16x32_bf16 v[112:115], v[168:171], v[136:139], v[112:115]
    s_waitcnt vmcnt(5) lgkmcnt(0)
    s_barrier
    ds_read_b64_tr_b16 v[192:193], v227 offset:0
    v_mfma_f32_16x16x32_bf16 v[112:115], v[172:175], v[140:143], v[112:115]
    buffer_load_dwordx4 v212, s[8:11], s0 offen offset:0  lds
    ds_read_b64_tr_b16 v[194:195], v227 offset:1280
    v_mfma_f32_16x16x32_bf16 v[124:127], v[176:179], v[144:147], v[120:123]
    buffer_load_dwordx4 v213, s[8:11], s0 offen offset:1024  lds
    ds_read_b64_tr_b16 v[196:197], v227 offset:5120
    v_mfma_f32_16x16x32_bf16 v[124:127], v[180:183], v[148:151], v[124:127]
    ds_read_b64_tr_b16 v[198:199], v227 offset:6400
    ds_read_b128 v[152:155], v222 offset:0
    v_mfma_f32_16x16x32_bf16 v[120:123], v[176:179], v[136:139], v[120:123]
    ds_read_b128 v[156:159], v223 offset:0
    ds_read_b128 v[160:163], v222 offset:2048
    v_mfma_f32_16x16x32_bf16 v[120:123], v[180:183], v[140:143], v[120:123]
    ds_read_b128 v[164:167], v223 offset:2048
    s_mov_b32 m0, s85
    v_mfma_f32_16x16x32_bf16 v[132:135], v[184:187], v[144:147], v[128:131]
    buffer_load_dwordx4 v214, s[8:11], s0 offen offset:0  lds
    ds_read_b64_tr_b16 v[168:169], v227 offset:8
    s_mul_i32 s1, s66, 1728
    v_mfma_f32_16x16x32_bf16 v[132:135], v[188:191], v[148:151], v[132:135]
    ds_read_b64_tr_b16 v[170:171], v227 offset:1288
    ds_read_b64_tr_b16 v[172:173], v227 offset:5128
    s_add_u32 m0, s82, 94208
    v_mfma_f32_16x16x32_bf16 v[128:131], v[184:187], v[136:139], v[128:131]
    buffer_load_dwordx4 v215, s[12:15], s1 offen offset:0  lds
    ds_read_b64_tr_b16 v[174:175], v227 offset:6408
    v_mfma_f32_16x16x32_bf16 v[128:131], v[188:191], v[140:143], v[128:131]
    buffer_load_dwordx4 v216, s[12:15], s1 offen offset:1024  lds
    s_waitcnt lgkmcnt(7)
    v_mfma_f32_16x16x32_bf16 v[16:19], v[192:195], v[152:155], v[16:19]
    buffer_load_dwordx4 v217, s[12:15], s1 offen offset:2048  lds
    s_waitcnt lgkmcnt(6)
    v_mfma_f32_16x16x32_bf16 v[16:19], v[196:199], v[156:159], v[16:19]
    buffer_load_dwordx4 v218, s[12:15], s1 offen offset:3072  lds
    s_waitcnt lgkmcnt(5)
    v_mfma_f32_16x16x32_bf16 v[20:23], v[192:195], v[160:163], v[20:23]
    ds_read_b64_tr_b16 v[176:177], v227 offset:16
    s_waitcnt lgkmcnt(5)
    v_mfma_f32_16x16x32_bf16 v[20:23], v[196:199], v[164:167], v[20:23]
    ds_read_b64_tr_b16 v[178:179], v227 offset:1296
    s_waitcnt lgkmcnt(2)
    v_mfma_f32_16x16x32_bf16 v[24:27], v[168:171], v[152:155], v[24:27]
    ds_read_b64_tr_b16 v[180:181], v227 offset:5136
    ds_read_b64_tr_b16 v[182:183], v227 offset:6416
    s_add_u32 m0, m0, 4096
    v_mfma_f32_16x16x32_bf16 v[24:27], v[172:175], v[156:159], v[24:27]
    buffer_load_dwordx4 v219, s[12:15], s1 offen offset:0  lds
    ds_read_b64_tr_b16 v[184:185], v227 offset:24
    v_mfma_f32_16x16x32_bf16 v[28:31], v[168:171], v[160:163], v[28:31]
    ds_read_b64_tr_b16 v[186:187], v227 offset:1304
    ds_read_b64_tr_b16 v[188:189], v227 offset:5144
    v_mfma_f32_16x16x32_bf16 v[28:31], v[172:175], v[164:167], v[28:31]
    ds_read_b64_tr_b16 v[190:191], v227 offset:6424
    s_add_u32 m0, s80, 141312
    s_waitcnt lgkmcnt(4)
    v_mfma_f32_16x16x32_bf16 v[32:35], v[176:179], v[152:155], v[32:35]
    buffer_load_dwordx4 v252, s[20:23], s32 offen offset:0 nt lds
    ds_read_b64_tr_b16 v[192:193], v227 offset:32
    v_mfma_f32_16x16x32_bf16 v[32:35], v[180:183], v[156:159], v[32:35]
    buffer_load_dwordx4 v252, s[20:23], s33 offen offset:1024 nt lds
    ds_read_b64_tr_b16 v[194:195], v227 offset:1312
    v_mfma_f32_16x16x32_bf16 v[36:39], v[176:179], v[160:163], v[36:39]
    ds_read_b64_tr_b16 v[196:197], v227 offset:5152
    ds_read_b64_tr_b16 v[198:199], v227 offset:6432
    v_mfma_f32_16x16x32_bf16 v[36:39], v[180:183], v[164:167], v[36:39]
    buffer_load_dwordx4 v252, s[20:23], s34 offen offset:2048 nt lds
    s_waitcnt lgkmcnt(4)
    v_mfma_f32_16x16x32_bf16 v[40:43], v[184:187], v[152:155], v[40:43]
    ds_read_b64_tr_b16 v[168:169], v230 offset:0
    ds_read_b64_tr_b16 v[170:171], v230 offset:2560
    v_mfma_f32_16x16x32_bf16 v[40:43], v[188:191], v[156:159], v[40:43]
    buffer_load_dwordx4 v252, s[20:23], s35 offen offset:3072 nt lds
    ds_read_b64_tr_b16 v[172:173], v230 offset:10240
    v_mfma_f32_16x16x32_bf16 v[44:47], v[184:187], v[160:163], v[44:47]
    ds_read_b64_tr_b16 v[174:175], v230 offset:12800
    s_add_u32 m0, s80, 0
    v_mfma_f32_16x16x32_bf16 v[44:47], v[188:191], v[164:167], v[44:47]
    ds_read_b64_tr_b16 v[176:177], v233 offset:0
    s_waitcnt lgkmcnt(5)
    v_mfma_f32_16x16x32_bf16 v[48:51], v[192:195], v[152:155], v[48:51]
    buffer_load_dwordx4 v208, s[4:7], s67 offen offset:0  lds
    ds_read_b64_tr_b16 v[178:179], v233 offset:2560
    v_mfma_f32_16x16x32_bf16 v[48:51], v[196:199], v[156:159], v[48:51]
    ds_read_b64_tr_b16 v[180:181], v233 offset:10240
    ds_read_b64_tr_b16 v[182:183], v233 offset:12800
    v_mfma_f32_16x16x32_bf16 v[52:55], v[192:195], v[160:163], v[52:55]
    ds_read_b64_tr_b16 v[184:185], v230 offset:64
    v_mfma_f32_16x16x32_bf16 v[52:55], v[196:199], v[164:167], v[52:55]
    buffer_load_dwordx4 v209, s[4:7], s67 offen offset:1024  lds
    s_waitcnt lgkmcnt(5)
    v_mfma_f32_16x16x32_bf16 v[56:59], v[168:171], v[152:155], v[56:59]
    ds_read_b64_tr_b16 v[186:187], v230 offset:2624
    ds_read_b64_tr_b16 v[188:189], v230 offset:10304
    v_mfma_f32_16x16x32_bf16 v[56:59], v[172:175], v[156:159], v[56:59]
    ds_read_b64_tr_b16 v[190:191], v230 offset:12864
    v_mfma_f32_16x16x32_bf16 v[60:63], v[168:171], v[160:163], v[60:63]
    buffer_load_dwordx4 v210, s[4:7], s67 offen offset:2048  lds
    ds_read_b64_tr_b16 v[192:193], v233 offset:64
    v_mfma_f32_16x16x32_bf16 v[60:63], v[172:175], v[164:167], v[60:63]
    ds_read_b64_tr_b16 v[194:195], v233 offset:2624
    s_waitcnt lgkmcnt(6)
    v_mfma_f32_16x16x32_bf16 v[64:67], v[176:179], v[152:155], v[64:67]
    ds_read_b64_tr_b16 v[196:197], v233 offset:10304
    ds_read_b64_tr_b16 v[198:199], v233 offset:12864
    v_mfma_f32_16x16x32_bf16 v[64:67], v[180:183], v[156:159], v[64:67]
    buffer_load_dwordx4 v211, s[4:7], s67 offen offset:3072  lds
    s_mul_i32 s0, s67, 1920
    v_mfma_f32_16x16x32_bf16 v[68:71], v[176:179], v[160:163], v[68:71]
    ds_read_b64_tr_b16 v[168:169], v230 offset:128
    s_add_u32 m0, s81, 0
    v_mfma_f32_16x16x32_bf16 v[68:71], v[180:183], v[164:167], v[68:71]
    buffer_load_dwordx4 v212, s[8:11], s0 offen offset:0  lds
    s_waitcnt lgkmcnt(5)
    v_mfma_f32_16x16x32_bf16 v[72:75], v[184:187], v[152:155], v[72:75]
    ds_read_b64_tr_b16 v[170:171], v230 offset:2688
    ds_read_b64_tr_b16 v[172:173], v230 offset:10368
    v_mfma_f32_16x16x32_bf16 v[72:75], v[188:191], v[156:159], v[72:75]
    ds_read_b64_tr_b16 v[174:175], v230 offset:12928
    v_mfma_f32_16x16x32_bf16 v[76:79], v[184:187], v[160:163], v[76:79]
    buffer_load_dwordx4 v213, s[8:11], s0 offen offset:1024  lds
    ds_read_b64_tr_b16 v[176:177], v233 offset:128
    v_mfma_f32_16x16x32_bf16 v[76:79], v[188:191], v[164:167], v[76:79]
    ds_read_b64_tr_b16 v[178:179], v233 offset:2688
    s_waitcnt lgkmcnt(6)
    v_mfma_f32_16x16x32_bf16 v[80:83], v[192:195], v[152:155], v[80:83]
    ds_read_b64_tr_b16 v[180:181], v233 offset:10368
    ds_read_b64_tr_b16 v[182:183], v233 offset:12928
    v_mfma_f32_16x16x32_bf16 v[80:83], v[196:199], v[156:159], v[80:83]
    ds_read_b64_tr_b16 v[184:185], v230 offset:192
    s_mov_b32 m0, s83
    v_mfma_f32_16x16x32_bf16 v[84:87], v[192:195], v[160:163], v[84:87]
    buffer_load_dwordx4 v214, s[8:11], s0 offen offset:0  lds
    ds_read_b64_tr_b16 v[186:187], v230 offset:2752
    v_mfma_f32_16x16x32_bf16 v[84:87], v[196:199], v[164:167], v[84:87]
    ds_read_b64_tr_b16 v[188:189], v230 offset:10432
    s_waitcnt lgkmcnt(7)
    v_mfma_f32_16x16x32_bf16 v[88:91], v[168:171], v[152:155], v[88:91]
    ds_read_b64_tr_b16 v[190:191], v230 offset:12992
    s_mul_i32 s1, s67, 1728
    v_mfma_f32_16x16x32_bf16 v[88:91], v[172:175], v[156:159], v[88:91]
    ds_read_b64_tr_b16 v[192:193], v233 offset:192
    s_add_u32 m0, s82, 0
    v_mfma_f32_16x16x32_bf16 v[92:95], v[168:171], v[160:163], v[92:95]
    buffer_load_dwordx4 v215, s[12:15], s1 offen offset:0  lds
    ds_read_b64_tr_b16 v[194:195], v233 offset:2752
    v_mfma_f32_16x16x32_bf16 v[92:95], v[172:175], v[164:167], v[92:95]
    buffer_load_dwordx4 v216, s[12:15], s1 offen offset:1024  lds
    s_waitcnt lgkmcnt(6)
    v_mfma_f32_16x16x32_bf16 v[96:99], v[176:179], v[152:155], v[96:99]
    ds_read_b64_tr_b16 v[196:197], v233 offset:10432
    ds_read_b64_tr_b16 v[198:199], v233 offset:12992
    v_mfma_f32_16x16x32_bf16 v[96:99], v[180:183], v[156:159], v[96:99]
    buffer_load_dwordx4 v217, s[12:15], s1 offen offset:2048  lds
    v_mfma_f32_16x16x32_bf16 v[100:103], v[176:179], v[160:163], v[100:103]
    ds_read_b64_tr_b16 v[168:169], v230 offset:256
    v_mfma_f32_16x16x32_bf16 v[100:103], v[180:183], v[164:167], v[100:103]
    ds_read_b64_tr_b16 v[170:171], v230 offset:2816
    s_waitcnt lgkmcnt(6)
    v_mfma_f32_16x16x32_bf16 v[104:107], v[184:187], v[152:155], v[104:107]
    buffer_load_dwordx4 v218, s[12:15], s1 offen offset:3072  lds
    ds_read_b64_tr_b16 v[172:173], v230 offset:10496
    v_mfma_f32_16x16x32_bf16 v[104:107], v[188:191], v[156:159], v[104:107]
    ds_read_b64_tr_b16 v[174:175], v230 offset:13056
    v_mfma_f32_16x16x32_bf16 v[108:111], v[184:187], v[160:163], v[108:111]
    ds_read_b64_tr_b16 v[176:177], v233 offset:256
    v_mfma_f32_16x16x32_bf16 v[108:111], v[188:191], v[164:167], v[108:111]
    ds_read_b64_tr_b16 v[178:179], v233 offset:2816
    s_waitcnt lgkmcnt(6)
    v_mfma_f32_16x16x32_bf16 v[112:115], v[192:195], v[152:155], v[112:115]
    ds_read_b64_tr_b16 v[180:181], v233 offset:10496
    ds_read_b64_tr_b16 v[182:183], v233 offset:13056
    v_mfma_f32_16x16x32_bf16 v[112:115], v[196:199], v[156:159], v[112:115]
    v_mfma_f32_16x16x32_bf16 v[116:119], v[192:195], v[160:163], v[116:119]
    s_waitcnt vmcnt(15) lgkmcnt(0)
    s_barrier
    ds_read_b64_tr_b16 v[184:185], v228 offset:0
    v_mfma_f32_16x16x32_bf16 v[116:119], v[196:199], v[164:167], v[116:119]
    ds_read_b64_tr_b16 v[186:187], v228 offset:1280
    s_add_u32 m0, m0, 4096
    v_mfma_f32_16x16x32_bf16 v[120:123], v[168:171], v[152:155], v[120:123]
    buffer_load_dwordx4 v219, s[12:15], s1 offen offset:0  lds
    ds_read_b64_tr_b16 v[188:189], v228 offset:5120
    v_mfma_f32_16x16x32_bf16 v[120:123], v[172:175], v[156:159], v[120:123]
    ds_read_b64_tr_b16 v[190:191], v228 offset:6400
    ds_read_b128 v[136:139], v224 offset:0
    v_mfma_f32_16x16x32_bf16 v[124:127], v[168:171], v[160:163], v[124:127]
    ds_read_b128 v[140:143], v225 offset:0
    ds_read_b128 v[144:147], v224 offset:2048
    v_mfma_f32_16x16x32_bf16 v[124:127], v[172:175], v[164:167], v[124:127]
    ds_read_b128 v[148:151], v225 offset:2048
    s_add_u32 m0, s80, 47104
    v_mfma_f32_16x16x32_bf16 v[128:131], v[176:179], v[152:155], v[128:131]
    buffer_load_dwordx4 v208, s[4:7], s68 offen offset:0  lds
    ds_read_b64_tr_b16 v[192:193], v228 offset:8
    v_mfma_f32_16x16x32_bf16 v[128:131], v[180:183], v[156:159], v[128:131]
    ds_read_b64_tr_b16 v[194:195], v228 offset:1288
    ds_read_b64_tr_b16 v[196:197], v228 offset:5128
    v_mfma_f32_16x16x32_bf16 v[132:135], v[176:179], v[160:163], v[132:135]
    ds_read_b64_tr_b16 v[198:199], v228 offset:6408
    v_mfma_f32_16x16x32_bf16 v[132:135], v[180:183], v[164:167], v[132:135]
    ds_read_b64_tr_b16 v[168:169], v228 offset:16
    s_waitcnt lgkmcnt(8)
    v_mfma_f32_16x16x32_bf16 v[16:19], v[184:187], v[136:139], v[16:19]
    buffer_load_dwordx4 v209, s[4:7], s68 offen offset:1024  lds
    s_waitcnt lgkmcnt(7)
    v_mfma_f32_16x16x32_bf16 v[16:19], v[188:191], v[140:143], v[16:19]
    ds_read_b64_tr_b16 v[170:171], v228 offset:1296
    s_waitcnt lgkmcnt(7)
    v_mfma_f32_16x16x32_bf16 v[20:23], v[184:187], v[144:147], v[20:23]
    ds_read_b64_tr_b16 v[172:173], v228 offset:5136
    s_waitcnt lgkmcnt(7)
    v_mfma_f32_16x16x32_bf16 v[20:23], v[188:191], v[148:151], v[20:23]
    ds_read_b64_tr_b16 v[174:175], v228 offset:6416
    s_waitcnt lgkmcnt(4)
    v_mfma_f32_16x16x32_bf16 v[24:27], v[192:195], v[136:139], v[24:27]
    buffer_load_dwordx4 v210, s[4:7], s68 offen offset:2048  lds
    ds_read_b64_tr_b16 v[176:177], v228 offset:24
    v_mfma_f32_16x16x32_bf16 v[24:27], v[196:199], v[140:143], v[24:27]
    ds_read_b64_tr_b16 v[178:179], v228 offset:1304
    ds_read_b64_tr_b16 v[180:181], v228 offset:5144
    v_mfma_f32_16x16x32_bf16 v[28:31], v[192:195], v[144:147], v[28:31]
    ds_read_b64_tr_b16 v[182:183], v228 offset:6424
    v_mfma_f32_16x16x32_bf16 v[28:31], v[196:199], v[148:151], v[28:31]
    ds_read_b64_tr_b16 v[184:185], v228 offset:32
    s_waitcnt lgkmcnt(5)
    v_mfma_f32_16x16x32_bf16 v[32:35], v[168:171], v[136:139], v[32:35]
    ds_read_b64_tr_b16 v[186:187], v228 offset:1312
    ds_read_b64_tr_b16 v[188:189], v228 offset:5152
    v_mfma_f32_16x16x32_bf16 v[32:35], v[172:175], v[140:143], v[32:35]
    buffer_load_dwordx4 v211, s[4:7], s68 offen offset:3072  lds
    ds_read_b64_tr_b16 v[190:191], v228 offset:6432
    v_mfma_f32_16x16x32_bf16 v[36:39], v[168:171], v[144:147], v[36:39]
    ds_read_b64_tr_b16 v[192:193], v231 offset:0
    v_mfma_f32_16x16x32_bf16 v[36:39], v[172:175], v[148:151], v[36:39]
    ds_read_b64_tr_b16 v[194:195], v231 offset:2560
    s_waitcnt lgkmcnt(6)
    v_mfma_f32_16x16x32_bf16 v[40:43], v[176:179], v[136:139], v[40:43]
    ds_read_b64_tr_b16 v[196:197], v231 offset:10240
    ds_read_b64_tr_b16 v[198:199], v231 offset:12800
    v_mfma_f32_16x16x32_bf16 v[40:43], v[180:183], v[140:143], v[40:43]
    ds_read_b64_tr_b16 v[168:169], v234 offset:0
    s_mul_i32 s0, s68, 1920
    v_mfma_f32_16x16x32_bf16 v[44:47], v[176:179], v[144:147], v[44:47]
    ds_read_b64_tr_b16 v[170:171], v234 offset:2560
    s_add_u32 m0, s81, 47104
    v_mfma_f32_16x16x32_bf16 v[44:47], v[180:183], v[148:151], v[44:47]
    buffer_load_dwordx4 v212, s[8:11], s0 offen offset:0  lds
    s_waitcnt lgkmcnt(6)
    v_mfma_f32_16x16x32_bf16 v[48:51], v[184:187], v[136:139], v[48:51]
    ds_read_b64_tr_b16 v[172:173], v234 offset:10240
    ds_read_b64_tr_b16 v[174:175], v234 offset:12800
    v_mfma_f32_16x16x32_bf16 v[48:51], v[188:191], v[140:143], v[48:51]
    buffer_load_dwordx4 v213, s[8:11], s0 offen offset:1024  lds
    v_mfma_f32_16x16x32_bf16 v[52:55], v[184:187], v[144:147], v[52:55]
    ds_read_b64_tr_b16 v[176:177], v231 offset:64
    v_mfma_f32_16x16x32_bf16 v[52:55], v[188:191], v[148:151], v[52:55]
    ds_read_b64_tr_b16 v[178:179], v231 offset:2624
    s_waitcnt lgkmcnt(6)
    v_mfma_f32_16x16x32_bf16 v[56:59], v[192:195], v[136:139], v[56:59]
    ds_read_b64_tr_b16 v[180:181], v231 offset:10304
    ds_read_b64_tr_b16 v[182:183], v231 offset:12864
    v_mfma_f32_16x16x32_bf16 v[56:59], v[196:199], v[140:143], v[56:59]
    ds_read_b64_tr_b16 v[184:185], v234 offset:64
    s_mov_b32 m0, s84
    v_mfma_f32_16x16x32_bf16 v[60:63], v[192:195], v[144:147], v[60:63]
    buffer_load_dwordx4 v214, s[8:11], s0 offen offset:0  lds
    ds_read_b64_tr_b16 v[186:187], v234 offset:2624
    v_mfma_f32_16x16x32_bf16 v[60:63], v[196:199], v[148:151], v[60:63]
    ds_read_b64_tr_b16 v[188:189], v234 offset:10304
    s_waitcnt lgkmcnt(7)
    v_mfma_f32_16x16x32_bf16 v[64:67], v[168:171], v[136:139], v[64:67]
    ds_read_b64_tr_b16 v[190:191], v234 offset:12864
    s_mul_i32 s1, s68, 1728
    v_mfma_f32_16x16x32_bf16 v[64:67], v[172:175], v[140:143], v[64:67]
    ds_read_b64_tr_b16 v[192:193], v231 offset:128
    s_add_u32 m0, s82, 47104
    v_mfma_f32_16x16x32_bf16 v[68:71], v[168:171], v[144:147], v[68:71]
    buffer_load_dwordx4 v215, s[12:15], s1 offen offset:0  lds
    ds_read_b64_tr_b16 v[194:195], v231 offset:2688
    v_mfma_f32_16x16x32_bf16 v[68:71], v[172:175], v[148:151], v[68:71]
    ds_read_b64_tr_b16 v[196:197], v231 offset:10368
    s_waitcnt lgkmcnt(7)
    v_mfma_f32_16x16x32_bf16 v[72:75], v[176:179], v[136:139], v[72:75]
    ds_read_b64_tr_b16 v[198:199], v231 offset:12928
    v_mfma_f32_16x16x32_bf16 v[72:75], v[180:183], v[140:143], v[72:75]
    ds_read_b64_tr_b16 v[168:169], v234 offset:128
    v_mfma_f32_16x16x32_bf16 v[76:79], v[176:179], v[144:147], v[76:79]
    buffer_load_dwordx4 v216, s[12:15], s1 offen offset:1024  lds
    ds_read_b64_tr_b16 v[170:171], v234 offset:2688
    v_mfma_f32_16x16x32_bf16 v[76:79], v[180:183], v[148:151], v[76:79]
    ds_read_b64_tr_b16 v[172:173], v234 offset:10368
    s_waitcnt lgkmcnt(7)
    v_mfma_f32_16x16x32_bf16 v[80:83], v[184:187], v[136:139], v[80:83]
    ds_read_b64_tr_b16 v[174:175], v234 offset:12928
    v_mfma_f32_16x16x32_bf16 v[80:83], v[188:191], v[140:143], v[80:83]
    ds_read_b64_tr_b16 v[176:177], v231 offset:192
    v_mfma_f32_16x16x32_bf16 v[84:87], v[184:187], v[144:147], v[84:87]
    buffer_load_dwordx4 v217, s[12:15], s1 offen offset:2048  lds
    ds_read_b64_tr_b16 v[178:179], v231 offset:2752
    v_mfma_f32_16x16x32_bf16 v[84:87], v[188:191], v[148:151], v[84:87]
    ds_read_b64_tr_b16 v[180:181], v231 offset:10432
    s_waitcnt lgkmcnt(7)
    v_mfma_f32_16x16x32_bf16 v[88:91], v[192:195], v[136:139], v[88:91]
    ds_read_b64_tr_b16 v[182:183], v231 offset:12992
    v_mfma_f32_16x16x32_bf16 v[88:91], v[196:199], v[140:143], v[88:91]
    ds_read_b64_tr_b16 v[184:185], v234 offset:192
    v_mfma_f32_16x16x32_bf16 v[92:95], v[192:195], v[144:147], v[92:95]
    ds_read_b64_tr_b16 v[186:187], v234 offset:2752
    v_mfma_f32_16x16x32_bf16 v[92:95], v[196:199], v[148:151], v[92:95]
    buffer_load_dwordx4 v218, s[12:15], s1 offen offset:3072  lds
    s_waitcnt lgkmcnt(6)
    v_mfma_f32_16x16x32_bf16 v[96:99], v[168:171], v[136:139], v[96:99]
    ds_read_b64_tr_b16 v[188:189], v234 offset:10432
    ds_read_b64_tr_b16 v[190:191], v234 offset:12992
    v_mfma_f32_16x16x32_bf16 v[96:99], v[172:175], v[140:143], v[96:99]
    ds_read_b64_tr_b16 v[192:193], v231 offset:256
    s_add_u32 m0, m0, 4096
    v_mfma_f32_16x16x32_bf16 v[100:103], v[168:171], v[144:147], v[100:103]
    ds_read_b64_tr_b16 v[194:195], v231 offset:2816
    v_mfma_f32_16x16x32_bf16 v[100:103], v[172:175], v[148:151], v[100:103]
    buffer_load_dwordx4 v219, s[12:15], s1 offen offset:0  lds
    s_waitcnt lgkmcnt(6)
    v_mfma_f32_16x16x32_bf16 v[104:107], v[176:179], v[136:139], v[104:107]
    ds_read_b64_tr_b16 v[196:197], v231 offset:10496
    ds_read_b64_tr_b16 v[198:199], v231 offset:13056
    v_mfma_f32_16x16x32_bf16 v[104:107], v[180:183], v[140:143], v[104:107]
    ds_read_b64_tr_b16 v[168:169], v234 offset:256
    v_mfma_f32_16x16x32_bf16 v[108:111], v[176:179], v[144:147], v[108:111]
    ds_read_b64_tr_b16 v[170:171], v234 offset:2816
    v_mfma_f32_16x16x32_bf16 v[108:111], v[180:183], v[148:151], v[108:111]
    ds_read_b64_tr_b16 v[172:173], v234 offset:10496
    s_waitcnt lgkmcnt(7)
    v_mfma_f32_16x16x32_bf16 v[112:115], v[184:187], v[136:139], v[112:115]
    ds_read_b64_tr_b16 v[174:175], v234 offset:13056
    v_mfma_f32_16x16x32_bf16 v[112:115], v[188:191], v[140:143], v[112:115]
    v_mfma_f32_16x16x32_bf16 v[116:119], v[184:187], v[144:147], v[116:119]
    s_waitcnt vmcnt(12) lgkmcnt(0)
    s_barrier
    ds_read_b64_tr_b16 v[176:177], v226 offset:0
    v_mfma_f32_16x16x32_bf16 v[116:119], v[188:191], v[148:151], v[116:119]
    ds_read_b64_tr_b16 v[178:179], v226 offset:1280
    s_add_u32 m0, s80, 94208
    v_mfma_f32_16x16x32_bf16 v[120:123], v[192:195], v[136:139], v[120:123]
    buffer_load_dwordx4 v208, s[4:7], s69 offen offset:0  lds
    ds_read_b64_tr_b16 v[180:181], v226 offset:5120
    v_mfma_f32_16x16x32_bf16 v[120:123], v[196:199], v[140:143], v[120:123]
    ds_read_b64_tr_b16 a[160:161], v200 offset:0
    ds_read_b64_tr_b16 v[182:183], v226 offset:6400
    v_mfma_f32_16x16x32_bf16 v[124:127], v[192:195], v[144:147], v[124:127]
    ds_read_b64_tr_b16 a[204:205], v254 offset:0
    ds_read_b128 v[152:155], v220 offset:0
    v_mfma_f32_16x16x32_bf16 v[124:127], v[196:199], v[148:151], v[124:127]
    buffer_load_dwordx4 v209, s[4:7], s69 offen offset:1024  lds
    ds_read_b128 v[156:159], v221 offset:0
    v_mfma_f32_16x16x32_bf16 v[128:131], v[168:171], v[136:139], v[128:131]
    ds_read_b64_tr_b16 a[162:163], v200 offset:512
    ds_read_b128 v[160:163], v220 offset:2048
    v_mfma_f32_16x16x32_bf16 v[128:131], v[172:175], v[140:143], v[128:131]
    ds_read_b64_tr_b16 a[164:165], v201 offset:0
    ds_read_b128 v[164:167], v221 offset:2048
    v_mfma_f32_16x16x32_bf16 v[132:135], v[168:171], v[144:147], v[132:135]
    buffer_load_dwordx4 v210, s[4:7], s69 offen offset:2048  lds
    ds_read_b64_tr_b16 v[184:185], v226 offset:8
    v_mfma_f32_16x16x32_bf16 v[132:135], v[172:175], v[148:151], v[132:135]
    ds_read_b64_tr_b16 a[166:167], v201 offset:512
    s_waitcnt lgkmcnt(7)
    v_mfma_f32_16x16x32_bf16 v[16:19], v[176:179], v[152:155], v[16:19]
    ds_read_b64_tr_b16 a[206:207], v254 offset:8
    ds_read_b64_tr_b16 v[186:187], v226 offset:1288
    ds_read_b64_tr_b16 v[188:189], v226 offset:5128
    ds_read_b64_tr_b16 v[190:191], v226 offset:6408
    s_waitcnt lgkmcnt(10)
    v_mfma_f32_16x16x32_bf16 v[16:19], v[180:183], v[156:159], v[16:19]
    ds_read_b64_tr_b16 a[168:169], v202 offset:64
    s_waitcnt lgkmcnt(9)
    v_mfma_f32_16x16x32_bf16 v[20:23], v[176:179], v[160:163], v[20:23]
    buffer_load_dwordx4 v211, s[4:7], s69 offen offset:3072  lds
    s_waitcnt lgkmcnt(7)
    v_mfma_f32_16x16x32_bf16 v[20:23], v[180:183], v[164:167], v[20:23]
    ds_read_b64_tr_b16 a[170:171], v202 offset:576
    s_waitcnt lgkmcnt(2)
    v_mfma_f32_16x16x32_bf16 v[24:27], v[184:187], v[152:155], v[24:27]
    ds_read_b64_tr_b16 a[208:209], v254 offset:16
    ds_read_b64_tr_b16 v[192:193], v226 offset:16
    ds_read_b64_tr_b16 v[194:195], v226 offset:1296
    ds_read_b64_tr_b16 v[196:197], v226 offset:5136
    ds_read_b64_tr_b16 v[198:199], v226 offset:6416
    v_mfma_f32_16x16x32_bf16 v[24:27], v[188:191], v[156:159], v[24:27]
    ds_read_b64_tr_b16 v[168:169], v226 offset:24
    ds_read_b64_tr_b16 v[170:171], v226 offset:1304
    v_mfma_f32_16x16x32_bf16 v[28:31], v[184:187], v[160:163], v[28:31]
    ds_read_b64_tr_b16 v[172:173], v226 offset:5144
    ds_read_b64_tr_b16 v[174:175], v226 offset:6424
    v_mfma_f32_16x16x32_bf16 v[28:31], v[188:191], v[164:167], v[28:31]
    ds_read_b64_tr_b16 v[176:177], v226 offset:32
    s_mul_i32 s0, s69, 1920
    s_waitcnt lgkmcnt(5)
    v_mfma_f32_16x16x32_bf16 v[32:35], v[192:195], v[152:155], v[32:35]
    ds_read_b64_tr_b16 v[178:179], v226 offset:1312
    ds_read_b64_tr_b16 v[180:181], v226 offset:5152
    s_add_u32 m0, s81, 94208
    v_mfma_f32_16x16x32_bf16 v[32:35], v[196:199], v[156:159], v[32:35]
    buffer_load_dwordx4 v212, s[8:11], s0 offen offset:0  lds
    ds_read_b64_tr_b16 v[182:183], v226 offset:6432
    v_mfma_f32_16x16x32_bf16 v[36:39], v[192:195], v[160:163], v[36:39]
    ds_read_b64_tr_b16 a[172:173], v203 offset:64
    ds_read_b64_tr_b16 v[184:185], v229 offset:0
    v_mfma_f32_16x16x32_bf16 v[36:39], v[196:199], v[164:167], v[36:39]
    ds_read_b64_tr_b16 a[174:175], v203 offset:576
    s_waitcnt lgkmcnt(7)
    v_mfma_f32_16x16x32_bf16 v[40:43], v[168:171], v[152:155], v[40:43]
    buffer_load_dwordx4 v213, s[8:11], s0 offen offset:1024  lds
    ds_read_b64_tr_b16 v[186:187], v229 offset:2560
    v_mfma_f32_16x16x32_bf16 v[40:43], v[172:175], v[156:159], v[40:43]
    ds_read_b64_tr_b16 a[210:211], v254 offset:24
    ds_read_b64_tr_b16 v[188:189], v229 offset:10240
    v_mfma_f32_16x16x32_bf16 v[44:47], v[168:171], v[160:163], v[44:47]
    ds_read_b64_tr_b16 v[190:191], v229 offset:12800
    s_mov_b32 m0, s85
    v_mfma_f32_16x16x32_bf16 v[44:47], v[172:175], v[164:167], v[44:47]
    buffer_load_dwordx4 v214, s[8:11], s0 offen offset:0  lds
    s_waitcnt lgkmcnt(7)
    v_mfma_f32_16x16x32_bf16 v[48:51], v[176:179], v[152:155], v[48:51]
    ds_read_b64_tr_b16 a[212:213], v254 offset:32
    ds_read_b64_tr_b16 v[192:193], v232 offset:0
    v_mfma_f32_16x16x32_bf16 v[48:51], v[180:183], v[156:159], v[48:51]
    ds_read_b64_tr_b16 v[194:195], v232 offset:2560
    ds_read_b64_tr_b16 v[196:197], v232 offset:10240
    v_mfma_f32_16x16x32_bf16 v[52:55], v[176:179], v[160:163], v[52:55]
    ds_read_b64_tr_b16 v[198:199], v232 offset:12800
    s_mul_i32 s1, s69, 1728
    s_add_u32 m0, s82, 94208
    v_mfma_f32_16x16x32_bf16 v[52:55], v[180:183], v[164:167], v[52:55]
    buffer_load_dwordx4 v215, s[12:15], s1 offen offset:0  lds
    s_waitcnt lgkmcnt(5)
    v_mfma_f32_16x16x32_bf16 v[56:59], v[184:187], v[152:155], v[56:59]
    buffer_load_dwordx4 v216, s[12:15], s1 offen offset:1024  lds
    ds_read_b64_tr_b16 v[168:169], v229 offset:64
    v_mfma_f32_16x16x32_bf16 v[56:59], v[188:191], v[156:159], v[56:59]
    ds_read_b64_tr_b16 a[214:215], v254 offset:160
    ds_read_b64_tr_b16 v[170:171], v229 offset:2624
    v_mfma_f32_16x16x32_bf16 v[60:63], v[184:187], v[160:163], v[60:63]
    ds_read_b64_tr_b16 v[172:173], v229 offset:10304
    ds_read_b64_tr_b16 v[174:175], v229 offset:12864
    v_mfma_f32_16x16x32_bf16 v[60:63], v[188:191], v[164:167], v[60:63]
    buffer_load_dwordx4 v217, s[12:15], s1 offen offset:2048  lds
    s_waitcnt lgkmcnt(5)
    v_mfma_f32_16x16x32_bf16 v[64:67], v[192:195], v[152:155], v[64:67]
    ds_read_b64_tr_b16 a[216:217], v254 offset:168
    ds_read_b64_tr_b16 v[176:177], v232 offset:64
    v_mfma_f32_16x16x32_bf16 v[64:67], v[196:199], v[156:159], v[64:67]
    ds_read_b64_tr_b16 v[178:179], v232 offset:2624
    ds_read_b64_tr_b16 v[180:181], v232 offset:10304
    v_mfma_f32_16x16x32_bf16 v[68:71], v[192:195], v[160:163], v[68:71]
    buffer_load_dwordx4 v218, s[12:15], s1 offen offset:3072  lds
    ds_read_b64_tr_b16 v[182:183], v232 offset:12864
    v_mfma_f32_16x16x32_bf16 v[68:71], v[196:199], v[164:167], v[68:71]
    ds_read_b64_tr_b16 v[184:185], v229 offset:128
    s_waitcnt lgkmcnt(6)
    v_mfma_f32_16x16x32_bf16 v[72:75], v[168:171], v[152:155], v[72:75]
    ds_read_b64_tr_b16 v[186:187], v229 offset:2688
    ds_read_b64_tr_b16 v[188:189], v229 offset:10368
    v_mfma_f32_16x16x32_bf16 v[72:75], v[172:175], v[156:159], v[72:75]
    ds_read_b64_tr_b16 a[218:219], v254 offset:176
    ds_read_b64_tr_b16 v[190:191], v229 offset:12928
    v_mfma_f32_16x16x32_bf16 v[76:79], v[168:171], v[160:163], v[76:79]
    ds_read_b64_tr_b16 v[192:193], v232 offset:128
    s_add_u32 m0, m0, 4096
    v_mfma_f32_16x16x32_bf16 v[76:79], v[172:175], v[164:167], v[76:79]
    buffer_load_dwordx4 v219, s[12:15], s1 offen offset:0  lds
    s_waitcnt lgkmcnt(6)
    v_mfma_f32_16x16x32_bf16 v[80:83], v[176:179], v[152:155], v[80:83]
    ds_read_b64_tr_b16 v[194:195], v232 offset:2688
    ds_read_b64_tr_b16 v[196:197], v232 offset:10368
    v_mfma_f32_16x16x32_bf16 v[80:83], v[180:183], v[156:159], v[80:83]
    ds_read_b64_tr_b16 v[198:199], v232 offset:12928
    v_mfma_f32_16x16x32_bf16 v[84:87], v[176:179], v[160:163], v[84:87]
    buffer_store_dwordx4 a[160:163], v6, s[16:19], s92 offen sc1
    ds_read_b64_tr_b16 v[168:169], v229 offset:192
    v_mfma_f32_16x16x32_bf16 v[84:87], v[180:183], v[164:167], v[84:87]
    ds_read_b64_tr_b16 a[220:221], v254 offset:184
    s_waitcnt lgkmcnt(6)
    v_mfma_f32_16x16x32_bf16 v[88:91], v[184:187], v[152:155], v[88:91]
    ds_read_b64_tr_b16 v[170:171], v229 offset:2752
    ds_read_b64_tr_b16 v[172:173], v229 offset:10432
    v_mfma_f32_16x16x32_bf16 v[88:91], v[188:191], v[156:159], v[88:91]
    buffer_store_dwordx4 a[164:167], v6, s[16:19], s93 offen sc1
    ds_read_b64_tr_b16 v[174:175], v229 offset:12992
    v_mfma_f32_16x16x32_bf16 v[92:95], v[184:187], v[160:163], v[92:95]
    ds_read_b64_tr_b16 v[176:177], v232 offset:192
    v_mfma_f32_16x16x32_bf16 v[92:95], v[188:191], v[164:167], v[92:95]
    ds_read_b64_tr_b16 a[222:223], v254 offset:192
    s_waitcnt lgkmcnt(7)
    v_mfma_f32_16x16x32_bf16 v[96:99], v[192:195], v[152:155], v[96:99]
    buffer_store_dwordx4 a[168:171], v6, s[16:19], s94 offen sc1
    ds_read_b64_tr_b16 v[178:179], v232 offset:2752
    v_mfma_f32_16x16x32_bf16 v[96:99], v[196:199], v[156:159], v[96:99]
    ds_read_b64_tr_b16 v[180:181], v232 offset:10432
    ds_read_b64_tr_b16 v[182:183], v232 offset:12992
    v_mfma_f32_16x16x32_bf16 v[100:103], v[192:195], v[160:163], v[100:103]
    ds_read_b64_tr_b16 v[184:185], v229 offset:256
    v_mfma_f32_16x16x32_bf16 v[100:103], v[196:199], v[164:167], v[100:103]
    ds_read_b64_tr_b16 v[186:187], v229 offset:2816
    s_waitcnt lgkmcnt(7)
    v_mfma_f32_16x16x32_bf16 v[104:107], v[168:171], v[152:155], v[104:107]
    buffer_store_dwordx4 a[172:175], v6, s[16:19], s95 offen sc1
    ds_read_b64_tr_b16 v[188:189], v229 offset:10496
    v_mfma_f32_16x16x32_bf16 v[104:107], v[172:175], v[156:159], v[104:107]
    ds_read_b64_tr_b16 a[224:225], v254 offset:320
    ds_read_b64_tr_b16 v[190:191], v229 offset:13056
    v_mfma_f32_16x16x32_bf16 v[108:111], v[168:171], v[160:163], v[108:111]
    ds_read_b64_tr_b16 v[192:193], v232 offset:256
    v_mfma_f32_16x16x32_bf16 v[108:111], v[172:175], v[164:167], v[108:111]
    ds_read_b64_tr_b16 v[194:195], v232 offset:2816
    s_waitcnt lgkmcnt(7)
    v_mfma_f32_16x16x32_bf16 v[112:115], v[176:179], v[152:155], v[112:115]
    ds_read_b64_tr_b16 v[196:197], v232 offset:10496
    ds_read_b64_tr_b16 v[198:199], v232 offset:13056
    v_mfma_f32_16x16x32_bf16 v[112:115], v[180:183], v[156:159], v[112:115]
    ds_read_b64_tr_b16 a[226:227], v254 offset:328
    v_mfma_f32_16x16x32_bf16 v[116:119], v[176:179], v[160:163], v[116:119]
    s_waitcnt vmcnt(16) lgkmcnt(0)
    s_barrier
    ds_read_b64_tr_b16 v[168:169], v227 offset:0
    v_mfma_f32_16x16x32_bf16 v[116:119], v[180:183], v[164:167], v[116:119]
    ds_read_b64_tr_b16 v[170:171], v227 offset:1280
    s_add_u32 m0, s80, 0
    v_mfma_f32_16x16x32_bf16 v[120:123], v[184:187], v[152:155], v[120:123]
    buffer_load_dwordx4 v208, s[4:7], s70 offen offset:0  lds
    ds_read_b64_tr_b16 v[172:173], v227 offset:5120
    v_mfma_f32_16x16x32_bf16 v[120:123], v[188:191], v[156:159], v[120:123]
    ds_read_b64_tr_b16 v[174:175], v227 offset:6400
    ds_read_b128 v[136:139], v222 offset:0
    v_mfma_f32_16x16x32_bf16 v[124:127], v[184:187], v[160:163], v[124:127]
    ds_read_b64_tr_b16 a[228:229], v254 offset:336
    ds_read_b128 v[140:143], v223 offset:0
    v_mfma_f32_16x16x32_bf16 v[124:127], v[188:191], v[164:167], v[124:127]
    buffer_load_dwordx4 v209, s[4:7], s70 offen offset:1024  lds
    ds_read_b128 v[144:147], v222 offset:2048
    v_mfma_f32_16x16x32_bf16 v[128:131], v[192:195], v[152:155], v[128:131]
    ds_read_b128 v[148:151], v223 offset:2048
    ds_read_b64_tr_b16 v[176:177], v227 offset:8
    v_mfma_f32_16x16x32_bf16 v[128:131], v[196:199], v[156:159], v[128:131]
    ds_read_b64_tr_b16 v[178:179], v227 offset:1288
    ds_read_b64_tr_b16 v[180:181], v227 offset:5128
    v_mfma_f32_16x16x32_bf16 v[132:135], v[192:195], v[160:163], v[132:135]
    ds_read_b64_tr_b16 v[182:183], v227 offset:6408
    v_mfma_f32_16x16x32_bf16 v[132:135], v[196:199], v[164:167], v[132:135]
    ds_read_b64_tr_b16 a[230:231], v254 offset:344
    s_waitcnt lgkmcnt(9)
    v_mfma_f32_16x16x32_bf16 v[16:19], v[168:171], v[136:139], v[16:19]
    buffer_load_dwordx4 v210, s[4:7], s70 offen offset:2048  lds
    s_waitcnt lgkmcnt(7)
    v_mfma_f32_16x16x32_bf16 v[16:19], v[172:175], v[140:143], v[16:19]
    ds_read_b64_tr_b16 v[184:185], v227 offset:16
    s_waitcnt lgkmcnt(7)
    v_mfma_f32_16x16x32_bf16 v[20:23], v[168:171], v[144:147], v[20:23]
    ds_read_b64_tr_b16 v[186:187], v227 offset:1296
    s_waitcnt lgkmcnt(7)
    v_mfma_f32_16x16x32_bf16 v[20:23], v[172:175], v[148:151], v[20:23]
    buffer_load_dwordx4 v211, s[4:7], s70 offen offset:3072  lds
    s_waitcnt lgkmcnt(3)
    v_mfma_f32_16x16x32_bf16 v[24:27], v[176:179], v[136:139], v[24:27]
    ds_read_b64_tr_b16 a[232:233], v254 offset:352
    ds_read_b64_tr_b16 v[188:189], v227 offset:5136
    ds_read_b64_tr_b16 v[190:191], v227 offset:6416
    v_mfma_f32_16x16x32_bf16 v[24:27], v[180:183], v[140:143], v[24:27]
    ds_read_b64_tr_b16 v[192:193], v227 offset:24
    ds_read_b64_tr_b16 v[194:195], v227 offset:1304
    v_mfma_f32_16x16x32_bf16 v[28:31], v[176:179], v[144:147], v[28:31]
    ds_read_b64_tr_b16 v[196:197], v227 offset:5144
    ds_read_b64_tr_b16 v[198:199], v227 offset:6424
    v_mfma_f32_16x16x32_bf16 v[28:31], v[180:183], v[148:151], v[28:31]
    ds_read_b64_tr_b16 v[168:169], v227 offset:32
    s_waitcnt lgkmcnt(5)
    v_mfma_f32_16x16x32_bf16 v[32:35], v[184:187], v[136:139], v[32:35]
    ds_read_b64_tr_b16 v[170:171], v227 offset:1312
    ds_read_b64_tr_b16 v[172:173], v227 offset:5152
    v_mfma_f32_16x16x32_bf16 v[32:35], v[188:191], v[140:143], v[32:35]
    ds_read_b64_tr_b16 v[174:175], v227 offset:6432
    s_mul_i32 s0, s70, 1920
    s_add_u32 m0, s81, 0
    v_mfma_f32_16x16x32_bf16 v[36:39], v[184:187], v[144:147], v[36:39]
    buffer_load_dwordx4 v212, s[8:11], s0 offen offset:0  lds
    ds_read_b64_tr_b16 v[176:177], v230 offset:0
    v_mfma_f32_16x16x32_bf16 v[36:39], v[188:191], v[148:151], v[36:39]
    ds_read_b64_tr_b16 a[234:235], v254 offset:480
    s_waitcnt lgkmcnt(6)
    v_mfma_f32_16x16x32_bf16 v[40:43], v[192:195], v[136:139], v[40:43]
    buffer_load_dwordx4 v213, s[8:11], s0 offen offset:1024  lds
    ds_read_b64_tr_b16 v[178:179], v230 offset:2560
    v_mfma_f32_16x16x32_bf16 v[40:43], v[196:199], v[140:143], v[40:43]
    ds_read_b64_tr_b16 v[180:181], v230 offset:10240
    ds_read_b64_tr_b16 v[182:183], v230 offset:12800
    v_mfma_f32_16x16x32_bf16 v[44:47], v[192:195], v[144:147], v[44:47]
    ds_read_b64_tr_b16 a[236:237], v254 offset:488
    ds_read_b64_tr_b16 v[184:185], v233 offset:0
    v_mfma_f32_16x16x32_bf16 v[44:47], v[196:199], v[148:151], v[44:47]
    ds_read_b64_tr_b16 v[186:187], v233 offset:2560
    s_waitcnt lgkmcnt(8)
    v_mfma_f32_16x16x32_bf16 v[48:51], v[168:171], v[136:139], v[48:51]
    ds_read_b64_tr_b16 v[188:189], v233 offset:10240
    ds_read_b64_tr_b16 v[190:191], v233 offset:12800
    v_mfma_f32_16x16x32_bf16 v[48:51], v[172:175], v[140:143], v[48:51]
    ds_read_b64_tr_b16 v[192:193], v230 offset:64
    s_mov_b32 m0, s83
    v_mfma_f32_16x16x32_bf16 v[52:55], v[168:171], v[144:147], v[52:55]
    buffer_load_dwordx4 v214, s[8:11], s0 offen offset:0  lds
    ds_read_b64_tr_b16 v[194:195], v230 offset:2624
    v_mfma_f32_16x16x32_bf16 v[52:55], v[172:175], v[148:151], v[52:55]
    ds_read_b64_tr_b16 a[238:239], v254 offset:496
    s_waitcnt lgkmcnt(8)
    v_mfma_f32_16x16x32_bf16 v[56:59], v[176:179], v[136:139], v[56:59]
    ds_read_b64_tr_b16 v[196:197], v230 offset:10304
    ds_read_b64_tr_b16 v[198:199], v230 offset:12864
    v_mfma_f32_16x16x32_bf16 v[56:59], v[180:183], v[140:143], v[56:59]
    ds_read_b64_tr_b16 v[168:169], v233 offset:64
    s_mul_i32 s1, s70, 1728
    s_add_u32 m0, s82, 0
    v_mfma_f32_16x16x32_bf16 v[60:63], v[176:179], v[144:147], v[60:63]
    buffer_load_dwordx4 v215, s[12:15], s1 offen offset:0  lds
    ds_read_b64_tr_b16 v[170:171], v233 offset:2624
    v_mfma_f32_16x16x32_bf16 v[60:63], v[180:183], v[148:151], v[60:63]
    buffer_load_dwordx4 v216, s[12:15], s1 offen offset:1024  lds
    s_waitcnt lgkmcnt(7)
    v_mfma_f32_16x16x32_bf16 v[64:67], v[184:187], v[136:139], v[64:67]
    ds_read_b64_tr_b16 a[240:241], v254 offset:504
    ds_read_b64_tr_b16 v[172:173], v233 offset:10304
    v_mfma_f32_16x16x32_bf16 v[64:67], v[188:191], v[140:143], v[64:67]
    ds_read_b64_tr_b16 v[174:175], v233 offset:12864
    v_mfma_f32_16x16x32_bf16 v[68:71], v[184:187], v[144:147], v[68:71]
    ds_read_b64_tr_b16 v[176:177], v230 offset:128
    v_mfma_f32_16x16x32_bf16 v[68:71], v[188:191], v[148:151], v[68:71]
    buffer_load_dwordx4 v217, s[12:15], s1 offen offset:2048  lds
    s_waitcnt lgkmcnt(6)
    v_mfma_f32_16x16x32_bf16 v[72:75], v[192:195], v[136:139], v[72:75]
    ds_read_b64_tr_b16 v[178:179], v230 offset:2688
    ds_read_b64_tr_b16 v[180:181], v230 offset:10368
    v_mfma_f32_16x16x32_bf16 v[72:75], v[196:199], v[140:143], v[72:75]
    ds_read_b64_tr_b16 a[242:243], v254 offset:512
    ds_read_b64_tr_b16 v[182:183], v230 offset:12928
    v_mfma_f32_16x16x32_bf16 v[76:79], v[192:195], v[144:147], v[76:79]
    ds_read_b64_tr_b16 v[184:185], v233 offset:128
    v_mfma_f32_16x16x32_bf16 v[76:79], v[196:199], v[148:151], v[76:79]
    buffer_load_dwordx4 v218, s[12:15], s1 offen offset:3072  lds
    s_waitcnt lgkmcnt(6)
    v_mfma_f32_16x16x32_bf16 v[80:83], v[168:171], v[136:139], v[80:83]
    ds_read_b64_tr_b16 v[186:187], v233 offset:2688
    ds_read_b64_tr_b16 v[188:189], v233 offset:10368
    v_mfma_f32_16x16x32_bf16 v[80:83], v[172:175], v[140:143], v[80:83]
    ds_read_b64_tr_b16 v[190:191], v233 offset:12928
    v_mfma_f32_16x16x32_bf16 v[84:87], v[168:171], v[144:147], v[84:87]
    ds_read_b64_tr_b16 a[244:245], v254 offset:640
    ds_read_b64_tr_b16 v[192:193], v230 offset:192
    v_mfma_f32_16x16x32_bf16 v[84:87], v[172:175], v[148:151], v[84:87]
    ds_read_b64_tr_b16 v[194:195], v230 offset:2752
    s_waitcnt lgkmcnt(7)
    v_mfma_f32_16x16x32_bf16 v[88:91], v[176:179], v[136:139], v[88:91]
    ds_read_b64_tr_b16 v[196:197], v230 offset:10432
    ds_read_b64_tr_b16 v[198:199], v230 offset:12992
    v_mfma_f32_16x16x32_bf16 v[88:91], v[180:183], v[140:143], v[88:91]
    ds_read_b64_tr_b16 v[168:169], v233 offset:192
    s_add_u32 m0, m0, 4096
    v_mfma_f32_16x16x32_bf16 v[92:95], v[176:179], v[144:147], v[92:95]
    buffer_load_dwordx4 v219, s[12:15], s1 offen offset:0  lds
    ds_read_b64_tr_b16 v[170:171], v233 offset:2752
    v_mfma_f32_16x16x32_bf16 v[92:95], v[180:183], v[148:151], v[92:95]
    ds_read_b64_tr_b16 a[246:247], v254 offset:648
    s_waitcnt lgkmcnt(8)
    v_mfma_f32_16x16x32_bf16 v[96:99], v[184:187], v[136:139], v[96:99]
    buffer_store_dwordx4 v[204:207], v6, s[16:19], s38 offen offset:0 sc1
    ds_read_b64_tr_b16 v[172:173], v233 offset:10432
    v_mfma_f32_16x16x32_bf16 v[96:99], v[188:191], v[140:143], v[96:99]
    ds_read_b64_tr_b16 v[174:175], v233 offset:12992
    v_mfma_f32_16x16x32_bf16 v[100:103], v[184:187], v[144:147], v[100:103]
    ds_read_b64_tr_b16 v[176:177], v230 offset:256
    v_mfma_f32_16x16x32_bf16 v[100:103], v[188:191], v[148:151], v[100:103]
    buffer_store_dwordx4 v[204:207], v6, s[16:19], s38 offen offset:1024 sc1
    s_waitcnt lgkmcnt(6)
    v_mfma_f32_16x16x32_bf16 v[104:107], v[192:195], v[136:139], v[104:107]
    ds_read_b64_tr_b16 a[248:249], v254 offset:656
    ds_read_b64_tr_b16 v[178:179], v230 offset:2816
    v_mfma_f32_16x16x32_bf16 v[104:107], v[196:199], v[140:143], v[104:107]
    ds_read_b64_tr_b16 v[180:181], v230 offset:10496
    ds_read_b64_tr_b16 v[182:183], v230 offset:13056
    v_mfma_f32_16x16x32_bf16 v[108:111], v[192:195], v[144:147], v[108:111]
    ds_read_b64_tr_b16 v[184:185], v233 offset:256
    v_mfma_f32_16x16x32_bf16 v[108:111], v[196:199], v[148:151], v[108:111]
    ds_read_b64_tr_b16 v[186:187], v233 offset:2816
    s_waitcnt lgkmcnt(7)
    v_mfma_f32_16x16x32_bf16 v[112:115], v[168:171], v[136:139], v[112:115]
    ds_read_b64_tr_b16 v[188:189], v233 offset:10496
    ds_read_b64_tr_b16 v[190:191], v233 offset:13056
    v_mfma_f32_16x16x32_bf16 v[112:115], v[172:175], v[140:143], v[112:115]
    ds_read_b64_tr_b16 a[250:251], v254 offset:664
    v_mfma_f32_16x16x32_bf16 v[116:119], v[168:171], v[144:147], v[116:119]
    s_waitcnt vmcnt(18) lgkmcnt(0)
    s_barrier
    ds_read_b64_tr_b16 v[192:193], v228 offset:0
    v_mfma_f32_16x16x32_bf16 v[116:119], v[172:175], v[148:151], v[116:119]
    ds_read_b64_tr_b16 v[194:195], v228 offset:1280
    s_add_u32 m0, s80, 47104
    v_mfma_f32_16x16x32_bf16 v[120:123], v[176:179], v[136:139], v[120:123]
    buffer_load_dwordx4 v208, s[4:7], s71 offen offset:0  lds
    ds_read_b64_tr_b16 v[196:197], v228 offset:5120
    v_mfma_f32_16x16x32_bf16 v[120:123], v[180:183], v[140:143], v[120:123]
    ds_read_b64_tr_b16 v[198:199], v228 offset:6400
    ds_read_b128 v[152:155], v224 offset:0
    v_mfma_f32_16x16x32_bf16 v[124:127], v[176:179], v[144:147], v[124:127]
    ds_read_b64_tr_b16 a[252:253], v254 offset:672
    ds_read_b128 v[156:159], v225 offset:0
    v_mfma_f32_16x16x32_bf16 v[124:127], v[180:183], v[148:151], v[124:127]
    buffer_load_dwordx4 v209, s[4:7], s71 offen offset:1024  lds
    ds_read_b128 v[160:163], v224 offset:2048
    v_mfma_f32_16x16x32_bf16 v[128:131], v[184:187], v[136:139], v[128:131]
    ds_read_b128 v[164:167], v225 offset:2048
    ds_read_b64_tr_b16 v[168:169], v228 offset:8
    v_mfma_f32_16x16x32_bf16 v[128:131], v[188:191], v[140:143], v[128:131]
    ds_read_b64_tr_b16 v[170:171], v228 offset:1288
    ds_read_b64_tr_b16 v[172:173], v228 offset:5128
    v_mfma_f32_16x16x32_bf16 v[132:135], v[184:187], v[144:147], v[132:135]
    ds_read_b64_tr_b16 v[174:175], v228 offset:6408
    v_mfma_f32_16x16x32_bf16 v[132:135], v[188:191], v[148:151], v[132:135]
    buffer_load_dwordx4 v210, s[4:7], s71 offen offset:2048  lds
    s_waitcnt lgkmcnt(8)
    v_mfma_f32_16x16x32_bf16 v[16:19], v[192:195], v[152:155], v[16:19]
    ds_read_b64_tr_b16 v[176:177], v228 offset:16
    s_waitcnt lgkmcnt(7)
    v_mfma_f32_16x16x32_bf16 v[16:19], v[196:199], v[156:159], v[16:19]
    ds_read_b64_tr_b16 v[178:179], v228 offset:1296
    s_waitcnt lgkmcnt(7)
    v_mfma_f32_16x16x32_bf16 v[20:23], v[192:195], v[160:163], v[20:23]
    ds_read_b64_tr_b16 v[180:181], v228 offset:5136
    s_waitcnt lgkmcnt(7)
    v_mfma_f32_16x16x32_bf16 v[20:23], v[196:199], v[164:167], v[20:23]
    buffer_load_dwordx4 v211, s[4:7], s71 offen offset:3072  lds
    s_waitcnt lgkmcnt(3)
    v_mfma_f32_16x16x32_bf16 v[24:27], v[168:171], v[152:155], v[24:27]
    ds_read_b64_tr_b16 v[182:183], v228 offset:6416
    ds_read_b64_tr_b16 v[184:185], v228 offset:24
    v_mfma_f32_16x16x32_bf16 v[24:27], v[172:175], v[156:159], v[24:27]
    ds_read_b64_tr_b16 v[186:187], v228 offset:1304
    ds_read_b64_tr_b16 v[188:189], v228 offset:5144
    v_mfma_f32_16x16x32_bf16 v[28:31], v[168:171], v[160:163], v[28:31]
    ds_read_b64_tr_b16 v[190:191], v228 offset:6424
    s_mul_i32 s0, s71, 1920
    v_mfma_f32_16x16x32_bf16 v[28:31], v[172:175], v[164:167], v[28:31]
    ds_read_b64_tr_b16 v[192:193], v228 offset:32
    s_waitcnt lgkmcnt(5)
    v_mfma_f32_16x16x32_bf16 v[32:35], v[176:179], v[152:155], v[32:35]
    ds_read_b64_tr_b16 v[194:195], v228 offset:1312
    ds_read_b64_tr_b16 v[196:197], v228 offset:5152
    v_mfma_f32_16x16x32_bf16 v[32:35], v[180:183], v[156:159], v[32:35]
    ds_read_b64_tr_b16 v[198:199], v228 offset:6432
    s_add_u32 m0, s81, 47104
    v_mfma_f32_16x16x32_bf16 v[36:39], v[176:179], v[160:163], v[36:39]
    buffer_load_dwordx4 v212, s[8:11], s0 offen offset:0  lds
    ds_read_b64_tr_b16 v[168:169], v231 offset:0
    v_mfma_f32_16x16x32_bf16 v[36:39], v[180:183], v[164:167], v[36:39]
    buffer_load_dwordx4 v213, s[8:11], s0 offen offset:1024  lds
    s_waitcnt lgkmcnt(5)
    v_mfma_f32_16x16x32_bf16 v[40:43], v[184:187], v[152:155], v[40:43]
    ds_read_b64_tr_b16 v[170:171], v231 offset:2560
    ds_read_b64_tr_b16 v[172:173], v231 offset:10240
    v_mfma_f32_16x16x32_bf16 v[40:43], v[188:191], v[156:159], v[40:43]
    ds_read_b64_tr_b16 v[174:175], v231 offset:12800
    s_mov_b32 m0, s84
    v_mfma_f32_16x16x32_bf16 v[44:47], v[184:187], v[160:163], v[44:47]
    ds_read_b64_tr_b16 v[176:177], v234 offset:0
    v_mfma_f32_16x16x32_bf16 v[44:47], v[188:191], v[164:167], v[44:47]
    buffer_load_dwordx4 v214, s[8:11], s0 offen offset:0  lds
    s_waitcnt lgkmcnt(5)
    v_mfma_f32_16x16x32_bf16 v[48:51], v[192:195], v[152:155], v[48:51]
    ds_read_b64_tr_b16 v[178:179], v234 offset:2560
    ds_read_b64_tr_b16 v[180:181], v234 offset:10240
    v_mfma_f32_16x16x32_bf16 v[48:51], v[196:199], v[156:159], v[48:51]
    ds_read_b64_tr_b16 v[182:183], v234 offset:12800
    s_mul_i32 s1, s71, 1728
    v_mfma_f32_16x16x32_bf16 v[52:55], v[192:195], v[160:163], v[52:55]
    ds_read_b64_tr_b16 v[184:185], v231 offset:64
    s_add_u32 m0, s82, 47104
    v_mfma_f32_16x16x32_bf16 v[52:55], v[196:199], v[164:167], v[52:55]
    buffer_load_dwordx4 v215, s[12:15], s1 offen offset:0  lds
    s_waitcnt lgkmcnt(5)
    v_mfma_f32_16x16x32_bf16 v[56:59], v[168:171], v[152:155], v[56:59]
    ds_read_b64_tr_b16 v[186:187], v231 offset:2624
    ds_read_b64_tr_b16 v[188:189], v231 offset:10304
    v_mfma_f32_16x16x32_bf16 v[56:59], v[172:175], v[156:159], v[56:59]
    ds_read_b64_tr_b16 v[190:191], v231 offset:12864
    v_mfma_f32_16x16x32_bf16 v[60:63], v[168:171], v[160:163], v[60:63]
    ds_read_b64_tr_b16 v[192:193], v234 offset:64
    v_mfma_f32_16x16x32_bf16 v[60:63], v[172:175], v[164:167], v[60:63]
    buffer_load_dwordx4 v216, s[12:15], s1 offen offset:1024  lds
    s_waitcnt lgkmcnt(5)
    v_mfma_f32_16x16x32_bf16 v[64:67], v[176:179], v[152:155], v[64:67]
    ds_read_b64_tr_b16 v[194:195], v234 offset:2624
    ds_read_b64_tr_b16 v[196:197], v234 offset:10304
    v_mfma_f32_16x16x32_bf16 v[64:67], v[180:183], v[156:159], v[64:67]
    ds_read_b64_tr_b16 v[198:199], v234 offset:12864
    v_mfma_f32_16x16x32_bf16 v[68:71], v[176:179], v[160:163], v[68:71]
    ds_read_b64_tr_b16 v[168:169], v231 offset:128
    v_mfma_f32_16x16x32_bf16 v[68:71], v[180:183], v[164:167], v[68:71]
    buffer_load_dwordx4 v217, s[12:15], s1 offen offset:2048  lds
    s_waitcnt lgkmcnt(5)
    v_mfma_f32_16x16x32_bf16 v[72:75], v[184:187], v[152:155], v[72:75]
    ds_read_b64_tr_b16 v[170:171], v231 offset:2688
    ds_read_b64_tr_b16 v[172:173], v231 offset:10368
    v_mfma_f32_16x16x32_bf16 v[72:75], v[188:191], v[156:159], v[72:75]
    ds_read_b64_tr_b16 v[174:175], v231 offset:12928
    v_mfma_f32_16x16x32_bf16 v[76:79], v[184:187], v[160:163], v[76:79]
    ds_read_b64_tr_b16 v[176:177], v234 offset:128
    v_mfma_f32_16x16x32_bf16 v[76:79], v[188:191], v[164:167], v[76:79]
    buffer_load_dwordx4 v218, s[12:15], s1 offen offset:3072  lds
    s_waitcnt lgkmcnt(5)
    v_mfma_f32_16x16x32_bf16 v[80:83], v[192:195], v[152:155], v[80:83]
    ds_read_b64_tr_b16 v[178:179], v234 offset:2688
    ds_read_b64_tr_b16 v[180:181], v234 offset:10368
    v_mfma_f32_16x16x32_bf16 v[80:83], v[196:199], v[156:159], v[80:83]
    ds_read_b64_tr_b16 v[182:183], v234 offset:12928
    s_add_u32 m0, m0, 4096
    v_mfma_f32_16x16x32_bf16 v[84:87], v[192:195], v[160:163], v[84:87]
    ds_read_b64_tr_b16 v[184:185], v231 offset:192
    v_mfma_f32_16x16x32_bf16 v[84:87], v[196:199], v[164:167], v[84:87]
    buffer_load_dwordx4 v219, s[12:15], s1 offen offset:0  lds
    s_waitcnt lgkmcnt(5)
    v_mfma_f32_16x16x32_bf16 v[88:91], v[168:171], v[152:155], v[88:91]
    ds_read_b64_tr_b16 v[186:187], v231 offset:2752
    ds_read_b64_tr_b16 v[188:189], v231 offset:10432
    v_mfma_f32_16x16x32_bf16 v[88:91], v[172:175], v[156:159], v[88:91]
    ds_read_b64_tr_b16 v[190:191], v231 offset:12992
    v_mfma_f32_16x16x32_bf16 v[92:95], v[168:171], v[160:163], v[92:95]
    ds_read_b64_tr_b16 v[192:193], v234 offset:192
    v_mfma_f32_16x16x32_bf16 v[92:95], v[172:175], v[164:167], v[92:95]
    buffer_store_dwordx4 v[204:207], v240, s[16:19], s38 offen offset:0 sc1
    s_waitcnt lgkmcnt(5)
    v_mfma_f32_16x16x32_bf16 v[96:99], v[176:179], v[152:155], v[96:99]
    ds_read_b64_tr_b16 v[194:195], v234 offset:2752
    ds_read_b64_tr_b16 v[196:197], v234 offset:10432
    v_mfma_f32_16x16x32_bf16 v[96:99], v[180:183], v[156:159], v[96:99]
    ds_read_b64_tr_b16 v[198:199], v234 offset:12992
    v_mfma_f32_16x16x32_bf16 v[100:103], v[176:179], v[160:163], v[100:103]
    ds_read_b64_tr_b16 v[168:169], v231 offset:256
    v_mfma_f32_16x16x32_bf16 v[100:103], v[180:183], v[164:167], v[100:103]
    buffer_store_dwordx4 v[204:207], v240, s[16:19], s38 offen offset:1024 sc1
    s_waitcnt lgkmcnt(5)
    v_mfma_f32_16x16x32_bf16 v[104:107], v[184:187], v[152:155], v[104:107]
    ds_read_b64_tr_b16 v[170:171], v231 offset:2816
    ds_read_b64_tr_b16 v[172:173], v231 offset:10496
    v_mfma_f32_16x16x32_bf16 v[104:107], v[188:191], v[156:159], v[104:107]
    ds_read_b64_tr_b16 v[174:175], v231 offset:13056
    v_mfma_f32_16x16x32_bf16 v[108:111], v[184:187], v[160:163], v[108:111]
    ds_read_b64_tr_b16 v[176:177], v234 offset:256
    v_mfma_f32_16x16x32_bf16 v[108:111], v[188:191], v[164:167], v[108:111]
    ds_read_b64_tr_b16 v[178:179], v234 offset:2816
    s_waitcnt lgkmcnt(6)
    v_mfma_f32_16x16x32_bf16 v[112:115], v[192:195], v[152:155], v[112:115]
    ds_read_b64_tr_b16 v[180:181], v234 offset:10496
    ds_read_b64_tr_b16 v[182:183], v234 offset:13056
    v_mfma_f32_16x16x32_bf16 v[112:115], v[196:199], v[156:159], v[112:115]
    v_mfma_f32_16x16x32_bf16 v[116:119], v[192:195], v[160:163], v[116:119]
    s_waitcnt vmcnt(16) lgkmcnt(0)
    s_barrier
    ds_read_b64_tr_b16 v[184:185], v226 offset:0
    v_mfma_f32_16x16x32_bf16 v[116:119], v[196:199], v[164:167], v[116:119]
    ds_read_b64_tr_b16 v[186:187], v226 offset:1280
    s_add_u32 m0, s80, 94208
    v_mfma_f32_16x16x32_bf16 v[120:123], v[168:171], v[152:155], v[120:123]
    buffer_load_dwordx4 v208, s[4:7], s72 offen offset:0  lds
    ds_read_b64_tr_b16 v[188:189], v226 offset:5120
    v_mfma_f32_16x16x32_bf16 v[120:123], v[172:175], v[156:159], v[120:123]
    buffer_store_dwordx2 v[246:247], v245, s[16:19], s91 offen sc1
    ds_read_b64_tr_b16 v[190:191], v226 offset:6400
    v_mfma_f32_16x16x32_bf16 v[124:127], v[168:171], v[160:163], v[124:127]
    ds_read_b128 v[136:139], v220 offset:0
    ds_read_b128 v[140:143], v221 offset:0
    v_mfma_f32_16x16x32_bf16 v[124:127], v[172:175], v[164:167], v[124:127]
    buffer_load_dwordx4 v209, s[4:7], s72 offen offset:1024  lds
    ds_read_b128 v[144:147], v220 offset:2048
    v_mfma_f32_16x16x32_bf16 v[128:131], v[176:179], v[152:155], v[128:131]
    ds_read_b128 v[148:151], v221 offset:2048
    ds_read_b64_tr_b16 v[192:193], v226 offset:8
    v_mfma_f32_16x16x32_bf16 v[128:131], v[180:183], v[156:159], v[128:131]
    ds_read_b64_tr_b16 v[194:195], v226 offset:1288
    ds_read_b64_tr_b16 v[196:197], v226 offset:5128
    v_mfma_f32_16x16x32_bf16 v[132:135], v[176:179], v[160:163], v[132:135]
    ds_read_b64_tr_b16 v[198:199], v226 offset:6408
    v_mfma_f32_16x16x32_bf16 v[132:135], v[180:183], v[164:167], v[132:135]
    buffer_load_dwordx4 v210, s[4:7], s72 offen offset:2048  lds
    s_waitcnt lgkmcnt(7)
    v_mfma_f32_16x16x32_bf16 v[16:19], v[184:187], v[136:139], v[16:19]
    ds_read_b64_tr_b16 v[168:169], v226 offset:16
    s_waitcnt lgkmcnt(7)
    v_mfma_f32_16x16x32_bf16 v[16:19], v[188:191], v[140:143], v[16:19]
    ds_read_b64_tr_b16 v[170:171], v226 offset:1296
    s_waitcnt lgkmcnt(7)
    v_mfma_f32_16x16x32_bf16 v[20:23], v[184:187], v[144:147], v[20:23]
    ds_read_b64_tr_b16 v[172:173], v226 offset:5136
    s_waitcnt lgkmcnt(7)
    v_mfma_f32_16x16x32_bf16 v[20:23], v[188:191], v[148:151], v[20:23]
    buffer_load_dwordx4 v211, s[4:7], s72 offen offset:3072  lds
    s_waitcnt lgkmcnt(3)
    v_mfma_f32_16x16x32_bf16 v[24:27], v[192:195], v[136:139], v[24:27]
    ds_read_b64_tr_b16 v[174:175], v226 offset:6416
    ds_read_b64_tr_b16 v[176:177], v226 offset:24
    v_mfma_f32_16x16x32_bf16 v[24:27], v[196:199], v[140:143], v[24:27]
    ds_read_b64_tr_b16 v[178:179], v226 offset:1304
    ds_read_b64_tr_b16 v[180:181], v226 offset:5144
    v_mfma_f32_16x16x32_bf16 v[28:31], v[192:195], v[144:147], v[28:31]
    ds_read_b64_tr_b16 v[182:183], v226 offset:6424
    s_mul_i32 s0, s72, 1920
    v_mfma_f32_16x16x32_bf16 v[28:31], v[196:199], v[148:151], v[28:31]
    ds_read_b64_tr_b16 v[184:185], v226 offset:32
    s_waitcnt lgkmcnt(5)
    v_mfma_f32_16x16x32_bf16 v[32:35], v[168:171], v[136:139], v[32:35]
    ds_read_b64_tr_b16 v[186:187], v226 offset:1312
    ds_read_b64_tr_b16 v[188:189], v226 offset:5152
    v_mfma_f32_16x16x32_bf16 v[32:35], v[172:175], v[140:143], v[32:35]
    ds_read_b64_tr_b16 v[190:191], v226 offset:6432
    s_add_u32 m0, s81, 94208
    v_mfma_f32_16x16x32_bf16 v[36:39], v[168:171], v[144:147], v[36:39]
    buffer_load_dwordx4 v212, s[8:11], s0 offen offset:0  lds
    ds_read_b64_tr_b16 v[192:193], v229 offset:0
    v_mfma_f32_16x16x32_bf16 v[36:39], v[172:175], v[148:151], v[36:39]
    buffer_load_dwordx4 v213, s[8:11], s0 offen offset:1024  lds
    s_waitcnt lgkmcnt(5)
    v_mfma_f32_16x16x32_bf16 v[40:43], v[176:179], v[136:139], v[40:43]
    ds_read_b64_tr_b16 v[194:195], v229 offset:2560
    ds_read_b64_tr_b16 v[196:197], v229 offset:10240
    v_mfma_f32_16x16x32_bf16 v[40:43], v[180:183], v[140:143], v[40:43]
    ds_read_b64_tr_b16 v[198:199], v229 offset:12800
    s_mov_b32 m0, s85
    v_mfma_f32_16x16x32_bf16 v[44:47], v[176:179], v[144:147], v[44:47]
    ds_read_b64_tr_b16 v[168:169], v232 offset:0
    v_mfma_f32_16x16x32_bf16 v[44:47], v[180:183], v[148:151], v[44:47]
    buffer_load_dwordx4 v214, s[8:11], s0 offen offset:0  lds
    s_waitcnt lgkmcnt(5)
    v_mfma_f32_16x16x32_bf16 v[48:51], v[184:187], v[136:139], v[48:51]
    ds_read_b64_tr_b16 v[170:171], v232 offset:2560
    ds_read_b64_tr_b16 v[172:173], v232 offset:10240
    v_mfma_f32_16x16x32_bf16 v[48:51], v[188:191], v[140:143], v[48:51]
    ds_read_b64_tr_b16 v[174:175], v232 offset:12800
    s_mul_i32 s1, s72, 1728
    v_mfma_f32_16x16x32_bf16 v[52:55], v[184:187], v[144:147], v[52:55]
    ds_read_b64_tr_b16 v[176:177], v229 offset:64
    s_add_u32 m0, s82, 94208
    v_mfma_f32_16x16x32_bf16 v[52:55], v[188:191], v[148:151], v[52:55]
    buffer_load_dwordx4 v215, s[12:15], s1 offen offset:0  lds
    s_waitcnt lgkmcnt(5)
    v_mfma_f32_16x16x32_bf16 v[56:59], v[192:195], v[136:139], v[56:59]
    ds_read_b64_tr_b16 v[178:179], v229 offset:2624
    ds_read_b64_tr_b16 v[180:181], v229 offset:10304
    v_mfma_f32_16x16x32_bf16 v[56:59], v[196:199], v[140:143], v[56:59]
    ds_read_b64_tr_b16 v[182:183], v229 offset:12864
    v_mfma_f32_16x16x32_bf16 v[60:63], v[192:195], v[144:147], v[60:63]
    ds_read_b64_tr_b16 v[184:185], v232 offset:64
    v_mfma_f32_16x16x32_bf16 v[60:63], v[196:199], v[148:151], v[60:63]
    buffer_load_dwordx4 v216, s[12:15], s1 offen offset:1024  lds
    s_waitcnt lgkmcnt(5)
    v_mfma_f32_16x16x32_bf16 v[64:67], v[168:171], v[136:139], v[64:67]
    ds_read_b64_tr_b16 v[186:187], v232 offset:2624
    ds_read_b64_tr_b16 v[188:189], v232 offset:10304
    v_mfma_f32_16x16x32_bf16 v[64:67], v[172:175], v[140:143], v[64:67]
    ds_read_b64_tr_b16 v[190:191], v232 offset:12864
    v_mfma_f32_16x16x32_bf16 v[68:71], v[168:171], v[144:147], v[68:71]
    ds_read_b64_tr_b16 v[192:193], v229 offset:128
    v_mfma_f32_16x16x32_bf16 v[68:71], v[172:175], v[148:151], v[68:71]
    buffer_load_dwordx4 v217, s[12:15], s1 offen offset:2048  lds
    s_waitcnt lgkmcnt(5)
    v_mfma_f32_16x16x32_bf16 v[72:75], v[176:179], v[136:139], v[72:75]
    ds_read_b64_tr_b16 v[194:195], v229 offset:2688
    ds_read_b64_tr_b16 v[196:197], v229 offset:10368
    v_mfma_f32_16x16x32_bf16 v[72:75], v[180:183], v[140:143], v[72:75]
    ds_read_b64_tr_b16 v[198:199], v229 offset:12928
    v_mfma_f32_16x16x32_bf16 v[76:79], v[176:179], v[144:147], v[76:79]
    ds_read_b64_tr_b16 v[168:169], v232 offset:128
    v_mfma_f32_16x16x32_bf16 v[76:79], v[180:183], v[148:151], v[76:79]
    buffer_load_dwordx4 v218, s[12:15], s1 offen offset:3072  lds
    s_waitcnt lgkmcnt(5)
    v_mfma_f32_16x16x32_bf16 v[80:83], v[184:187], v[136:139], v[80:83]
    ds_read_b64_tr_b16 v[170:171], v232 offset:2688
    ds_read_b64_tr_b16 v[172:173], v232 offset:10368
    v_mfma_f32_16x16x32_bf16 v[80:83], v[188:191], v[140:143], v[80:83]
    ds_read_b64_tr_b16 v[174:175], v232 offset:12928
    s_add_u32 m0, m0, 4096
    v_mfma_f32_16x16x32_bf16 v[84:87], v[184:187], v[144:147], v[84:87]
    ds_read_b64_tr_b16 v[176:177], v229 offset:192
    v_mfma_f32_16x16x32_bf16 v[84:87], v[188:191], v[148:151], v[84:87]
    buffer_load_dwordx4 v219, s[12:15], s1 offen offset:0  lds
    s_waitcnt lgkmcnt(5)
    v_mfma_f32_16x16x32_bf16 v[88:91], v[192:195], v[136:139], v[88:91]
    ds_read_b64_tr_b16 v[178:179], v229 offset:2752
    ds_read_b64_tr_b16 v[180:181], v229 offset:10432
    v_mfma_f32_16x16x32_bf16 v[88:91], v[196:199], v[140:143], v[88:91]
    ds_read_b64_tr_b16 v[182:183], v229 offset:12992
    v_mfma_f32_16x16x32_bf16 v[92:95], v[192:195], v[144:147], v[92:95]
    ds_read_b64_tr_b16 v[184:185], v232 offset:192
    v_mfma_f32_16x16x32_bf16 v[92:95], v[196:199], v[148:151], v[92:95]
    buffer_store_dwordx2 v[204:205], v6, s[16:19], s39 offen offset:0 sc1
    s_waitcnt lgkmcnt(5)
    v_mfma_f32_16x16x32_bf16 v[96:99], v[168:171], v[136:139], v[96:99]
    ds_read_b64_tr_b16 v[186:187], v232 offset:2752
    ds_read_b64_tr_b16 v[188:189], v232 offset:10432
    v_mfma_f32_16x16x32_bf16 v[96:99], v[172:175], v[140:143], v[96:99]
    ds_read_b64_tr_b16 v[190:191], v232 offset:12992
    v_mfma_f32_16x16x32_bf16 v[100:103], v[168:171], v[144:147], v[100:103]
    ds_read_b64_tr_b16 v[192:193], v229 offset:256
    v_mfma_f32_16x16x32_bf16 v[100:103], v[172:175], v[148:151], v[100:103]
    buffer_store_dwordx2 v[204:205], v6, s[16:19], s39 offen offset:1024 sc1
    s_waitcnt lgkmcnt(5)
    v_mfma_f32_16x16x32_bf16 v[104:107], v[176:179], v[136:139], v[104:107]
    ds_read_b64_tr_b16 v[194:195], v229 offset:2816
    ds_read_b64_tr_b16 v[196:197], v229 offset:10496
    v_mfma_f32_16x16x32_bf16 v[104:107], v[180:183], v[140:143], v[104:107]
    ds_read_b64_tr_b16 v[198:199], v229 offset:13056
    v_mfma_f32_16x16x32_bf16 v[108:111], v[176:179], v[144:147], v[108:111]
    ds_read_b64_tr_b16 v[168:169], v232 offset:256
    v_mfma_f32_16x16x32_bf16 v[108:111], v[180:183], v[148:151], v[108:111]
    ds_read_b64_tr_b16 v[170:171], v232 offset:2816
    s_waitcnt lgkmcnt(6)
    v_mfma_f32_16x16x32_bf16 v[112:115], v[184:187], v[136:139], v[112:115]
    ds_read_b64_tr_b16 v[172:173], v232 offset:10496
    ds_read_b64_tr_b16 v[174:175], v232 offset:13056
    v_mfma_f32_16x16x32_bf16 v[112:115], v[188:191], v[140:143], v[112:115]
    v_mfma_f32_16x16x32_bf16 v[116:119], v[184:187], v[144:147], v[116:119]
    s_waitcnt vmcnt(17) lgkmcnt(0)
    s_barrier
    ds_read_b64_tr_b16 v[176:177], v227 offset:0
    v_mfma_f32_16x16x32_bf16 v[116:119], v[188:191], v[148:151], v[116:119]
    ds_read_b64_tr_b16 v[178:179], v227 offset:1280
    s_add_u32 m0, s80, 0
    v_mfma_f32_16x16x32_bf16 v[120:123], v[192:195], v[136:139], v[120:123]
    buffer_load_dwordx4 v208, s[4:7], s73 offen offset:0  lds
    ds_read_b64_tr_b16 v[180:181], v227 offset:5120
    v_mfma_f32_16x16x32_bf16 v[120:123], v[196:199], v[140:143], v[120:123]
    ds_read_b64_tr_b16 v[182:183], v227 offset:6400
    ds_read_b128 v[152:155], v222 offset:0
    v_mfma_f32_16x16x32_bf16 v[124:127], v[192:195], v[144:147], v[124:127]
    ds_read_b128 v[156:159], v223 offset:0
    ds_read_b128 v[160:163], v222 offset:2048
    v_mfma_f32_16x16x32_bf16 v[124:127], v[196:199], v[148:151], v[124:127]
    ds_read_b128 v[164:167], v223 offset:2048
    v_mfma_f32_16x16x32_bf16 v[128:131], v[168:171], v[136:139], v[128:131]
    buffer_load_dwordx4 v209, s[4:7], s73 offen offset:1024  lds
    ds_read_b64_tr_b16 v[184:185], v227 offset:8
    v_mfma_f32_16x16x32_bf16 v[128:131], v[172:175], v[140:143], v[128:131]
    ds_read_b64_tr_b16 v[186:187], v227 offset:1288
    ds_read_b64_tr_b16 v[188:189], v227 offset:5128
    v_mfma_f32_16x16x32_bf16 v[132:135], v[168:171], v[144:147], v[132:135]
    ds_read_b64_tr_b16 v[190:191], v227 offset:6408
    v_mfma_f32_16x16x32_bf16 v[132:135], v[172:175], v[148:151], v[132:135]
    ds_read_b64_tr_b16 v[192:193], v227 offset:16
    s_waitcnt lgkmcnt(8)
    v_mfma_f32_16x16x32_bf16 v[16:19], v[176:179], v[152:155], v[16:19]
    ds_read_b64_tr_b16 v[194:195], v227 offset:1296
    s_waitcnt lgkmcnt(8)
    v_mfma_f32_16x16x32_bf16 v[16:19], v[180:183], v[156:159], v[16:19]
    buffer_load_dwordx4 v210, s[4:7], s73 offen offset:2048  lds
    s_waitcnt lgkmcnt(7)
    v_mfma_f32_16x16x32_bf16 v[20:23], v[176:179], v[160:163], v[20:23]
    ds_read_b64_tr_b16 v[196:197], v227 offset:5136
    s_waitcnt lgkmcnt(7)
    v_mfma_f32_16x16x32_bf16 v[20:23], v[180:183], v[164:167], v[20:23]
    ds_read_b64_tr_b16 v[198:199], v227 offset:6416
    s_waitcnt lgkmcnt(4)
    v_mfma_f32_16x16x32_bf16 v[24:27], v[184:187], v[152:155], v[24:27]
    ds_read_b64_tr_b16 v[168:169], v227 offset:24
    ds_read_b64_tr_b16 v[170:171], v227 offset:1304
    v_mfma_f32_16x16x32_bf16 v[24:27], v[188:191], v[156:159], v[24:27]
    buffer_load_dwordx4 v211, s[4:7], s73 offen offset:3072  lds
    ds_read_b64_tr_b16 v[172:173], v227 offset:5144
    v_mfma_f32_16x16x32_bf16 v[28:31], v[184:187], v[160:163], v[28:31]
    ds_read_b64_tr_b16 v[174:175], v227 offset:6424
    v_mfma_f32_16x16x32_bf16 v[28:31], v[188:191], v[164:167], v[28:31]
    ds_read_b64_tr_b16 v[176:177], v227 offset:32
    s_waitcnt lgkmcnt(5)
    v_mfma_f32_16x16x32_bf16 v[32:35], v[192:195], v[152:155], v[32:35]
    ds_read_b64_tr_b16 v[178:179], v227 offset:1312
    ds_read_b64_tr_b16 v[180:181], v227 offset:5152
    v_mfma_f32_16x16x32_bf16 v[32:35], v[196:199], v[156:159], v[32:35]
    ds_read_b64_tr_b16 v[182:183], v227 offset:6432
    s_mul_i32 s0, s73, 1920
    v_mfma_f32_16x16x32_bf16 v[36:39], v[192:195], v[160:163], v[36:39]
    ds_read_b64_tr_b16 v[184:185], v230 offset:0
    s_add_u32 m0, s81, 0
    v_mfma_f32_16x16x32_bf16 v[36:39], v[196:199], v[164:167], v[36:39]
    buffer_load_dwordx4 v212, s[8:11], s0 offen offset:0  lds
    s_waitcnt lgkmcnt(5)
    v_mfma_f32_16x16x32_bf16 v[40:43], v[168:171], v[152:155], v[40:43]
    ds_read_b64_tr_b16 v[186:187], v230 offset:2560
    ds_read_b64_tr_b16 v[188:189], v230 offset:10240
    v_mfma_f32_16x16x32_bf16 v[40:43], v[172:175], v[156:159], v[40:43]
    ds_read_b64_tr_b16 v[190:191], v230 offset:12800
    v_mfma_f32_16x16x32_bf16 v[44:47], v[168:171], v[160:163], v[44:47]
    ds_read_b64_tr_b16 v[192:193], v233 offset:0
    v_mfma_f32_16x16x32_bf16 v[44:47], v[172:175], v[164:167], v[44:47]
    buffer_load_dwordx4 v213, s[8:11], s0 offen offset:1024  lds
    s_waitcnt lgkmcnt(5)
    v_mfma_f32_16x16x32_bf16 v[48:51], v[176:179], v[152:155], v[48:51]
    ds_read_b64_tr_b16 v[194:195], v233 offset:2560
    ds_read_b64_tr_b16 v[196:197], v233 offset:10240
    v_mfma_f32_16x16x32_bf16 v[48:51], v[180:183], v[156:159], v[48:51]
    ds_read_b64_tr_b16 v[198:199], v233 offset:12800
    s_mov_b32 m0, s83
    v_mfma_f32_16x16x32_bf16 v[52:55], v[176:179], v[160:163], v[52:55]
    ds_read_b64_tr_b16 v[168:169], v230 offset:64
    v_mfma_f32_16x16x32_bf16 v[52:55], v[180:183], v[164:167], v[52:55]
    buffer_load_dwordx4 v214, s[8:11], s0 offen offset:0  lds
    s_waitcnt lgkmcnt(5)
    v_mfma_f32_16x16x32_bf16 v[56:59], v[184:187], v[152:155], v[56:59]
    ds_read_b64_tr_b16 v[170:171], v230 offset:2624
    ds_read_b64_tr_b16 v[172:173], v230 offset:10304
    v_mfma_f32_16x16x32_bf16 v[56:59], v[188:191], v[156:159], v[56:59]
    ds_read_b64_tr_b16 v[174:175], v230 offset:12864
    s_mul_i32 s74, s63, 5
    v_mfma_f32_16x16x32_bf16 v[60:63], v[184:187], v[160:163], v[60:63]
    ds_read_b64_tr_b16 v[176:177], v233 offset:64
    s_add_u32 s75, s74, 4
    v_mfma_f32_16x16x32_bf16 v[60:63], v[188:191], v[164:167], v[60:63]
    ds_read_b64_tr_b16 v[178:179], v233 offset:2624
    s_lshr_b32 s74, s74, 2
    s_waitcnt lgkmcnt(6)
    v_mfma_f32_16x16x32_bf16 v[64:67], v[192:195], v[152:155], v[64:67]
    ds_read_b64_tr_b16 v[180:181], v233 offset:10304
    ds_read_b64_tr_b16 v[182:183], v233 offset:12864
    s_mul_i32 s74, s74, 74
    v_mfma_f32_16x16x32_bf16 v[64:67], v[196:199], v[156:159], v[64:67]
    ds_read_b64_tr_b16 v[184:185], v230 offset:128
    s_lshr_b32 s74, s74, 2
    s_lshr_b32 s75, s75, 2
    v_mfma_f32_16x16x32_bf16 v[68:71], v[192:195], v[160:163], v[68:71]
    ds_read_b64_tr_b16 v[186:187], v230 offset:2688
    s_mul_i32 s75, s75, 74
    s_add_u32 s75, s75, 73
    v_mfma_f32_16x16x32_bf16 v[68:71], v[196:199], v[164:167], v[68:71]
    ds_read_b64_tr_b16 v[188:189], v230 offset:10368
    s_lshr_b32 s75, s75, 2
    s_waitcnt lgkmcnt(7)
    v_mfma_f32_16x16x32_bf16 v[72:75], v[168:171], v[152:155], v[72:75]
    ds_read_b64_tr_b16 v[190:191], v230 offset:12928
    v_add_u32 v235, s74, v0
    v_min_u32 v235, s75, v235
    v_mfma_f32_16x16x32_bf16 v[72:75], v[172:175], v[156:159], v[72:75]
    ds_read_b64_tr_b16 v[192:193], v233 offset:128
    v_lshlrev_b32 v235, 7, v235
    s_mov_b32 s74, 98304
    v_mfma_f32_16x16x32_bf16 v[76:79], v[168:171], v[160:163], v[76:79]
    ds_read_b64_tr_b16 v[194:195], v233 offset:2688
    s_mul_i32 s1, s73, 1728
    s_add_u32 m0, s82, 0
    v_mfma_f32_16x16x32_bf16 v[76:79], v[172:175], v[164:167], v[76:79]
    buffer_load_dwordx4 v215, s[12:15], s1 offen offset:0  lds
    s_waitcnt lgkmcnt(6)
    v_mfma_f32_16x16x32_bf16 v[80:83], v[176:179], v[152:155], v[80:83]
    buffer_load_dwordx4 v216, s[12:15], s1 offen offset:1024  lds
    ds_read_b64_tr_b16 v[196:197], v233 offset:10368
    v_mfma_f32_16x16x32_bf16 v[80:83], v[180:183], v[156:159], v[80:83]
    buffer_load_dwordx4 v217, s[12:15], s1 offen offset:2048  lds
    ds_read_b64_tr_b16 v[198:199], v233 offset:12928
    v_mfma_f32_16x16x32_bf16 v[84:87], v[176:179], v[160:163], v[84:87]
    ds_read_b64_tr_b16 v[168:169], v230 offset:192
    v_mfma_f32_16x16x32_bf16 v[84:87], v[180:183], v[164:167], v[84:87]
    ds_read_b64_tr_b16 v[170:171], v230 offset:2752
    s_waitcnt lgkmcnt(6)
    v_mfma_f32_16x16x32_bf16 v[88:91], v[184:187], v[152:155], v[88:91]
    ds_read_b64_tr_b16 v[172:173], v230 offset:10432
    ds_read_b64_tr_b16 v[174:175], v230 offset:12992
    v_mfma_f32_16x16x32_bf16 v[88:91], v[188:191], v[156:159], v[88:91]
    ds_read_b64_tr_b16 v[176:177], v233 offset:192
    v_mfma_f32_16x16x32_bf16 v[92:95], v[184:187], v[160:163], v[92:95]
    buffer_load_dwordx4 v218, s[12:15], s1 offen offset:3072  lds
    ds_read_b64_tr_b16 v[178:179], v233 offset:2752
    v_mfma_f32_16x16x32_bf16 v[92:95], v[188:191], v[164:167], v[92:95]
    ds_read_b64_tr_b16 v[180:181], v233 offset:10432
    s_waitcnt lgkmcnt(7)
    v_mfma_f32_16x16x32_bf16 v[96:99], v[192:195], v[152:155], v[96:99]
    ds_read_b64_tr_b16 v[182:183], v233 offset:12992
    v_mfma_f32_16x16x32_bf16 v[96:99], v[196:199], v[156:159], v[96:99]
    ds_read_b64_tr_b16 v[184:185], v230 offset:256
    s_add_u32 m0, m0, 4096
    v_mfma_f32_16x16x32_bf16 v[100:103], v[192:195], v[160:163], v[100:103]
    ds_read_b64_tr_b16 v[186:187], v230 offset:2816
    v_mfma_f32_16x16x32_bf16 v[100:103], v[196:199], v[164:167], v[100:103]
    buffer_load_dwordx4 v219, s[12:15], s1 offen offset:0  lds
    s_waitcnt lgkmcnt(6)
    v_mfma_f32_16x16x32_bf16 v[104:107], v[168:171], v[152:155], v[104:107]
    ds_read_b64_tr_b16 v[188:189], v230 offset:10496
    ds_read_b64_tr_b16 v[190:191], v230 offset:13056
    v_mfma_f32_16x16x32_bf16 v[104:107], v[172:175], v[156:159], v[104:107]
    ds_read_b64_tr_b16 v[192:193], v233 offset:256
    v_mfma_f32_16x16x32_bf16 v[108:111], v[168:171], v[160:163], v[108:111]
    ds_read_b64_tr_b16 v[194:195], v233 offset:2816
    v_mfma_f32_16x16x32_bf16 v[108:111], v[172:175], v[164:167], v[108:111]
    buffer_load_dwordx2 v[248:249], v235, s[16:19], s74 offen sc1
    s_waitcnt lgkmcnt(6)
    v_mfma_f32_16x16x32_bf16 v[112:115], v[176:179], v[152:155], v[112:115]
    ds_read_b64_tr_b16 v[196:197], v233 offset:10496
    ds_read_b64_tr_b16 v[198:199], v233 offset:13056
    v_mfma_f32_16x16x32_bf16 v[112:115], v[180:183], v[156:159], v[112:115]
    v_mfma_f32_16x16x32_bf16 v[116:119], v[176:179], v[160:163], v[116:119]
    s_waitcnt vmcnt(15) lgkmcnt(0)
    s_barrier
    ds_read_b64_tr_b16 v[168:169], v228 offset:0
    v_mfma_f32_16x16x32_bf16 v[116:119], v[180:183], v[164:167], v[116:119]
    ds_read_b64_tr_b16 v[170:171], v228 offset:1280
    v_mfma_f32_16x16x32_bf16 v[120:123], v[184:187], v[152:155], v[120:123]
    ds_read_b64_tr_b16 v[172:173], v228 offset:5120
    ds_read_b64_tr_b16 v[174:175], v228 offset:6400
    v_mfma_f32_16x16x32_bf16 v[120:123], v[188:191], v[156:159], v[120:123]
    ds_read_b128 v[136:139], v224 offset:0
    ds_read_b128 v[140:143], v225 offset:0
    v_mfma_f32_16x16x32_bf16 v[124:127], v[184:187], v[160:163], v[124:127]
    ds_read_b128 v[144:147], v224 offset:2048
    v_mfma_f32_16x16x32_bf16 v[124:127], v[188:191], v[164:167], v[124:127]
    ds_read_b128 v[148:151], v225 offset:2048
    v_mfma_f32_16x16x32_bf16 v[128:131], v[192:195], v[152:155], v[128:131]
    ds_read_b64_tr_b16 v[176:177], v228 offset:8
    ds_read_b64_tr_b16 v[178:179], v228 offset:1288
    v_mfma_f32_16x16x32_bf16 v[128:131], v[196:199], v[156:159], v[128:131]
    ds_read_b64_tr_b16 v[180:181], v228 offset:5128
    ds_read_b64_tr_b16 v[182:183], v228 offset:6408
    v_mfma_f32_16x16x32_bf16 v[132:135], v[192:195], v[160:163], v[132:135]
    ds_read_b64_tr_b16 v[184:185], v228 offset:16
    v_mfma_f32_16x16x32_bf16 v[132:135], v[196:199], v[164:167], v[132:135]
    ds_read_b64_tr_b16 v[186:187], v228 offset:1296
    s_waitcnt lgkmcnt(9)
    v_mfma_f32_16x16x32_bf16 v[16:19], v[168:171], v[136:139], v[16:19]
    ds_read_b64_tr_b16 v[188:189], v228 offset:5136
    s_waitcnt lgkmcnt(9)
    v_mfma_f32_16x16x32_bf16 v[16:19], v[172:175], v[140:143], v[16:19]
    ds_read_b64_tr_b16 v[190:191], v228 offset:6416
    s_waitcnt lgkmcnt(9)
    v_mfma_f32_16x16x32_bf16 v[20:23], v[168:171], v[144:147], v[20:23]
    ds_read_b64_tr_b16 v[192:193], v228 offset:24
    s_waitcnt lgkmcnt(9)
    v_mfma_f32_16x16x32_bf16 v[20:23], v[172:175], v[148:151], v[20:23]
    ds_read_b64_tr_b16 v[194:195], v228 offset:1304
    s_waitcnt vmcnt(0)
    s_waitcnt lgkmcnt(6)
    v_mfma_f32_16x16x32_bf16 v[24:27], v[176:179], v[136:139], v[24:27]
    ds_read_b64_tr_b16 v[196:197], v228 offset:5144
    ds_read_b64_tr_b16 v[198:199], v228 offset:6424
    v_mfma_f32_16x16x32_bf16 v[24:27], v[180:183], v[140:143], v[24:27]
    ds_read_b64_tr_b16 v[168:169], v228 offset:32
    v_cmp_ne_u64 vcc, s[58:59], v[248:249]
    v_mfma_f32_16x16x32_bf16 v[28:31], v[176:179], v[144:147], v[28:31]
    ds_read_b64_tr_b16 v[170:171], v228 offset:1312
    s_nop 1
    s_cbranch_vccnz L_slow_28
L_back_29:
    v_mfma_f32_16x16x32_bf16 v[28:31], v[180:183], v[148:151], v[28:31]
    ds_read_b64_tr_b16 v[172:173], v228 offset:5152
    s_waitcnt lgkmcnt(7)
    v_mfma_f32_16x16x32_bf16 v[32:35], v[184:187], v[136:139], v[32:35]
    ds_read_b64_tr_b16 v[174:175], v228 offset:6432
    v_mfma_f32_16x16x32_bf16 v[32:35], v[188:191], v[140:143], v[32:35]
    s_add_u32 s100, s97, 0
    buffer_load_dwordx4 a[0:3], v6, s[16:19], s100 offen offset:0 sc1
    v_mfma_f32_16x16x32_bf16 v[36:39], v[184:187], v[144:147], v[36:39]
    ds_read_b64_tr_b16 v[176:177], v231 offset:0
    v_mfma_f32_16x16x32_bf16 v[36:39], v[188:191], v[148:151], v[36:39]
    ds_read_b64_tr_b16 v[178:179], v231 offset:2560
    s_waitcnt lgkmcnt(6)
    v_mfma_f32_16x16x32_bf16 v[40:43], v[192:195], v[136:139], v[40:43]
    ds_read_b64_tr_b16 v[180:181], v231 offset:10240
    ds_read_b64_tr_b16 v[182:183], v231 offset:12800
    v_mfma_f32_16x16x32_bf16 v[40:43], v[196:199], v[140:143], v[40:43]
    buffer_load_dwordx4 a[4:7], v6, s[16:19], s100 offen offset:1024 sc1
    v_mfma_f32_16x16x32_bf16 v[44:47], v[192:195], v[144:147], v[44:47]
    ds_read_b64_tr_b16 v[184:185], v234 offset:0
    v_mfma_f32_16x16x32_bf16 v[44:47], v[196:199], v[148:151], v[44:47]
    ds_read_b64_tr_b16 v[186:187], v234 offset:2560
    s_waitcnt lgkmcnt(6)
    v_mfma_f32_16x16x32_bf16 v[48:51], v[168:171], v[136:139], v[48:51]
    ds_read_b64_tr_b16 v[188:189], v234 offset:10240
    ds_read_b64_tr_b16 v[190:191], v234 offset:12800
    v_mfma_f32_16x16x32_bf16 v[48:51], v[172:175], v[140:143], v[48:51]
    buffer_load_dwordx4 a[8:11], v6, s[16:19], s100 offen offset:2048 sc1
    v_mfma_f32_16x16x32_bf16 v[52:55], v[168:171], v[144:147], v[52:55]
    ds_read_b64_tr_b16 v[192:193], v231 offset:64
    v_mfma_f32_16x16x32_bf16 v[52:55], v[172:175], v[148:151], v[52:55]
    ds_read_b64_tr_b16 v[194:195], v231 offset:2624
    s_waitcnt lgkmcnt(6)
    v_mfma_f32_16x16x32_bf16 v[56:59], v[176:179], v[136:139], v[56:59]
    ds_read_b64_tr_b16 v[196:197], v231 offset:10304
    ds_read_b64_tr_b16 v[198:199], v231 offset:12864
    v_mfma_f32_16x16x32_bf16 v[56:59], v[180:183], v[140:143], v[56:59]
    buffer_load_dwordx4 a[12:15], v6, s[16:19], s100 offen offset:3072 sc1
    v_mfma_f32_16x16x32_bf16 v[60:63], v[176:179], v[144:147], v[60:63]
    ds_read_b64_tr_b16 v[168:169], v234 offset:64
    v_mfma_f32_16x16x32_bf16 v[60:63], v[180:183], v[148:151], v[60:63]
    ds_read_b64_tr_b16 v[170:171], v234 offset:2624
    s_waitcnt lgkmcnt(6)
    v_mfma_f32_16x16x32_bf16 v[64:67], v[184:187], v[136:139], v[64:67]
    ds_read_b64_tr_b16 v[172:173], v234 offset:10304
    ds_read_b64_tr_b16 v[174:175], v234 offset:12864
    v_mfma_f32_16x16x32_bf16 v[64:67], v[188:191], v[140:143], v[64:67]
    buffer_load_dwordx4 a[16:19], v240, s[16:19], s100 offen offset:0 sc1
    v_mfma_f32_16x16x32_bf16 v[68:71], v[184:187], v[144:147], v[68:71]
    ds_read_b64_tr_b16 v[176:177], v231 offset:128
    v_mfma_f32_16x16x32_bf16 v[68:71], v[188:191], v[148:151], v[68:71]
    ds_read_b64_tr_b16 v[178:179], v231 offset:2688
    s_waitcnt lgkmcnt(6)
    v_mfma_f32_16x16x32_bf16 v[72:75], v[192:195], v[136:139], v[72:75]
    ds_read_b64_tr_b16 v[180:181], v231 offset:10368
    ds_read_b64_tr_b16 v[182:183], v231 offset:12928
    v_mfma_f32_16x16x32_bf16 v[72:75], v[196:199], v[140:143], v[72:75]
    s_add_u32 s100, s97, 20480
    buffer_load_dwordx4 a[20:23], v6, s[16:19], s100 offen offset:0 sc1
    v_mfma_f32_16x16x32_bf16 v[76:79], v[192:195], v[144:147], v[76:79]
    ds_read_b64_tr_b16 v[184:185], v234 offset:128
    v_mfma_f32_16x16x32_bf16 v[76:79], v[196:199], v[148:151], v[76:79]
    ds_read_b64_tr_b16 v[186:187], v234 offset:2688
    s_waitcnt lgkmcnt(6)
    v_mfma_f32_16x16x32_bf16 v[80:83], v[168:171], v[136:139], v[80:83]
    ds_read_b64_tr_b16 v[188:189], v234 offset:10368
    ds_read_b64_tr_b16 v[190:191], v234 offset:12928
    v_mfma_f32_16x16x32_bf16 v[80:83], v[172:175], v[140:143], v[80:83]
    buffer_load_dwordx4 a[24:27], v6, s[16:19], s100 offen offset:1024 sc1
    v_mfma_f32_16x16x32_bf16 v[84:87], v[168:171], v[144:147], v[84:87]
    ds_read_b64_tr_b16 v[192:193], v231 offset:192
    v_mfma_f32_16x16x32_bf16 v[84:87], v[172:175], v[148:151], v[84:87]
    ds_read_b64_tr_b16 v[194:195], v231 offset:2752
    s_waitcnt lgkmcnt(6)
    v_mfma_f32_16x16x32_bf16 v[88:91], v[176:179], v[136:139], v[88:91]
    ds_read_b64_tr_b16 v[196:197], v231 offset:10432
    ds_read_b64_tr_b16 v[198:199], v231 offset:12992
    v_mfma_f32_16x16x32_bf16 v[88:91], v[180:183], v[140:143], v[88:91]
    buffer_load_dwordx4 a[28:31], v6, s[16:19], s100 offen offset:2048 sc1
    v_mfma_f32_16x16x32_bf16 v[92:95], v[176:179], v[144:147], v[92:95]
    ds_read_b64_tr_b16 v[168:169], v234 offset:192
    v_mfma_f32_16x16x32_bf16 v[92:95], v[180:183], v[148:151], v[92:95]
    ds_read_b64_tr_b16 v[170:171], v234 offset:2752
    s_waitcnt lgkmcnt(6)
    v_mfma_f32_16x16x32_bf16 v[96:99], v[184:187], v[136:139], v[96:99]
    ds_read_b64_tr_b16 v[172:173], v234 offset:10432
    ds_read_b64_tr_b16 v[174:175], v234 offset:12992
    v_mfma_f32_16x16x32_bf16 v[96:99], v[188:191], v[140:143], v[96:99]
    buffer_load_dwordx4 a[32:35], v6, s[16:19], s100 offen offset:3072 sc1
    v_mfma_f32_16x16x32_bf16 v[100:103], v[184:187], v[144:147], v[100:103]
    ds_read_b64_tr_b16 v[176:177], v231 offset:256
    v_mfma_f32_16x16x32_bf16 v[100:103], v[188:191], v[148:151], v[100:103]
    ds_read_b64_tr_b16 v[178:179], v231 offset:2816
    s_waitcnt lgkmcnt(6)
    v_mfma_f32_16x16x32_bf16 v[104:107], v[192:195], v[136:139], v[104:107]
    ds_read_b64_tr_b16 v[180:181], v231 offset:10496
    ds_read_b64_tr_b16 v[182:183], v231 offset:13056
    v_mfma_f32_16x16x32_bf16 v[104:107], v[196:199], v[140:143], v[104:107]
    buffer_load_dwordx4 a[36:39], v240, s[16:19], s100 offen offset:0 sc1
    v_mfma_f32_16x16x32_bf16 v[108:111], v[192:195], v[144:147], v[108:111]
    ds_read_b64_tr_b16 v[184:185], v234 offset:256
    v_mfma_f32_16x16x32_bf16 v[108:111], v[196:199], v[148:151], v[108:111]
    ds_read_b64_tr_b16 v[186:187], v234 offset:2816
    s_waitcnt lgkmcnt(6)
    v_mfma_f32_16x16x32_bf16 v[112:115], v[168:171], v[136:139], v[112:115]
    ds_read_b64_tr_b16 v[188:189], v234 offset:10496
    ds_read_b64_tr_b16 v[190:191], v234 offset:13056
    v_mfma_f32_16x16x32_bf16 v[112:115], v[172:175], v[140:143], v[112:115]
    s_add_u32 s100, s97, 40960
    buffer_load_dwordx4 a[40:43], v6, s[16:19], s100 offen offset:0 sc1
    v_mfma_f32_16x16x32_bf16 v[116:119], v[168:171], v[144:147], v[116:119]
    s_waitcnt lgkmcnt(0)
    s_barrier
    ds_read_b64_tr_b16 v[192:193], v226 offset:0
    v_mfma_f32_16x16x32_bf16 v[116:119], v[172:175], v[148:151], v[116:119]
    ds_read_b64_tr_b16 v[194:195], v226 offset:1280
    v_mfma_f32_16x16x32_bf16 v[120:123], v[176:179], v[136:139], v[120:123]
    ds_read_b64_tr_b16 v[196:197], v226 offset:5120
    ds_read_b64_tr_b16 v[198:199], v226 offset:6400
    v_mfma_f32_16x16x32_bf16 v[120:123], v[180:183], v[140:143], v[120:123]
    buffer_load_dwordx4 a[44:47], v6, s[16:19], s100 offen offset:1024 sc1
    ds_read_b128 v[152:155], v220 offset:0
    v_mfma_f32_16x16x32_bf16 v[124:127], v[176:179], v[144:147], v[124:127]
    ds_read_b128 v[156:159], v221 offset:0
    ds_read_b128 v[160:163], v220 offset:2048
    v_mfma_f32_16x16x32_bf16 v[124:127], v[180:183], v[148:151], v[124:127]
    ds_read_b128 v[164:167], v221 offset:2048
    v_mfma_f32_16x16x32_bf16 v[128:131], v[184:187], v[136:139], v[128:131]
    ds_read_b64_tr_b16 v[168:169], v226 offset:8
    ds_read_b64_tr_b16 v[170:171], v226 offset:1288
    v_mfma_f32_16x16x32_bf16 v[128:131], v[188:191], v[140:143], v[128:131]
    buffer_load_dwordx4 a[48:51], v6, s[16:19], s100 offen offset:2048 sc1
    ds_read_b64_tr_b16 v[172:173], v226 offset:5128
    v_mfma_f32_16x16x32_bf16 v[132:135], v[184:187], v[144:147], v[132:135]
    ds_read_b64_tr_b16 v[174:175], v226 offset:6408
    v_mfma_f32_16x16x32_bf16 v[132:135], v[188:191], v[148:151], v[132:135]
    ds_read_b64_tr_b16 v[176:177], v226 offset:16
    s_waitcnt lgkmcnt(8)
    v_mfma_f32_16x16x32_bf16 v[16:19], v[192:195], v[152:155], v[16:19]
    ds_read_b64_tr_b16 v[178:179], v226 offset:1296
    s_waitcnt lgkmcnt(8)
    v_mfma_f32_16x16x32_bf16 v[16:19], v[196:199], v[156:159], v[16:19]
    buffer_load_dwordx4 a[52:55], v6, s[16:19], s100 offen offset:3072 sc1
    s_waitcnt lgkmcnt(7)
    v_mfma_f32_16x16x32_bf16 v[20:23], v[192:195], v[160:163], v[20:23]
    ds_read_b64_tr_b16 v[180:181], v226 offset:5136
    s_waitcnt lgkmcnt(7)
    v_mfma_f32_16x16x32_bf16 v[20:23], v[196:199], v[164:167], v[20:23]
    ds_read_b64_tr_b16 v[182:183], v226 offset:6416
    s_waitcnt lgkmcnt(4)
    v_mfma_f32_16x16x32_bf16 v[24:27], v[168:171], v[152:155], v[24:27]
    ds_read_b64_tr_b16 v[184:185], v226 offset:24
    ds_read_b64_tr_b16 v[186:187], v226 offset:1304
    v_mfma_f32_16x16x32_bf16 v[24:27], v[172:175], v[156:159], v[24:27]
    buffer_load_dwordx4 a[56:59], v240, s[16:19], s100 offen offset:0 sc1
    ds_read_b64_tr_b16 v[188:189], v226 offset:5144
    v_mfma_f32_16x16x32_bf16 v[28:31], v[168:171], v[160:163], v[28:31]
    ds_read_b64_tr_b16 v[190:191], v226 offset:6424
    v_mfma_f32_16x16x32_bf16 v[28:31], v[172:175], v[164:167], v[28:31]
    ds_read_b64_tr_b16 v[192:193], v226 offset:32
    s_waitcnt lgkmcnt(5)
    v_mfma_f32_16x16x32_bf16 v[32:35], v[176:179], v[152:155], v[32:35]
    ds_read_b64_tr_b16 v[194:195], v226 offset:1312
    ds_read_b64_tr_b16 v[196:197], v226 offset:5152
    v_mfma_f32_16x16x32_bf16 v[32:35], v[180:183], v[156:159], v[32:35]
    s_add_u32 s100, s97, 61440
    buffer_load_dwordx4 a[60:63], v6, s[16:19], s100 offen offset:0 sc1
    ds_read_b64_tr_b16 v[198:199], v226 offset:6432
    v_mfma_f32_16x16x32_bf16 v[36:39], v[176:179], v[160:163], v[36:39]
    ds_read_b64_tr_b16 v[168:169], v229 offset:0
    v_mfma_f32_16x16x32_bf16 v[36:39], v[180:183], v[164:167], v[36:39]
    ds_read_b64_tr_b16 v[170:171], v229 offset:2560
    s_waitcnt lgkmcnt(6)
    v_mfma_f32_16x16x32_bf16 v[40:43], v[184:187], v[152:155], v[40:43]
    ds_read_b64_tr_b16 v[172:173], v229 offset:10240
    ds_read_b64_tr_b16 v[174:175], v229 offset:12800
    v_mfma_f32_16x16x32_bf16 v[40:43], v[188:191], v[156:159], v[40:43]
    buffer_load_dwordx4 a[64:67], v6, s[16:19], s100 offen offset:1024 sc1
    v_mfma_f32_16x16x32_bf16 v[44:47], v[184:187], v[160:163], v[44:47]
    ds_read_b64_tr_b16 v[176:177], v232 offset:0
    v_mfma_f32_16x16x32_bf16 v[44:47], v[188:191], v[164:167], v[44:47]
    ds_read_b64_tr_b16 v[178:179], v232 offset:2560
    s_waitcnt lgkmcnt(6)
    v_mfma_f32_16x16x32_bf16 v[48:51], v[192:195], v[152:155], v[48:51]
    ds_read_b64_tr_b16 v[180:181], v232 offset:10240
    ds_read_b64_tr_b16 v[182:183], v232 offset:12800
    v_mfma_f32_16x16x32_bf16 v[48:51], v[196:199], v[156:159], v[48:51]
    buffer_load_dwordx4 a[68:71], v6, s[16:19], s100 offen offset:2048 sc1
    v_mfma_f32_16x16x32_bf16 v[52:55], v[192:195], v[160:163], v[52:55]
    ds_read_b64_tr_b16 v[184:185], v229 offset:64
    v_mfma_f32_16x16x32_bf16 v[52:55], v[196:199], v[164:167], v[52:55]
    ds_read_b64_tr_b16 v[186:187], v229 offset:2624
    s_waitcnt lgkmcnt(6)
    v_mfma_f32_16x16x32_bf16 v[56:59], v[168:171], v[152:155], v[56:59]
    ds_read_b64_tr_b16 v[188:189], v229 offset:10304
    ds_read_b64_tr_b16 v[190:191], v229 offset:12864
    v_mfma_f32_16x16x32_bf16 v[56:59], v[172:175], v[156:159], v[56:59]
    buffer_load_dwordx4 a[72:75], v6, s[16:19], s100 offen offset:3072 sc1
    v_mfma_f32_16x16x32_bf16 v[60:63], v[168:171], v[160:163], v[60:63]
    ds_read_b64_tr_b16 v[192:193], v232 offset:64
    v_mfma_f32_16x16x32_bf16 v[60:63], v[172:175], v[164:167], v[60:63]
    ds_read_b64_tr_b16 v[194:195], v232 offset:2624
    s_waitcnt lgkmcnt(6)
    v_mfma_f32_16x16x32_bf16 v[64:67], v[176:179], v[152:155], v[64:67]
    ds_read_b64_tr_b16 v[196:197], v232 offset:10304
    ds_read_b64_tr_b16 v[198:199], v232 offset:12864
    v_mfma_f32_16x16x32_bf16 v[64:67], v[180:183], v[156:159], v[64:67]
    buffer_load_dwordx4 a[76:79], v240, s[16:19], s100 offen offset:0 sc1
    v_mfma_f32_16x16x32_bf16 v[68:71], v[176:179], v[160:163], v[68:71]
    ds_read_b64_tr_b16 v[168:169], v229 offset:128
    v_mfma_f32_16x16x32_bf16 v[68:71], v[180:183], v[164:167], v[68:71]
    ds_read_b64_tr_b16 v[170:171], v229 offset:2688
    s_waitcnt lgkmcnt(6)
    v_mfma_f32_16x16x32_bf16 v[72:75], v[184:187], v[152:155], v[72:75]
    ds_read_b64_tr_b16 v[172:173], v229 offset:10368
    ds_read_b64_tr_b16 v[174:175], v229 offset:12928
    v_mfma_f32_16x16x32_bf16 v[72:75], v[188:191], v[156:159], v[72:75]
    s_add_u32 s100, s97, 81920
    buffer_load_dwordx4 a[80:83], v6, s[16:19], s100 offen offset:0 sc1
    v_mfma_f32_16x16x32_bf16 v[76:79], v[184:187], v[160:163], v[76:79]
    ds_read_b64_tr_b16 v[176:177], v232 offset:128
    v_mfma_f32_16x16x32_bf16 v[76:79], v[188:191], v[164:167], v[76:79]
    ds_read_b64_tr_b16 v[178:179], v232 offset:2688
    s_waitcnt lgkmcnt(6)
    v_mfma_f32_16x16x32_bf16 v[80:83], v[192:195], v[152:155], v[80:83]
    ds_read_b64_tr_b16 v[180:181], v232 offset:10368
    ds_read_b64_tr_b16 v[182:183], v232 offset:12928
    v_mfma_f32_16x16x32_bf16 v[80:83], v[196:199], v[156:159], v[80:83]
    buffer_load_dwordx4 a[84:87], v6, s[16:19], s100 offen offset:1024 sc1
    v_mfma_f32_16x16x32_bf16 v[84:87], v[192:195], v[160:163], v[84:87]
    ds_read_b64_tr_b16 v[184:185], v229 offset:192
    v_mfma_f32_16x16x32_bf16 v[84:87], v[196:199], v[164:167], v[84:87]
    ds_read_b64_tr_b16 v[186:187], v229 offset:2752
    s_waitcnt lgkmcnt(6)
    v_mfma_f32_16x16x32_bf16 v[88:91], v[168:171], v[152:155], v[88:91]
    ds_read_b64_tr_b16 v[188:189], v229 offset:10432
    ds_read_b64_tr_b16 v[190:191], v229 offset:12992
    v_mfma_f32_16x16x32_bf16 v[88:91], v[172:175], v[156:159], v[88:91]
    buffer_load_dwordx4 a[88:91], v6, s[16:19], s100 offen offset:2048 sc1
    v_mfma_f32_16x16x32_bf16 v[92:95], v[168:171], v[160:163], v[92:95]
    ds_read_b64_tr_b16 v[192:193], v232 offset:192
    v_mfma_f32_16x16x32_bf16 v[92:95], v[172:175], v[164:167], v[92:95]
    ds_read_b64_tr_b16 v[194:195], v232 offset:2752
    s_waitcnt lgkmcnt(6)
    v_mfma_f32_16x16x32_bf16 v[96:99], v[176:179], v[152:155], v[96:99]
    ds_read_b64_tr_b16 v[196:197], v232 offset:10432
    ds_read_b64_tr_b16 v[198:199], v232 offset:12992
    v_mfma_f32_16x16x32_bf16 v[96:99], v[180:183], v[156:159], v[96:99]
    buffer_load_dwordx4 a[92:95], v6, s[16:19], s100 offen offset:3072 sc1
    v_mfma_f32_16x16x32_bf16 v[100:103], v[176:179], v[160:163], v[100:103]
    ds_read_b64_tr_b16 v[168:169], v229 offset:256
    v_mfma_f32_16x16x32_bf16 v[100:103], v[180:183], v[164:167], v[100:103]
    ds_read_b64_tr_b16 v[170:171], v229 offset:2816
    s_waitcnt lgkmcnt(6)
    v_mfma_f32_16x16x32_bf16 v[104:107], v[184:187], v[152:155], v[104:107]
    ds_read_b64_tr_b16 v[172:173], v229 offset:10496
    ds_read_b64_tr_b16 v[174:175], v229 offset:13056
    v_mfma_f32_16x16x32_bf16 v[104:107], v[188:191], v[156:159], v[104:107]
    buffer_load_dwordx4 a[96:99], v240, s[16:19], s100 offen offset:0 sc1
    v_mfma_f32_16x16x32_bf16 v[108:111], v[184:187], v[160:163], v[108:111]
    ds_read_b64_tr_b16 v[176:177], v232 offset:256
    v_mfma_f32_16x16x32_bf16 v[108:111], v[188:191], v[164:167], v[108:111]
    ds_read_b64_tr_b16 v[178:179], v232 offset:2816
    s_waitcnt lgkmcnt(6)
    v_mfma_f32_16x16x32_bf16 v[112:115], v[192:195], v[152:155], v[112:115]
    ds_read_b64_tr_b16 v[180:181], v232 offset:10496
    ds_read_b64_tr_b16 v[182:183], v232 offset:13056
    v_mfma_f32_16x16x32_bf16 v[112:115], v[196:199], v[156:159], v[112:115]
    s_add_u32 s100, s97, 102400
    buffer_load_dwordx4 a[100:103], v6, s[16:19], s100 offen offset:0 sc1
    v_mfma_f32_16x16x32_bf16 v[116:119], v[192:195], v[160:163], v[116:119]
    v_mfma_f32_16x16x32_bf16 v[116:119], v[196:199], v[164:167], v[116:119]
    s_waitcnt lgkmcnt(4)
    v_mfma_f32_16x16x32_bf16 v[120:123], v[168:171], v[152:155], v[120:123]
    v_mfma_f32_16x16x32_bf16 v[120:123], v[172:175], v[156:159], v[120:123]
    buffer_load_dwordx4 a[104:107], v6, s[16:19], s100 offen offset:1024 sc1
    v_mfma_f32_16x16x32_bf16 v[124:127], v[168:171], v[160:163], v[124:127]
    v_mfma_f32_16x16x32_bf16 v[124:127], v[172:175], v[164:167], v[124:127]
    s_waitcnt lgkmcnt(0)
    v_mfma_f32_16x16x32_bf16 v[128:131], v[176:179], v[152:155], v[128:131]
    v_mfma_f32_16x16x32_bf16 v[128:131], v[180:183], v[156:159], v[128:131]
    buffer_load_dwordx4 a[108:111], v6, s[16:19], s100 offen offset:2048 sc1
    v_mfma_f32_16x16x32_bf16 v[132:135], v[176:179], v[160:163], v[132:135]
    v_mfma_f32_16x16x32_bf16 v[132:135], v[180:183], v[164:167], v[132:135]
    s_mov_b32 s24, s48
    s_and_b32 s25, s49, 0xffff
    s_mov_b32 s26, 1280
    s_mov_b32 s27, 0x20000
    s_mov_b32 s20, s52
    s_and_b32 s21, s53, 0xffff
    s_mov_b32 s22, 2621440
    s_mov_b32 s23, 0x20000
    s_mul_i32 s80, s63, 160
    s_and_b32 s81, s63, 1
    s_lshl_b32 s82, s81, 5
    s_add_u32 s82, s82, s80
    s_xor_b32 s81, s81, 1
    s_lshl_b32 s81, s81, 7
    s_add_u32 s81, s81, s80
    s_min_u32 s83, s3, 1
    s_mul_i32 s83, s83, 1280
    s_sub_u32 s26, 1280, s83
    s_lshr_b32 s85, s62, 1
    s_lshl_b32 s83, s85, 11
    s_add_u32 s83, s83, 40960
    s_add_u32 s84, s83, 1024
    v_and_b32 v235, 7, v0
    v_lshlrev_b32 v235, 7, v235
    s_mov_b32 s98, 0xc0135761
    v_mov_b32 v14, 0xbdd2d3e8
    s_lshl_b32 s77, s89, 6
    s_add_u32 s77, s77, s76
    v_pk_mul_f32 v[136:137], v[56:57], v[56:57]
    buffer_load_dwordx4 a[112:115], v6, s[16:19], s100 offen offset:3072 sc1
    v_pk_mul_f32 v[138:139], v[58:59], v[58:59]
    v_pk_mul_f32 v[140:141], v[64:65], v[64:65]
    v_pk_mul_f32 v[142:143], v[66:67], v[66:67]
    v_pk_fma_f32 v[136:137], v[136:137], v[14:15], s[98:99] op_sel_hi:[1,0,0]
    v_pk_fma_f32 v[138:139], v[138:139], v[14:15], s[98:99] op_sel_hi:[1,0,0]
    v_pk_fma_f32 v[140:141], v[140:141], v[14:15], s[98:99] op_sel_hi:[1,0,0]
    v_pk_fma_f32 v[142:143], v[142:143], v[14:15], s[98:99] op_sel_hi:[1,0,0]
    v_pk_mul_f32 v[136:137], v[136:137], v[56:57]
    v_pk_mul_f32 v[138:139], v[138:139], v[58:59]
    v_pk_mul_f32 v[140:141], v[140:141], v[64:65]
    v_pk_mul_f32 v[142:143], v[142:143], v[66:67]
    v_exp_f32 v136, v136
    v_exp_f32 v137, v137
    v_exp_f32 v138, v138
    v_exp_f32 v139, v139
    v_exp_f32 v140, v140
    v_exp_f32 v141, v141
    v_exp_f32 v142, v142
    buffer_load_dwordx4 a[116:119], v240, s[16:19], s100 offen offset:0 sc1
    v_exp_f32 v143, v143
    v_pk_add_f32 v[136:137], v[136:137], 1.0 op_sel_hi:[1,0]
    v_pk_add_f32 v[138:139], v[138:139], 1.0 op_sel_hi:[1,0]
    v_pk_add_f32 v[140:141], v[140:141], 1.0 op_sel_hi:[1,0]
    v_pk_add_f32 v[142:143], v[142:143], 1.0 op_sel_hi:[1,0]
    v_rcp_f32 v136, v136
    v_rcp_f32 v137, v137
    v_rcp_f32 v138, v138
    v_rcp_f32 v139, v139
    v_rcp_f32 v140, v140
    v_rcp_f32 v141, v141
    v_rcp_f32 v142, v142
    v_rcp_f32 v143, v143
    v_pk_mul_f32 v[136:137], v[136:137], v[56:57]
    v_pk_mul_f32 v[138:139], v[138:139], v[58:59]
    v_pk_mul_f32 v[140:141], v[140:141], v[64:65]
    s_add_u32 s100, s97, 122880
    buffer_load_dwordx4 a[120:123], v6, s[16:19], s100 offen offset:0 sc1
    v_pk_mul_f32 v[142:143], v[142:143], v[66:67]
    v_cvt_pk_bf16_f32 v152, v136, v137
    v_cvt_pk_bf16_f32 v153, v138, v139
    v_cvt_pk_bf16_f32 v154, v140, v141
    v_cvt_pk_bf16_f32 v155, v142, v143
    s_add_u32 s78, s77, 0
    buffer_store_dwordx4 v[152:155], v6, s[16:19], s78 offen offset:0 sc1
    v_pk_mul_f32 v[144:145], v[60:61], v[60:61]
    v_pk_mul_f32 v[146:147], v[62:63], v[62:63]
    v_pk_mul_f32 v[148:149], v[68:69], v[68:69]
    v_pk_mul_f32 v[150:151], v[70:71], v[70:71]
    v_pk_fma_f32 v[144:145], v[144:145], v[14:15], s[98:99] op_sel_hi:[1,0,0]
    v_pk_fma_f32 v[146:147], v[146:147], v[14:15], s[98:99] op_sel_hi:[1,0,0]
    v_pk_fma_f32 v[148:149], v[148:149], v[14:15], s[98:99] op_sel_hi:[1,0,0]
    v_pk_fma_f32 v[150:151], v[150:151], v[14:15], s[98:99] op_sel_hi:[1,0,0]
    v_pk_mul_f32 v[144:145], v[144:145], v[60:61]
    v_pk_mul_f32 v[146:147], v[146:147], v[62:63]
    v_pk_mul_f32 v[148:149], v[148:149], v[68:69]
    v_pk_mul_f32 v[150:151], v[150:151], v[70:71]
    v_exp_f32 v144, v144
    v_exp_f32 v145, v145
    v_exp_f32 v146, v146
    v_exp_f32 v147, v147
    v_exp_f32 v148, v148
    v_exp_f32 v149, v149
    v_exp_f32 v150, v150
    v_exp_f32 v151, v151
    v_pk_add_f32 v[144:145], v[144:145], 1.0 op_sel_hi:[1,0]
    v_pk_add_f32 v[146:147], v[146:147], 1.0 op_sel_hi:[1,0]
    v_pk_add_f32 v[148:149], v[148:149], 1.0 op_sel_hi:[1,0]
    v_pk_add_f32 v[150:151], v[150:151], 1.0 op_sel_hi:[1,0]
    v_rcp_f32 v144, v144
    buffer_load_dwordx4 a[124:127], v6, s[16:19], s100 offen offset:1024 sc1
    v_rcp_f32 v145, v145
    v_rcp_f32 v146, v146
    v_rcp_f32 v147, v147
    v_rcp_f32 v148, v148
    v_rcp_f32 v149, v149
    v_rcp_f32 v150, v150
    v_rcp_f32 v151, v151
    v_pk_mul_f32 v[144:145], v[144:145], v[60:61]
    v_pk_mul_f32 v[146:147], v[146:147], v[62:63]
    v_pk_mul_f32 v[148:149], v[148:149], v[68:69]
    v_pk_mul_f32 v[150:151], v[150:151], v[70:71]
    v_cvt_pk_bf16_f32 v156, v144, v145
    v_cvt_pk_bf16_f32 v157, v146, v147
    v_cvt_pk_bf16_f32 v158, v148, v149
    v_cvt_pk_bf16_f32 v159, v150, v151
    buffer_store_dwordx4 v[156:159], v6, s[16:19], s78 offen offset:1024 sc1
    v_pk_mul_f32 v[136:137], v[72:73], v[72:73]
    v_pk_mul_f32 v[138:139], v[74:75], v[74:75]
    v_pk_mul_f32 v[140:141], v[80:81], v[80:81]
    v_pk_mul_f32 v[142:143], v[82:83], v[82:83]
    v_pk_fma_f32 v[136:137], v[136:137], v[14:15], s[98:99] op_sel_hi:[1,0,0]
    v_pk_fma_f32 v[138:139], v[138:139], v[14:15], s[98:99] op_sel_hi:[1,0,0]
    v_pk_fma_f32 v[140:141], v[140:141], v[14:15], s[98:99] op_sel_hi:[1,0,0]
    v_pk_fma_f32 v[142:143], v[142:143], v[14:15], s[98:99] op_sel_hi:[1,0,0]
    v_pk_mul_f32 v[136:137], v[136:137], v[72:73]
    v_pk_mul_f32 v[138:139], v[138:139], v[74:75]
    v_pk_mul_f32 v[140:141], v[140:141], v[80:81]
    v_pk_mul_f32 v[142:143], v[142:143], v[82:83]
    v_exp_f32 v136, v136
    v_exp_f32 v137, v137
    v_exp_f32 v138, v138
    v_exp_f32 v139, v139
    v_exp_f32 v140, v140
    v_exp_f32 v141, v141
    v_exp_f32 v142, v142
    buffer_load_dwordx4 a[128:131], v6, s[16:19], s100 offen offset:2048 sc1
    v_exp_f32 v143, v143
    v_pk_add_f32 v[136:137], v[136:137], 1.0 op_sel_hi:[1,0]
    v_pk_add_f32 v[138:139], v[138:139], 1.0 op_sel_hi:[1,0]
    v_pk_add_f32 v[140:141], v[140:141], 1.0 op_sel_hi:[1,0]
    v_pk_add_f32 v[142:143], v[142:143], 1.0 op_sel_hi:[1,0]
    v_rcp_f32 v136, v136
    v_rcp_f32 v137, v137
    v_rcp_f32 v138, v138
    v_rcp_f32 v139, v139
    v_rcp_f32 v140, v140
    v_rcp_f32 v141, v141
    v_rcp_f32 v142, v142
    v_rcp_f32 v143, v143
    v_pk_mul_f32 v[136:137], v[136:137], v[72:73]
    v_pk_mul_f32 v[138:139], v[138:139], v[74:75]
    v_pk_mul_f32 v[140:141], v[140:141], v[80:81]
    buffer_load_dwordx4 a[132:135], v6, s[16:19], s100 offen offset:3072 sc1
    v_pk_mul_f32 v[142:143], v[142:143], v[82:83]
    v_cvt_pk_bf16_f32 v160, v136, v137
    v_cvt_pk_bf16_f32 v161, v138, v139
    v_cvt_pk_bf16_f32 v162, v140, v141
    v_cvt_pk_bf16_f32 v163, v142, v143
    s_add_u32 s78, s77, 4096
    buffer_store_dwordx4 v[160:163], v6, s[16:19], s78 offen offset:0 sc1
    v_pk_mul_f32 v[144:145], v[76:77], v[76:77]
    v_pk_mul_f32 v[146:147], v[78:79], v[78:79]
    v_pk_mul_f32 v[148:149], v[84:85], v[84:85]
    v_pk_mul_f32 v[150:151], v[86:87], v[86:87]
    v_pk_fma_f32 v[144:145], v[144:145], v[14:15], s[98:99] op_sel_hi:[1,0,0]
    v_pk_fma_f32 v[146:147], v[146:147], v[14:15], s[98:99] op_sel_hi:[1,0,0]
    v_pk_fma_f32 v[148:149], v[148:149], v[14:15], s[98:99] op_sel_hi:[1,0,0]
    v_pk_fma_f32 v[150:151], v[150:151], v[14:15], s[98:99] op_sel_hi:[1,0,0]
    v_pk_mul_f32 v[144:145], v[144:145], v[76:77]
    v_pk_mul_f32 v[146:147], v[146:147], v[78:79]
    v_pk_mul_f32 v[148:149], v[148:149], v[84:85]
    v_pk_mul_f32 v[150:151], v[150:151], v[86:87]
    v_exp_f32 v144, v144
    v_exp_f32 v145, v145
    v_exp_f32 v146, v146
    v_exp_f32 v147, v147
    v_exp_f32 v148, v148
    v_exp_f32 v149, v149
    v_exp_f32 v150, v150
    v_exp_f32 v151, v151
    v_pk_add_f32 v[144:145], v[144:145], 1.0 op_sel_hi:[1,0]
    v_pk_add_f32 v[146:147], v[146:147], 1.0 op_sel_hi:[1,0]
    v_pk_add_f32 v[148:149], v[148:149], 1.0 op_sel_hi:[1,0]
    v_pk_add_f32 v[150:151], v[150:151], 1.0 op_sel_hi:[1,0]
    v_rcp_f32 v144, v144
    buffer_load_dwordx4 a[136:139], v240, s[16:19], s100 offen offset:0 sc1
    v_rcp_f32 v145, v145
    v_rcp_f32 v146, v146
    v_rcp_f32 v147, v147
    v_rcp_f32 v148, v148
    v_rcp_f32 v149, v149
    v_rcp_f32 v150, v150
    v_rcp_f32 v151, v151
    v_pk_mul_f32 v[144:145], v[144:145], v[76:77]
    v_pk_mul_f32 v[146:147], v[146:147], v[78:79]
    v_pk_mul_f32 v[148:149], v[148:149], v[84:85]
    v_pk_mul_f32 v[150:151], v[150:151], v[86:87]
    v_cvt_pk_bf16_f32 v164, v144, v145
    v_cvt_pk_bf16_f32 v165, v146, v147
    v_cvt_pk_bf16_f32 v166, v148, v149
    v_cvt_pk_bf16_f32 v167, v150, v151
    buffer_store_dwordx4 v[164:167], v6, s[16:19], s78 offen offset:1024 sc1
    v_pk_mul_f32 v[136:137], v[88:89], v[88:89]
    v_pk_mul_f32 v[138:139], v[90:91], v[90:91]
    v_pk_mul_f32 v[140:141], v[96:97], v[96:97]
    v_pk_mul_f32 v[142:143], v[98:99], v[98:99]
    v_pk_fma_f32 v[136:137], v[136:137], v[14:15], s[98:99] op_sel_hi:[1,0,0]
    v_pk_fma_f32 v[138:139], v[138:139], v[14:15], s[98:99] op_sel_hi:[1,0,0]
    v_pk_fma_f32 v[140:141], v[140:141], v[14:15], s[98:99] op_sel_hi:[1,0,0]
    v_pk_fma_f32 v[142:143], v[142:143], v[14:15], s[98:99] op_sel_hi:[1,0,0]
    v_pk_mul_f32 v[136:137], v[136:137], v[88:89]
    v_pk_mul_f32 v[138:139], v[138:139], v[90:91]
    v_pk_mul_f32 v[140:141], v[140:141], v[96:97]
    v_pk_mul_f32 v[142:143], v[142:143], v[98:99]
    v_exp_f32 v136, v136
    v_exp_f32 v137, v137
    v_exp_f32 v138, v138
    v_exp_f32 v139, v139
    v_exp_f32 v140, v140
    v_exp_f32 v141, v141
    v_exp_f32 v142, v142
    s_add_u32 s100, s97, 143360
    buffer_load_dwordx4 a[140:143], v6, s[16:19], s100 offen offset:0 sc1
    v_exp_f32 v143, v143
    v_pk_add_f32 v[136:137], v[136:137], 1.0 op_sel_hi:[1,0]
    v_pk_add_f32 v[138:139], v[138:139], 1.0 op_sel_hi:[1,0]
    v_pk_add_f32 v[140:141], v[140:141], 1.0 op_sel_hi:[1,0]
    v_pk_add_f32 v[142:143], v[142:143], 1.0 op_sel_hi:[1,0]
    v_rcp_f32 v136, v136
    v_rcp_f32 v137, v137
    v_rcp_f32 v138, v138
    v_rcp_f32 v139, v139
    v_rcp_f32 v140, v140
    v_rcp_f32 v141, v141
    v_rcp_f32 v142, v142
    v_rcp_f32 v143, v143
    v_pk_mul_f32 v[136:137], v[136:137], v[88:89]
    v_pk_mul_f32 v[138:139], v[138:139], v[90:91]
    v_pk_mul_f32 v[140:141], v[140:141], v[96:97]
    buffer_load_dwordx4 a[144:147], v6, s[16:19], s100 offen offset:1024 sc1
    v_pk_mul_f32 v[142:143], v[142:143], v[98:99]
    v_cvt_pk_bf16_f32 v152, v136, v137
    v_cvt_pk_bf16_f32 v153, v138, v139
    v_cvt_pk_bf16_f32 v154, v140, v141
    v_cvt_pk_bf16_f32 v155, v142, v143
    s_add_u32 s78, s77, 8192
    buffer_store_dwordx4 v[152:155], v6, s[16:19], s78 offen offset:0 sc1
    v_pk_mul_f32 v[144:145], v[92:93], v[92:93]
    v_pk_mul_f32 v[146:147], v[94:95], v[94:95]
    v_pk_mul_f32 v[148:149], v[100:101], v[100:101]
    v_pk_mul_f32 v[150:151], v[102:103], v[102:103]
    v_pk_fma_f32 v[144:145], v[144:145], v[14:15], s[98:99] op_sel_hi:[1,0,0]
    v_pk_fma_f32 v[146:147], v[146:147], v[14:15], s[98:99] op_sel_hi:[1,0,0]
    v_pk_fma_f32 v[148:149], v[148:149], v[14:15], s[98:99] op_sel_hi:[1,0,0]
    v_pk_fma_f32 v[150:151], v[150:151], v[14:15], s[98:99] op_sel_hi:[1,0,0]
    v_pk_mul_f32 v[144:145], v[144:145], v[92:93]
    v_pk_mul_f32 v[146:147], v[146:147], v[94:95]
    v_pk_mul_f32 v[148:149], v[148:149], v[100:101]
    v_pk_mul_f32 v[150:151], v[150:151], v[102:103]
    v_exp_f32 v144, v144
    v_exp_f32 v145, v145
    v_exp_f32 v146, v146
    v_exp_f32 v147, v147
    v_exp_f32 v148, v148
    v_exp_f32 v149, v149
    v_exp_f32 v150, v150
    v_exp_f32 v151, v151
    v_pk_add_f32 v[144:145], v[144:145], 1.0 op_sel_hi:[1,0]
    v_pk_add_f32 v[146:147], v[146:147], 1.0 op_sel_hi:[1,0]
    v_pk_add_f32 v[148:149], v[148:149], 1.0 op_sel_hi:[1,0]
    v_pk_add_f32 v[150:151], v[150:151], 1.0 op_sel_hi:[1,0]
    v_rcp_f32 v144, v144
    buffer_load_dwordx4 a[148:151], v6, s[16:19], s100 offen offset:2048 sc1
    v_rcp_f32 v145, v145
    v_rcp_f32 v146, v146
    v_rcp_f32 v147, v147
    v_rcp_f32 v148, v148
    v_rcp_f32 v149, v149
    v_rcp_f32 v150, v150
    v_rcp_f32 v151, v151
    v_pk_mul_f32 v[144:145], v[144:145], v[92:93]
    v_pk_mul_f32 v[146:147], v[146:147], v[94:95]
    v_pk_mul_f32 v[148:149], v[148:149], v[100:101]
    v_pk_mul_f32 v[150:151], v[150:151], v[102:103]
    v_cvt_pk_bf16_f32 v156, v144, v145
    v_cvt_pk_bf16_f32 v157, v146, v147
    v_cvt_pk_bf16_f32 v158, v148, v149
    v_cvt_pk_bf16_f32 v159, v150, v151
    buffer_store_dwordx4 v[156:159], v6, s[16:19], s78 offen offset:1024 sc1
    v_pk_mul_f32 v[136:137], v[104:105], v[104:105]
    v_pk_mul_f32 v[138:139], v[106:107], v[106:107]
    v_pk_mul_f32 v[140:141], v[112:113], v[112:113]
    v_pk_mul_f32 v[142:143], v[114:115], v[114:115]
    v_pk_fma_f32 v[136:137], v[136:137], v[14:15], s[98:99] op_sel_hi:[1,0,0]
    v_pk_fma_f32 v[138:139], v[138:139], v[14:15], s[98:99] op_sel_hi:[1,0,0]
    v_pk_fma_f32 v[140:141], v[140:141], v[14:15], s[98:99] op_sel_hi:[1,0,0]
    v_pk_fma_f32 v[142:143], v[142:143], v[14:15], s[98:99] op_sel_hi:[1,0,0]
    v_pk_mul_f32 v[136:137], v[136:137], v[104:105]
    v_pk_mul_f32 v[138:139], v[138:139], v[106:107]
    v_pk_mul_f32 v[140:141], v[140:141], v[112:113]
    v_pk_mul_f32 v[142:143], v[142:143], v[114:115]
    v_exp_f32 v136, v136
    v_exp_f32 v137, v137
    v_exp_f32 v138, v138
    v_exp_f32 v139, v139
    v_exp_f32 v140, v140
    v_exp_f32 v141, v141
    v_exp_f32 v142, v142
    buffer_load_dwordx4 a[152:155], v6, s[16:19], s100 offen offset:3072 sc1
    v_exp_f32 v143, v143
    v_pk_add_f32 v[136:137], v[136:137], 1.0 op_sel_hi:[1,0]
    v_pk_add_f32 v[138:139], v[138:139], 1.0 op_sel_hi:[1,0]
    v_pk_add_f32 v[140:141], v[140:141], 1.0 op_sel_hi:[1,0]
    v_pk_add_f32 v[142:143], v[142:143], 1.0 op_sel_hi:[1,0]
    v_rcp_f32 v136, v136
    v_rcp_f32 v137, v137
    v_rcp_f32 v138, v138
    v_rcp_f32 v139, v139
    v_rcp_f32 v140, v140
    v_rcp_f32 v141, v141
    v_rcp_f32 v142, v142
    v_rcp_f32 v143, v143
    v_pk_mul_f32 v[136:137], v[136:137], v[104:105]
    v_pk_mul_f32 v[138:139], v[138:139], v[106:107]
    v_pk_mul_f32 v[140:141], v[140:141], v[112:113]
    buffer_load_dwordx4 a[156:159], v240, s[16:19], s100 offen offset:0 sc1
    v_pk_mul_f32 v[142:143], v[142:143], v[114:115]
    v_cvt_pk_bf16_f32 v160, v136, v137
    v_cvt_pk_bf16_f32 v161, v138, v139
    v_cvt_pk_bf16_f32 v162, v140, v141
    v_cvt_pk_bf16_f32 v163, v142, v143
    s_add_u32 s78, s77, 12288
    buffer_store_dwordx4 v[160:163], v6, s[16:19], s78 offen offset:0 sc1
    v_pk_mul_f32 v[144:145], v[108:109], v[108:109]
    v_pk_mul_f32 v[146:147], v[110:111], v[110:111]
    v_pk_mul_f32 v[148:149], v[116:117], v[116:117]
    v_pk_mul_f32 v[150:151], v[118:119], v[118:119]
    v_pk_fma_f32 v[144:145], v[144:145], v[14:15], s[98:99] op_sel_hi:[1,0,0]
    v_pk_fma_f32 v[146:147], v[146:147], v[14:15], s[98:99] op_sel_hi:[1,0,0]
    v_pk_fma_f32 v[148:149], v[148:149], v[14:15], s[98:99] op_sel_hi:[1,0,0]
    v_pk_fma_f32 v[150:151], v[150:151], v[14:15], s[98:99] op_sel_hi:[1,0,0]
    v_pk_mul_f32 v[144:145], v[144:145], v[108:109]
    v_pk_mul_f32 v[146:147], v[146:147], v[110:111]
    v_pk_mul_f32 v[148:149], v[148:149], v[116:117]
    v_pk_mul_f32 v[150:151], v[150:151], v[118:119]
    v_exp_f32 v144, v144
    v_exp_f32 v145, v145
    v_exp_f32 v146, v146
    v_exp_f32 v147, v147
    v_exp_f32 v148, v148
    v_exp_f32 v149, v149
    v_exp_f32 v150, v150
    v_exp_f32 v151, v151
    v_pk_add_f32 v[144:145], v[144:145], 1.0 op_sel_hi:[1,0]
    v_pk_add_f32 v[146:147], v[146:147], 1.0 op_sel_hi:[1,0]
    v_pk_add_f32 v[148:149], v[148:149], 1.0 op_sel_hi:[1,0]
    v_pk_add_f32 v[150:151], v[150:151], 1.0 op_sel_hi:[1,0]
    v_rcp_f32 v144, v144
    s_add_u32 s100, s97, 163840
    buffer_load_dwordx4 a[160:163], v6, s[16:19], s100 offen offset:0 sc1
    v_rcp_f32 v145, v145
    v_rcp_f32 v146, v146
    v_rcp_f32 v147, v147
    v_rcp_f32 v148, v148
    v_rcp_f32 v149, v149
    v_rcp_f32 v150, v150
    v_rcp_f32 v151, v151
    v_pk_mul_f32 v[144:145], v[144:145], v[108:109]
    v_pk_mul_f32 v[146:147], v[146:147], v[110:111]
    v_pk_mul_f32 v[148:149], v[148:149], v[116:117]
    v_pk_mul_f32 v[150:151], v[150:151], v[118:119]
    v_cvt_pk_bf16_f32 v164, v144, v145
    v_cvt_pk_bf16_f32 v165, v146, v147
    v_cvt_pk_bf16_f32 v166, v148, v149
    v_cvt_pk_bf16_f32 v167, v150, v151
    buffer_store_dwordx4 v[164:167], v6, s[16:19], s78 offen offset:1024 sc1
    v_pk_mul_f32 v[136:137], v[120:121], v[120:121]
    v_pk_mul_f32 v[138:139], v[122:123], v[122:123]
    v_pk_mul_f32 v[140:141], v[128:129], v[128:129]
    v_pk_mul_f32 v[142:143], v[130:131], v[130:131]
    v_pk_fma_f32 v[136:137], v[136:137], v[14:15], s[98:99] op_sel_hi:[1,0,0]
    v_pk_fma_f32 v[138:139], v[138:139], v[14:15], s[98:99] op_sel_hi:[1,0,0]
    v_pk_fma_f32 v[140:141], v[140:141], v[14:15], s[98:99] op_sel_hi:[1,0,0]
    v_pk_fma_f32 v[142:143], v[142:143], v[14:15], s[98:99] op_sel_hi:[1,0,0]
    v_pk_mul_f32 v[136:137], v[136:137], v[120:121]
    v_pk_mul_f32 v[138:139], v[138:139], v[122:123]
    v_pk_mul_f32 v[140:141], v[140:141], v[128:129]
    v_pk_mul_f32 v[142:143], v[142:143], v[130:131]
    v_exp_f32 v136, v136
    v_exp_f32 v137, v137
    v_exp_f32 v138, v138
    v_exp_f32 v139, v139
    v_exp_f32 v140, v140
    v_exp_f32 v141, v141
    v_exp_f32 v142, v142
    buffer_load_dwordx4 a[164:167], v6, s[16:19], s100 offen offset:1024 sc1
    v_exp_f32 v143, v143
    v_pk_add_f32 v[136:137], v[136:137], 1.0 op_sel_hi:[1,0]
    v_pk_add_f32 v[138:139], v[138:139], 1.0 op_sel_hi:[1,0]
    v_pk_add_f32 v[140:141], v[140:141], 1.0 op_sel_hi:[1,0]
    v_pk_add_f32 v[142:143], v[142:143], 1.0 op_sel_hi:[1,0]
    v_rcp_f32 v136, v136
    v_rcp_f32 v137, v137
    v_rcp_f32 v138, v138
    v_rcp_f32 v139, v139
    v_rcp_f32 v140, v140
    v_rcp_f32 v141, v141
    v_rcp_f32 v142, v142
    v_rcp_f32 v143, v143
    v_pk_mul_f32 v[136:137], v[136:137], v[120:121]
    v_pk_mul_f32 v[138:139], v[138:139], v[122:123]
    v_pk_mul_f32 v[140:141], v[140:141], v[128:129]
    buffer_load_dwordx4 a[168:171], v6, s[16:19], s100 offen offset:2048 sc1
    v_pk_mul_f32 v[142:143], v[142:143], v[130:131]
    v_cvt_pk_bf16_f32 v152, v136, v137
    v_cvt_pk_bf16_f32 v153, v138, v139
    v_cvt_pk_bf16_f32 v154, v140, v141
    v_cvt_pk_bf16_f32 v155, v142, v143
    s_add_u32 s78, s77, 16384
    s_cmp_lt_u32 s61, 6
    s_cselect_b32 s78, s78, 2146435072
    buffer_store_dwordx4 v[152:155], v6, s[16:19], s78 offen offset:0 sc1
    v_pk_mul_f32 v[144:145], v[124:125], v[124:125]
    v_pk_mul_f32 v[146:147], v[126:127], v[126:127]
    v_pk_mul_f32 v[148:149], v[132:133], v[132:133]
    v_pk_mul_f32 v[150:151], v[134:135], v[134:135]
    v_pk_fma_f32 v[144:145], v[144:145], v[14:15], s[98:99] op_sel_hi:[1,0,0]
    v_pk_fma_f32 v[146:147], v[146:147], v[14:15], s[98:99] op_sel_hi:[1,0,0]
    v_pk_fma_f32 v[148:149], v[148:149], v[14:15], s[98:99] op_sel_hi:[1,0,0]
    v_pk_fma_f32 v[150:151], v[150:151], v[14:15], s[98:99] op_sel_hi:[1,0,0]
    v_pk_mul_f32 v[144:145], v[144:145], v[124:125]
    v_pk_mul_f32 v[146:147], v[146:147], v[126:127]
    v_pk_mul_f32 v[148:149], v[148:149], v[132:133]
    v_pk_mul_f32 v[150:151], v[150:151], v[134:135]
    v_exp_f32 v144, v144
    v_exp_f32 v145, v145
    v_exp_f32 v146, v146
    v_exp_f32 v147, v147
    v_exp_f32 v148, v148
    v_exp_f32 v149, v149
    v_exp_f32 v150, v150
    v_exp_f32 v151, v151
    v_pk_add_f32 v[144:145], v[144:145], 1.0 op_sel_hi:[1,0]
    v_pk_add_f32 v[146:147], v[146:147], 1.0 op_sel_hi:[1,0]
    v_pk_add_f32 v[148:149], v[148:149], 1.0 op_sel_hi:[1,0]
    v_pk_add_f32 v[150:151], v[150:151], 1.0 op_sel_hi:[1,0]
    buffer_load_dwordx4 a[172:175], v6, s[16:19], s100 offen offset:3072 sc1
    v_rcp_f32 v144, v144
    v_rcp_f32 v145, v145
    v_rcp_f32 v146, v146
    v_rcp_f32 v147, v147
    v_rcp_f32 v148, v148
    v_rcp_f32 v149, v149
    v_rcp_f32 v150, v150
    v_rcp_f32 v151, v151
    v_pk_mul_f32 v[144:145], v[144:145], v[124:125]
    v_pk_mul_f32 v[146:147], v[146:147], v[126:127]
    v_pk_mul_f32 v[148:149], v[148:149], v[132:133]
    v_pk_mul_f32 v[150:151], v[150:151], v[134:135]
    v_cvt_pk_bf16_f32 v156, v144, v145
    v_cvt_pk_bf16_f32 v157, v146, v147
    v_cvt_pk_bf16_f32 v158, v148, v149
    v_cvt_pk_bf16_f32 v159, v150, v151
    buffer_store_dwordx4 v[156:159], v6, s[16:19], s78 offen offset:1024 sc1
    s_lshl_b32 s78, s60, 4
    s_add_u32 s78, s78, s61
    s_lshl_b32 s78, s78, 7
    s_add_u32 s78, s78, 40960
    s_cmp_eq_u32 s3, 0
    s_cselect_b32 s79, s78, 2146435072
    s_mov_b32 s98, 0x3fb8aa3b
    v_lshlrev_b32 v7, 4, v2
    v_lshlrev_b32 v8, 3, v2
    buffer_load_dwordx4 v[224:227], v7, s[24:27], s82 offen
    buffer_load_dwordx4 v[228:231], v7, s[24:27], s82 offen offset:64
    buffer_load_dwordx2 v[232:233], v8, s[24:27], s81 offen
    v_cvt_pk_bf16_f32 v56, v16, v17
    v_cvt_pk_bf16_f32 v57, v18, v19
    v_cvt_pk_bf16_f32 v58, v24, v25
    v_cvt_pk_bf16_f32 v59, v26, v27
    v_cvt_pk_bf16_f32 v60, v32, v33
    v_cvt_pk_bf16_f32 v61, v34, v35
    v_cvt_pk_bf16_f32 v62, v40, v41
    v_cvt_pk_bf16_f32 v63, v42, v43
    v_cvt_pk_bf16_f32 v64, v48, v49
    v_cvt_pk_bf16_f32 v65, v50, v51
    v_cvt_pk_bf16_f32 v66, v20, v21
    v_cvt_pk_bf16_f32 v67, v22, v23
    v_cvt_pk_bf16_f32 v68, v28, v29
    v_cvt_pk_bf16_f32 v69, v30, v31
    v_cvt_pk_bf16_f32 v70, v36, v37
    v_cvt_pk_bf16_f32 v71, v38, v39
    v_cvt_pk_bf16_f32 v72, v44, v45
    v_cvt_pk_bf16_f32 v73, v46, v47
    v_cvt_pk_bf16_f32 v74, v52, v53
    v_cvt_pk_bf16_f32 v75, v54, v55
    v_mfma_f32_4x4x4_16b_bf16 v[76:79], a[204:205], v[56:57], 0
    v_mfma_f32_4x4x4_16b_bf16 v[80:83], a[206:207], v[56:57], 0
    v_mfma_f32_4x4x4_16b_bf16 v[84:87], a[208:209], v[56:57], 0
    v_mfma_f32_4x4x4_16b_bf16 v[88:91], a[210:211], v[56:57], 0
    v_mfma_f32_4x4x4_16b_bf16 v[92:95], a[212:213], v[56:57], 0
    v_mfma_f32_4x4x4_16b_bf16 v[96:99], a[204:205], v[66:67], 0
    v_mfma_f32_4x4x4_16b_bf16 v[100:103], a[206:207], v[66:67], 0
    v_mfma_f32_4x4x4_16b_bf16 v[104:107], a[208:209], v[66:67], 0
    v_mfma_f32_4x4x4_16b_bf16 v[108:111], a[210:211], v[66:67], 0
    v_mfma_f32_4x4x4_16b_bf16 v[112:115], a[212:213], v[66:67], 0
    v_mfma_f32_4x4x4_16b_bf16 v[76:79], a[214:215], v[58:59], v[76:79]
    v_mfma_f32_4x4x4_16b_bf16 v[80:83], a[216:217], v[58:59], v[80:83]
    buffer_load_dwordx4 a[176:179], v240, s[16:19], s100 offen offset:0 sc1
    v_mfma_f32_4x4x4_16b_bf16 v[84:87], a[218:219], v[58:59], v[84:87]
    v_mfma_f32_4x4x4_16b_bf16 v[88:91], a[220:221], v[58:59], v[88:91]
    v_mfma_f32_4x4x4_16b_bf16 v[92:95], a[222:223], v[58:59], v[92:95]
    v_mfma_f32_4x4x4_16b_bf16 v[96:99], a[214:215], v[68:69], v[96:99]
    v_mfma_f32_4x4x4_16b_bf16 v[100:103], a[216:217], v[68:69], v[100:103]
    v_mfma_f32_4x4x4_16b_bf16 v[104:107], a[218:219], v[68:69], v[104:107]
    v_mfma_f32_4x4x4_16b_bf16 v[108:111], a[220:221], v[68:69], v[108:111]
    v_mfma_f32_4x4x4_16b_bf16 v[112:115], a[222:223], v[68:69], v[112:115]
    s_mov_b32 s100, s86
    buffer_load_dwordx4 a[180:183], v6, s[16:19], s100 offen offset:0 sc1
    v_mfma_f32_4x4x4_16b_bf16 v[76:79], a[224:225], v[60:61], v[76:79]
    v_mfma_f32_4x4x4_16b_bf16 v[80:83], a[226:227], v[60:61], v[80:83]
    v_mfma_f32_4x4x4_16b_bf16 v[84:87], a[228:229], v[60:61], v[84:87]
    v_mfma_f32_4x4x4_16b_bf16 v[88:91], a[230:231], v[60:61], v[88:91]
    v_mfma_f32_4x4x4_16b_bf16 v[92:95], a[232:233], v[60:61], v[92:95]
    v_mfma_f32_4x4x4_16b_bf16 v[96:99], a[224:225], v[70:71], v[96:99]
    v_mfma_f32_4x4x4_16b_bf16 v[100:103], a[226:227], v[70:71], v[100:103]
    buffer_load_dwordx4 a[184:187], v6, s[16:19], s100 offen offset:1024 sc1
    v_mfma_f32_4x4x4_16b_bf16 v[104:107], a[228:229], v[70:71], v[104:107]
    v_mfma_f32_4x4x4_16b_bf16 v[108:111], a[230:231], v[70:71], v[108:111]
    v_mfma_f32_4x4x4_16b_bf16 v[112:115], a[232:233], v[70:71], v[112:115]
    v_mfma_f32_4x4x4_16b_bf16 v[76:79], a[234:235], v[62:63], v[76:79]
    v_mfma_f32_4x4x4_16b_bf16 v[80:83], a[236:237], v[62:63], v[80:83]
    v_mfma_f32_4x4x4_16b_bf16 v[84:87], a[238:239], v[62:63], v[84:87]
    v_mfma_f32_4x4x4_16b_bf16 v[88:91], a[240:241], v[62:63], v[88:91]
    buffer_load_dwordx4 a[188:191], v6, s[16:19], s100 offen offset:2048 sc1
    v_mfma_f32_4x4x4_16b_bf16 v[92:95], a[242:243], v[62:63], v[92:95]
    v_mfma_f32_4x4x4_16b_bf16 v[96:99], a[234:235], v[72:73], v[96:99]
    v_mfma_f32_4x4x4_16b_bf16 v[100:103], a[236:237], v[72:73], v[100:103]
    v_mfma_f32_4x4x4_16b_bf16 v[104:107], a[238:239], v[72:73], v[104:107]
    v_mfma_f32_4x4x4_16b_bf16 v[108:111], a[240:241], v[72:73], v[108:111]
    v_mfma_f32_4x4x4_16b_bf16 v[112:115], a[242:243], v[72:73], v[112:115]
    v_mfma_f32_4x4x4_16b_bf16 v[76:79], a[244:245], v[64:65], v[76:79]
    v_mfma_f32_4x4x4_16b_bf16 v[80:83], a[246:247], v[64:65], v[80:83]
    buffer_load_dwordx4 a[192:195], v6, s[16:19], s100 offen offset:3072 sc1
    v_mfma_f32_4x4x4_16b_bf16 v[84:87], a[248:249], v[64:65], v[84:87]
    v_mfma_f32_4x4x4_16b_bf16 v[88:91], a[250:251], v[64:65], v[88:91]
    v_mfma_f32_4x4x4_16b_bf16 v[92:95], a[252:253], v[64:65], v[92:95]
    v_mfma_f32_4x4x4_16b_bf16 v[96:99], a[244:245], v[74:75], v[96:99]
    v_mfma_f32_4x4x4_16b_bf16 v[100:103], a[246:247], v[74:75], v[100:103]
    v_mfma_f32_4x4x4_16b_bf16 v[104:107], a[248:249], v[74:75], v[104:107]
    v_mfma_f32_4x4x4_16b_bf16 v[108:111], a[250:251], v[74:75], v[108:111]
    buffer_load_dwordx4 a[196:199], v240, s[16:19], s100 offen offset:0 sc1
    v_mfma_f32_4x4x4_16b_bf16 v[112:115], a[252:253], v[74:75], v[112:115]
    v_max3_f32 v8, v76, v77, v78
    v_min3_f32 v10, v76, v77, v78
    v_max3_f32 v8, v8, v79, v80
    v_min3_f32 v10, v10, v79, v80
    v_max3_f32 v8, v8, v81, v82
    v_min3_f32 v10, v10, v81, v82
    v_max3_f32 v8, v8, v83, v84
    v_min3_f32 v10, v10, v83, v84
    v_max3_f32 v8, v8, v85, v86
    v_min3_f32 v10, v10, v85, v86
    v_max3_f32 v8, v8, v87, v88
    v_min3_f32 v10, v10, v87, v88
    v_max3_f32 v8, v8, v89, v90
    s_add_u32 s100, s97, 194560
    buffer_load_dwordx4 a[200:203], v6, s[16:19], s100 offen offset:0 sc1
    v_min3_f32 v10, v10, v89, v90
    v_max3_f32 v8, v8, v91, v92
    v_min3_f32 v10, v10, v91, v92
    v_max3_f32 v8, v8, v93, v94
    v_min3_f32 v10, v10, v93, v94
    v_max_f32 v8, v8, v95
    v_min_f32 v10, v10, v95
    s_waitcnt vmcnt(10)
    s_barrier
    buffer_store_dwordx2 v[246:247], v245, s[16:19], s79 offen sc1
    v_mul_f32_e64 v8, -v8, s98
    v_mul_f32 v10, s98, v10
    v_pk_fma_f32 v[16:17], v[76:77], s[98:99], v[8:9] op_sel_hi:[1,0,0]
    v_pk_fma_f32 v[36:37], v[76:77], s[98:99], v[10:11] op_sel_hi:[1,0,0] neg_lo:[1,0,0] neg_hi:[1,0,0]
    v_pk_fma_f32 v[18:19], v[78:79], s[98:99], v[8:9] op_sel_hi:[1,0,0]
    v_pk_fma_f32 v[38:39], v[78:79], s[98:99], v[10:11] op_sel_hi:[1,0,0] neg_lo:[1,0,0] neg_hi:[1,0,0]
    v_pk_fma_f32 v[20:21], v[80:81], s[98:99], v[8:9] op_sel_hi:[1,0,0]
    v_pk_fma_f32 v[40:41], v[80:81], s[98:99], v[10:11] op_sel_hi:[1,0,0] neg_lo:[1,0,0] neg_hi:[1,0,0]
    v_pk_fma_f32 v[22:23], v[82:83], s[98:99], v[8:9] op_sel_hi:[1,0,0]
    v_pk_fma_f32 v[42:43], v[82:83], s[98:99], v[10:11] op_sel_hi:[1,0,0] neg_lo:[1,0,0] neg_hi:[1,0,0]
    v_pk_fma_f32 v[24:25], v[84:85], s[98:99], v[8:9] op_sel_hi:[1,0,0]
    v_pk_fma_f32 v[44:45], v[84:85], s[98:99], v[10:11] op_sel_hi:[1,0,0] neg_lo:[1,0,0] neg_hi:[1,0,0]
    v_pk_fma_f32 v[26:27], v[86:87], s[98:99], v[8:9] op_sel_hi:[1,0,0]
    v_pk_fma_f32 v[46:47], v[86:87], s[98:99], v[10:11] op_sel_hi:[1,0,0] neg_lo:[1,0,0] neg_hi:[1,0,0]
    v_pk_fma_f32 v[28:29], v[88:89], s[98:99], v[8:9] op_sel_hi:[1,0,0]
    v_pk_fma_f32 v[48:49], v[88:89], s[98:99], v[10:11] op_sel_hi:[1,0,0] neg_lo:[1,0,0] neg_hi:[1,0,0]
    v_pk_fma_f32 v[30:31], v[90:91], s[98:99], v[8:9] op_sel_hi:[1,0,0]
    v_pk_fma_f32 v[50:51], v[90:91], s[98:99], v[10:11] op_sel_hi:[1,0,0] neg_lo:[1,0,0] neg_hi:[1,0,0]
    v_pk_fma_f32 v[32:33], v[92:93], s[98:99], v[8:9] op_sel_hi:[1,0,0]
    v_pk_fma_f32 v[52:53], v[92:93], s[98:99], v[10:11] op_sel_hi:[1,0,0] neg_lo:[1,0,0] neg_hi:[1,0,0]
    buffer_load_dwordx4 a[204:207], v6, s[16:19], s100 offen offset:1024 sc1
    v_pk_fma_f32 v[34:35], v[94:95], s[98:99], v[8:9] op_sel_hi:[1,0,0]
    v_pk_fma_f32 v[54:55], v[94:95], s[98:99], v[10:11] op_sel_hi:[1,0,0] neg_lo:[1,0,0] neg_hi:[1,0,0]
    v_exp_f32 v16, v16
    v_exp_f32 v17, v17
    v_exp_f32 v18, v18
    v_exp_f32 v19, v19
    v_exp_f32 v20, v20
    v_exp_f32 v21, v21
    v_exp_f32 v22, v22
    buffer_load_dwordx4 a[208:211], v6, s[16:19], s100 offen offset:2048 sc1
    v_exp_f32 v23, v23
    v_exp_f32 v24, v24
    v_exp_f32 v25, v25
    v_exp_f32 v26, v26
    v_exp_f32 v27, v27
    v_exp_f32 v28, v28
    v_exp_f32 v29, v29
    buffer_load_dwordx4 a[212:215], v6, s[16:19], s100 offen offset:3072 sc1
    v_exp_f32 v30, v30
    v_exp_f32 v31, v31
    v_exp_f32 v32, v32
    v_exp_f32 v33, v33
    v_exp_f32 v34, v34
    v_exp_f32 v35, v35
    v_exp_f32 v36, v36
    v_exp_f32 v37, v37
    buffer_load_dwordx4 a[216:219], v240, s[16:19], s100 offen offset:0 sc1
    v_exp_f32 v38, v38
    v_exp_f32 v39, v39
    v_exp_f32 v40, v40
    v_exp_f32 v41, v41
    v_exp_f32 v42, v42
    v_exp_f32 v43, v43
    v_exp_f32 v44, v44
    s_add_u32 s100, s97, 215040
    buffer_load_dwordx4 a[220:223], v6, s[16:19], s100 offen offset:0 sc1
    v_exp_f32 v45, v45
    v_exp_f32 v46, v46
    v_exp_f32 v47, v47
    v_exp_f32 v48, v48
    v_exp_f32 v49, v49
    v_exp_f32 v50, v50
    v_exp_f32 v51, v51
    buffer_load_dwordx4 a[224:227], v6, s[16:19], s100 offen offset:1024 sc1
    v_exp_f32 v52, v52
    v_exp_f32 v53, v53
    v_exp_f32 v54, v54
    v_exp_f32 v55, v55
    v_pk_add_f32 v[8:9], v[16:17], v[18:19]
    v_pk_add_f32 v[10:11], v[36:37], v[38:39]
    v_pk_add_f32 v[8:9], v[8:9], v[20:21]
    v_pk_add_f32 v[10:11], v[10:11], v[40:41]
    v_pk_add_f32 v[8:9], v[8:9], v[22:23]
    v_pk_add_f32 v[10:11], v[10:11], v[42:43]
    v_pk_add_f32 v[8:9], v[8:9], v[24:25]
    buffer_load_dwordx4 a[228:231], v6, s[16:19], s100 offen offset:2048 sc1
    v_pk_add_f32 v[10:11], v[10:11], v[44:45]
    v_pk_add_f32 v[8:9], v[8:9], v[26:27]
    v_pk_add_f32 v[10:11], v[10:11], v[46:47]
    v_pk_add_f32 v[8:9], v[8:9], v[28:29]
    v_pk_add_f32 v[10:11], v[10:11], v[48:49]
    v_pk_add_f32 v[8:9], v[8:9], v[30:31]
    v_pk_add_f32 v[10:11], v[10:11], v[50:51]
    v_pk_add_f32 v[8:9], v[8:9], v[32:33]
    v_pk_add_f32 v[10:11], v[10:11], v[52:53]
    v_pk_add_f32 v[8:9], v[8:9], v[34:35]
    v_pk_add_f32 v[10:11], v[10:11], v[54:55]
    v_add_f32 v8, v8, v9
    v_add_f32 v10, v10, v11
    v_rcp_f32 v8, v8
    buffer_load_dwordx4 a[232:235], v6, s[16:19], s100 offen offset:3072 sc1
    v_rcp_f32 v10, v10
    v_pk_mul_f32 v[16:17], v[16:17], v[8:9] op_sel_hi:[1,0]
    v_pk_mul_f32 v[18:19], v[18:19], v[8:9] op_sel_hi:[1,0]
    v_pk_mul_f32 v[20:21], v[20:21], v[8:9] op_sel_hi:[1,0]
    v_pk_mul_f32 v[22:23], v[22:23], v[8:9] op_sel_hi:[1,0]
    v_pk_mul_f32 v[24:25], v[24:25], v[8:9] op_sel_hi:[1,0]
    v_pk_mul_f32 v[26:27], v[26:27], v[8:9] op_sel_hi:[1,0]
    v_pk_mul_f32 v[28:29], v[28:29], v[8:9] op_sel_hi:[1,0]
    v_pk_mul_f32 v[30:31], v[30:31], v[8:9] op_sel_hi:[1,0]
    v_pk_mul_f32 v[32:33], v[32:33], v[8:9] op_sel_hi:[1,0]
    v_pk_mul_f32 v[34:35], v[34:35], v[8:9] op_sel_hi:[1,0]
    v_pk_mul_f32 v[36:37], v[36:37], v[10:11] op_sel_hi:[1,0]
    v_pk_mul_f32 v[38:39], v[38:39], v[10:11] op_sel_hi:[1,0]
    v_pk_mul_f32 v[40:41], v[40:41], v[10:11] op_sel_hi:[1,0]
    buffer_load_dwordx4 a[236:239], v240, s[16:19], s100 offen offset:0 sc1
    v_pk_mul_f32 v[42:43], v[42:43], v[10:11] op_sel_hi:[1,0]
    v_pk_mul_f32 v[44:45], v[44:45], v[10:11] op_sel_hi:[1,0]
    v_pk_mul_f32 v[46:47], v[46:47], v[10:11] op_sel_hi:[1,0]
    v_pk_mul_f32 v[48:49], v[48:49], v[10:11] op_sel_hi:[1,0]
    v_pk_mul_f32 v[50:51], v[50:51], v[10:11] op_sel_hi:[1,0]
    v_pk_mul_f32 v[52:53], v[52:53], v[10:11] op_sel_hi:[1,0]
    v_pk_mul_f32 v[54:55], v[54:55], v[10:11] op_sel_hi:[1,0]
    v_cvt_pk_bf16_f32 v116, v16, v17
    v_cvt_pk_bf16_f32 v117, v18, v19
    v_cvt_pk_bf16_f32 v118, v20, v21
    v_cvt_pk_bf16_f32 v119, v22, v23
    v_cvt_pk_bf16_f32 v120, v24, v25
    v_cvt_pk_bf16_f32 v121, v26, v27
    v_cvt_pk_bf16_f32 v122, v28, v29
    v_cvt_pk_bf16_f32 v123, v30, v31
    s_add_u32 s100, s97, 235520
    buffer_load_dwordx4 a[240:243], v6, s[16:19], s100 offen offset:0 sc1
    v_cvt_pk_bf16_f32 v124, v32, v33
    v_cvt_pk_bf16_f32 v125, v34, v35
    v_cvt_pk_bf16_f32 v126, v36, v37
    v_cvt_pk_bf16_f32 v127, v38, v39
    v_cvt_pk_bf16_f32 v128, v40, v41
    v_cvt_pk_bf16_f32 v129, v42, v43
    v_cvt_pk_bf16_f32 v130, v44, v45
    v_cvt_pk_bf16_f32 v131, v46, v47
    v_cvt_pk_bf16_f32 v132, v48, v49
    v_cvt_pk_bf16_f32 v133, v50, v51
    v_cvt_pk_bf16_f32 v134, v52, v53
    v_cvt_pk_bf16_f32 v135, v54, v55
    v_max3_f32 v8, v96, v97, v98
    v_min3_f32 v10, v96, v97, v98
    buffer_load_dwordx4 a[244:247], v6, s[16:19], s100 offen offset:1024 sc1
    v_max3_f32 v8, v8, v99, v100
    v_min3_f32 v10, v10, v99, v100
    v_max3_f32 v8, v8, v101, v102
    v_min3_f32 v10, v10, v101, v102
    v_max3_f32 v8, v8, v103, v104
    v_min3_f32 v10, v10, v103, v104
    v_max3_f32 v8, v8, v105, v106
    v_min3_f32 v10, v10, v105, v106
    v_max3_f32 v8, v8, v107, v108
    v_min3_f32 v10, v10, v107, v108
    v_max3_f32 v8, v8, v109, v110
    v_min3_f32 v10, v10, v109, v110
    v_max3_f32 v8, v8, v111, v112
    v_min3_f32 v10, v10, v111, v112
    v_max3_f32 v8, v8, v113, v114
    buffer_load_dwordx4 a[248:251], v6, s[16:19], s100 offen offset:2048 sc1
    v_min3_f32 v10, v10, v113, v114
    v_max_f32 v8, v8, v115
    v_min_f32 v10, v10, v115
    v_mul_f32_e64 v8, -v8, s98
    v_mul_f32 v10, s98, v10
    v_pk_fma_f32 v[16:17], v[96:97], s[98:99], v[8:9] op_sel_hi:[1,0,0]
    v_pk_fma_f32 v[36:37], v[96:97], s[98:99], v[10:11] op_sel_hi:[1,0,0] neg_lo:[1,0,0] neg_hi:[1,0,0]
    v_pk_fma_f32 v[18:19], v[98:99], s[98:99], v[8:9] op_sel_hi:[1,0,0]
    v_pk_fma_f32 v[38:39], v[98:99], s[98:99], v[10:11] op_sel_hi:[1,0,0] neg_lo:[1,0,0] neg_hi:[1,0,0]
    v_pk_fma_f32 v[20:21], v[100:101], s[98:99], v[8:9] op_sel_hi:[1,0,0]
    v_pk_fma_f32 v[40:41], v[100:101], s[98:99], v[10:11] op_sel_hi:[1,0,0] neg_lo:[1,0,0] neg_hi:[1,0,0]
    v_pk_fma_f32 v[22:23], v[102:103], s[98:99], v[8:9] op_sel_hi:[1,0,0]
    v_pk_fma_f32 v[42:43], v[102:103], s[98:99], v[10:11] op_sel_hi:[1,0,0] neg_lo:[1,0,0] neg_hi:[1,0,0]
    v_pk_fma_f32 v[24:25], v[104:105], s[98:99], v[8:9] op_sel_hi:[1,0,0]
    v_pk_fma_f32 v[44:45], v[104:105], s[98:99], v[10:11] op_sel_hi:[1,0,0] neg_lo:[1,0,0] neg_hi:[1,0,0]
    buffer_load_dwordx4 a[252:255], v6, s[16:19], s100 offen offset:3072 sc1
    v_pk_fma_f32 v[26:27], v[106:107], s[98:99], v[8:9] op_sel_hi:[1,0,0]
    v_pk_fma_f32 v[46:47], v[106:107], s[98:99], v[10:11] op_sel_hi:[1,0,0] neg_lo:[1,0,0] neg_hi:[1,0,0]
    v_pk_fma_f32 v[28:29], v[108:109], s[98:99], v[8:9] op_sel_hi:[1,0,0]
    v_pk_fma_f32 v[48:49], v[108:109], s[98:99], v[10:11] op_sel_hi:[1,0,0] neg_lo:[1,0,0] neg_hi:[1,0,0]
    v_pk_fma_f32 v[30:31], v[110:111], s[98:99], v[8:9] op_sel_hi:[1,0,0]
    v_pk_fma_f32 v[50:51], v[110:111], s[98:99], v[10:11] op_sel_hi:[1,0,0] neg_lo:[1,0,0] neg_hi:[1,0,0]
    v_pk_fma_f32 v[32:33], v[112:113], s[98:99], v[8:9] op_sel_hi:[1,0,0]
    v_pk_fma_f32 v[52:53], v[112:113], s[98:99], v[10:11] op_sel_hi:[1,0,0] neg_lo:[1,0,0] neg_hi:[1,0,0]
    v_pk_fma_f32 v[34:35], v[114:115], s[98:99], v[8:9] op_sel_hi:[1,0,0]
    v_pk_fma_f32 v[54:55], v[114:115], s[98:99], v[10:11] op_sel_hi:[1,0,0] neg_lo:[1,0,0] neg_hi:[1,0,0]
    v_exp_f32 v16, v16
    v_exp_f32 v17, v17
    v_exp_f32 v18, v18
    s_add_u32 m0, s88, 73728
    s_nop 0
    buffer_load_dwordx4 v240, s[16:19], s100 offen offset:0 sc1 lds
    v_exp_f32 v19, v19
    v_exp_f32 v20, v20
    v_exp_f32 v21, v21
    v_exp_f32 v22, v22
    v_exp_f32 v23, v23
    v_exp_f32 v24, v24
    v_exp_f32 v25, v25
    s_add_u32 s100, s97, 256000
    s_add_u32 m0, s88, 74752
    s_nop 0
    buffer_load_dwordx4 v6, s[16:19], s100 offen offset:0 sc1 lds
    v_exp_f32 v26, v26
    v_exp_f32 v27, v27
    v_exp_f32 v28, v28
    v_exp_f32 v29, v29
    v_exp_f32 v30, v30
    v_exp_f32 v31, v31
    s_add_u32 m0, s88, 74752
    s_nop 0
    buffer_load_dwordx4 v6, s[16:19], s100 offen offset:1024 sc1 lds
    v_exp_f32 v32, v32
    v_exp_f32 v33, v33
    v_exp_f32 v34, v34
    v_exp_f32 v35, v35
    v_exp_f32 v36, v36
    v_exp_f32 v37, v37
    v_exp_f32 v38, v38
    s_add_u32 m0, s88, 74752
    s_nop 0
    buffer_load_dwordx4 v6, s[16:19], s100 offen offset:2048 sc1 lds
    v_exp_f32 v39, v39
    v_exp_f32 v40, v40
    v_exp_f32 v41, v41
    v_exp_f32 v42, v42
    v_exp_f32 v43, v43
    v_exp_f32 v44, v44
    v_exp_f32 v45, v45
    s_add_u32 m0, s88, 74752
    s_nop 0
    buffer_load_dwordx4 v6, s[16:19], s100 offen offset:3072 sc1 lds
    v_exp_f32 v46, v46
    v_exp_f32 v47, v47
    v_exp_f32 v48, v48
    v_exp_f32 v49, v49
    v_exp_f32 v50, v50
    v_exp_f32 v51, v51
    v_exp_f32 v52, v52
    s_add_u32 m0, s88, 78848
    s_nop 0
    buffer_load_dwordx4 v240, s[16:19], s100 offen offset:0 sc1 lds
    v_exp_f32 v53, v53
    v_exp_f32 v54, v54
    v_exp_f32 v55, v55
    v_pk_add_f32 v[8:9], v[16:17], v[18:19]
    v_pk_add_f32 v[10:11], v[36:37], v[38:39]
    v_pk_add_f32 v[8:9], v[8:9], v[20:21]
    v_pk_add_f32 v[10:11], v[10:11], v[40:41]
    v_pk_add_f32 v[8:9], v[8:9], v[22:23]
    v_pk_add_f32 v[10:11], v[10:11], v[42:43]
    v_pk_add_f32 v[8:9], v[8:9], v[24:25]
    v_pk_add_f32 v[10:11], v[10:11], v[44:45]
    s_add_u32 s100, s97, 276480
    s_add_u32 m0, s88, 79872
    s_nop 0
    buffer_load_dwordx4 v6, s[16:19], s100 offen offset:0 sc1 lds
    v_pk_add_f32 v[8:9], v[8:9], v[26:27]
    v_pk_add_f32 v[10:11], v[10:11], v[46:47]
    v_pk_add_f32 v[8:9], v[8:9], v[28:29]
    v_pk_add_f32 v[10:11], v[10:11], v[48:49]
    v_pk_add_f32 v[8:9], v[8:9], v[30:31]
    v_pk_add_f32 v[10:11], v[10:11], v[50:51]
    v_pk_add_f32 v[8:9], v[8:9], v[32:33]
    v_pk_add_f32 v[10:11], v[10:11], v[52:53]
    v_pk_add_f32 v[8:9], v[8:9], v[34:35]
    v_pk_add_f32 v[10:11], v[10:11], v[54:55]
    buffer_load_dwordx2 v[252:253], v235, s[16:19], s83 offen sc1
    v_add_f32 v8, v8, v9
    v_add_f32 v10, v10, v11
    v_rcp_f32 v8, v8
    v_rcp_f32 v10, v10
    v_pk_mul_f32 v[16:17], v[16:17], v[8:9] op_sel_hi:[1,0]
    v_pk_mul_f32 v[18:19], v[18:19], v[8:9] op_sel_hi:[1,0]
    v_pk_mul_f32 v[20:21], v[20:21], v[8:9] op_sel_hi:[1,0]
    v_pk_mul_f32 v[22:23], v[22:23], v[8:9] op_sel_hi:[1,0]
    v_pk_mul_f32 v[24:25], v[24:25], v[8:9] op_sel_hi:[1,0]
    v_pk_mul_f32 v[26:27], v[26:27], v[8:9] op_sel_hi:[1,0]
    v_pk_mul_f32 v[28:29], v[28:29], v[8:9] op_sel_hi:[1,0]
    v_pk_mul_f32 v[30:31], v[30:31], v[8:9] op_sel_hi:[1,0]
    v_pk_mul_f32 v[32:33], v[32:33], v[8:9] op_sel_hi:[1,0]
    v_pk_mul_f32 v[34:35], v[34:35], v[8:9] op_sel_hi:[1,0]
    v_pk_mul_f32 v[36:37], v[36:37], v[10:11] op_sel_hi:[1,0]
    v_pk_mul_f32 v[38:39], v[38:39], v[10:11] op_sel_hi:[1,0]
    s_add_u32 m0, s88, 79872
    s_nop 0
    buffer_load_dwordx4 v6, s[16:19], s100 offen offset:1024 sc1 lds
    v_pk_mul_f32 v[40:41], v[40:41], v[10:11] op_sel_hi:[1,0]
    v_pk_mul_f32 v[42:43], v[42:43], v[10:11] op_sel_hi:[1,0]
    v_pk_mul_f32 v[44:45], v[44:45], v[10:11] op_sel_hi:[1,0]
    v_pk_mul_f32 v[46:47], v[46:47], v[10:11] op_sel_hi:[1,0]
    v_pk_mul_f32 v[48:49], v[48:49], v[10:11] op_sel_hi:[1,0]
    v_pk_mul_f32 v[50:51], v[50:51], v[10:11] op_sel_hi:[1,0]
    v_pk_mul_f32 v[52:53], v[52:53], v[10:11] op_sel_hi:[1,0]
    v_pk_mul_f32 v[54:55], v[54:55], v[10:11] op_sel_hi:[1,0]
    v_cvt_pk_bf16_f32 v136, v16, v17
    v_cvt_pk_bf16_f32 v137, v18, v19
    v_cvt_pk_bf16_f32 v138, v20, v21
    v_cvt_pk_bf16_f32 v139, v22, v23
    v_cvt_pk_bf16_f32 v140, v24, v25
    v_cvt_pk_bf16_f32 v141, v26, v27
    s_add_u32 m0, s88, 79872
    s_nop 0
    buffer_load_dwordx4 v6, s[16:19], s100 offen offset:2048 sc1 lds
    v_cvt_pk_bf16_f32 v142, v28, v29
    v_cvt_pk_bf16_f32 v143, v30, v31
    v_cvt_pk_bf16_f32 v144, v32, v33
    v_cvt_pk_bf16_f32 v145, v34, v35
    v_cvt_pk_bf16_f32 v146, v36, v37
    v_cvt_pk_bf16_f32 v147, v38, v39
    v_cvt_pk_bf16_f32 v148, v40, v41
    v_cvt_pk_bf16_f32 v149, v42, v43
    v_cvt_pk_bf16_f32 v150, v44, v45
    v_cvt_pk_bf16_f32 v151, v46, v47
    v_cvt_pk_bf16_f32 v152, v48, v49
    v_cvt_pk_bf16_f32 v153, v50, v51
    v_cvt_pk_bf16_f32 v154, v52, v53
    v_cvt_pk_bf16_f32 v155, v54, v55
    s_add_u32 m0, s88, 79872
    s_nop 0
    buffer_load_dwordx4 v6, s[16:19], s100 offen offset:3072 sc1 lds
    s_add_u32 m0, s88, 83968
    s_nop 0
    buffer_load_dwordx4 v240, s[16:19], s100 offen offset:0 sc1 lds
    s_add_u32 s100, s97, 296960
    s_add_u32 m0, s88, 84992
    s_nop 0
    buffer_load_dwordx4 v6, s[16:19], s100 offen offset:0 sc1 lds
    s_add_u32 m0, s88, 84992
    s_nop 0
    buffer_load_dwordx4 v6, s[16:19], s100 offen offset:1024 sc1 lds
    s_add_u32 m0, s88, 84992
    s_nop 0
    buffer_load_dwordx4 v6, s[16:19], s100 offen offset:2048 sc1 lds
    s_add_u32 m0, s88, 84992
    s_nop 0
    buffer_load_dwordx4 v6, s[16:19], s100 offen offset:3072 sc1 lds
    s_add_u32 m0, s88, 89088
    s_nop 0
    buffer_load_dwordx4 v240, s[16:19], s100 offen offset:0 sc1 lds
    s_add_u32 s100, s97, 317440
    s_add_u32 m0, s88, 90112
    s_nop 0
    buffer_load_dwordx4 v6, s[16:19], s100 offen offset:0 sc1 lds
    s_add_u32 m0, s88, 90112
    s_nop 0
    buffer_load_dwordx4 v6, s[16:19], s100 offen offset:1024 sc1 lds
    s_waitcnt vmcnt(11)
    v_cmp_ne_u64 vcc, s[58:59], v[252:253]
    s_nop 3
    s_cbranch_vccnz L_slow_30
L_back_31:
    s_add_u32 s101, s96, 0
    buffer_load_dwordx4 v[204:207], v236, s[16:19], s101 offen sc1
    s_add_u32 s55, s96, 16384
    buffer_load_dwordx4 v[208:211], v236, s[16:19], s55 offen sc1
    buffer_load_dwordx4 v[212:215], v237, s[16:19], s101 offen sc1
    buffer_load_dwordx4 v[216:219], v237, s[16:19], s55 offen sc1
    buffer_load_dwordx4 v[220:223], v238, s[16:19], s101 offen sc1
    buffer_load_dwordx4 v[168:171], v238, s[16:19], s55 offen sc1
    v_lshlrev_b32 v96, 16, v224
    v_and_b32 v97, 0xffff0000, v224
    v_lshlrev_b32 v98, 16, v225
    v_and_b32 v99, 0xffff0000, v225
    v_lshlrev_b32 v100, 16, v226
    v_and_b32 v101, 0xffff0000, v226
    v_lshlrev_b32 v102, 16, v227
    v_and_b32 v103, 0xffff0000, v227
    v_lshlrev_b32 v104, 16, v228
    v_and_b32 v105, 0xffff0000, v228
    v_lshlrev_b32 v106, 16, v229
    v_and_b32 v107, 0xffff0000, v229
    v_lshlrev_b32 v108, 16, v230
    v_and_b32 v109, 0xffff0000, v230
    v_lshlrev_b32 v110, 16, v231
    v_and_b32 v111, 0xffff0000, v231
    v_lshlrev_b32 v112, 16, v232
    v_and_b32 v113, 0xffff0000, v232
    v_lshlrev_b32 v114, 16, v233
    v_and_b32 v115, 0xffff0000, v233
    s_add_u32 s74, s88, 73728
    v_add_u32 v234, s74, v6
    s_waitcnt vmcnt(5)
    v_mfma_f32_16x16x32_bf16 v[16:19], a[0:3], v[204:207], v[96:99]
    s_waitcnt vmcnt(4)
    v_mfma_f32_16x16x32_bf16 v[16:19], a[20:23], v[208:211], v[16:19]
    v_mfma_f32_16x16x32_bf16 v[20:23], a[4:7], v[204:207], v[100:103]
    buffer_load_dwordx4 v[172:175], v239, s[16:19], s101 offen sc1
    v_mfma_f32_16x16x32_bf16 v[20:23], a[24:27], v[208:211], v[20:23]
    v_mfma_f32_16x16x32_bf16 v[24:27], a[8:11], v[204:207], v[104:107]
    v_mfma_f32_16x16x32_bf16 v[24:27], a[28:31], v[208:211], v[24:27]
    v_mfma_f32_16x16x32_bf16 v[28:31], a[12:15], v[204:207], v[108:111]
    buffer_load_dwordx4 v[176:179], v239, s[16:19], s55 offen sc1
    v_mfma_f32_16x16x32_bf16 v[28:31], a[32:35], v[208:211], v[28:31]
    v_mfma_f32_16x16x32_bf16 v[32:35], a[16:19], v[204:207], v[112:115]
    v_mfma_f32_16x16x32_bf16 v[32:35], a[36:39], v[208:211], v[32:35]
    s_waitcnt vmcnt(5)
    v_mfma_f32_16x16x32_bf16 v[36:39], a[0:3], v[212:215], v[96:99]
    s_add_u32 s101, s96, 32768
    buffer_load_dwordx4 v[180:183], v236, s[16:19], s101 offen sc1
    s_waitcnt vmcnt(5)
    v_mfma_f32_16x16x32_bf16 v[36:39], a[20:23], v[216:219], v[36:39]
    v_mfma_f32_16x16x32_bf16 v[40:43], a[4:7], v[212:215], v[100:103]
    v_mfma_f32_16x16x32_bf16 v[40:43], a[24:27], v[216:219], v[40:43]
    v_mfma_f32_16x16x32_bf16 v[44:47], a[8:11], v[212:215], v[104:107]
    s_add_u32 s55, s96, 49152
    buffer_load_dwordx4 v[184:187], v236, s[16:19], s55 offen sc1
    v_mfma_f32_16x16x32_bf16 v[44:47], a[28:31], v[216:219], v[44:47]
    v_mfma_f32_16x16x32_bf16 v[48:51], a[12:15], v[212:215], v[108:111]
    v_mfma_f32_16x16x32_bf16 v[48:51], a[32:35], v[216:219], v[48:51]
    v_mfma_f32_16x16x32_bf16 v[52:55], a[16:19], v[212:215], v[112:115]
    buffer_load_dwordx4 v[188:191], v237, s[16:19], s101 offen sc1
    v_mfma_f32_16x16x32_bf16 v[52:55], a[36:39], v[216:219], v[52:55]
    s_waitcnt vmcnt(6)
    v_mfma_f32_16x16x32_bf16 v[56:59], a[0:3], v[220:223], v[96:99]
    s_waitcnt vmcnt(5)
    v_mfma_f32_16x16x32_bf16 v[56:59], a[20:23], v[168:171], v[56:59]
    v_mfma_f32_16x16x32_bf16 v[60:63], a[4:7], v[220:223], v[100:103]
    buffer_load_dwordx4 v[192:195], v237, s[16:19], s55 offen sc1
    v_mfma_f32_16x16x32_bf16 v[60:63], a[24:27], v[168:171], v[60:63]
    v_mfma_f32_16x16x32_bf16 v[64:67], a[8:11], v[220:223], v[104:107]
    v_mfma_f32_16x16x32_bf16 v[64:67], a[28:31], v[168:171], v[64:67]
    v_mfma_f32_16x16x32_bf16 v[68:71], a[12:15], v[220:223], v[108:111]
    buffer_load_dwordx4 v[196:199], v238, s[16:19], s101 offen sc1
    v_mfma_f32_16x16x32_bf16 v[68:71], a[32:35], v[168:171], v[68:71]
    v_mfma_f32_16x16x32_bf16 v[72:75], a[16:19], v[220:223], v[112:115]
    v_mfma_f32_16x16x32_bf16 v[72:75], a[36:39], v[168:171], v[72:75]
    s_waitcnt vmcnt(6)
    v_mfma_f32_16x16x32_bf16 v[76:79], a[0:3], v[172:175], v[96:99]
    s_mul_i32 s89, s61, 15360
    s_mul_i32 s90, s3, 3840
    s_add_u32 s89, s89, s90
    s_add_u32 s89, s89, 2359296
    v_lshlrev_b32 v13, 4, v1
    buffer_load_dwordx4 v[204:207], v6, s[16:19], s89 offen offset:0 sc1
    buffer_load_dwordx4 v[208:211], v6, s[16:19], s89 offen offset:1024 sc1
    buffer_load_dwordx4 v[212:215], v6, s[16:19], s89 offen offset:2048 sc1
    buffer_load_dwordx4 v[216:219], v6, s[16:19], s89 offen offset:2816 sc1
    buffer_load_dwordx4 v[248:251], v13, s[16:19], s43 offen offset:0 sc1
    buffer_load_dwordx4 v[252:255], v13, s[16:19], s43 offen offset:256 sc1
    s_waitcnt vmcnt(11)
    v_mfma_f32_16x16x32_bf16 v[76:79], a[20:23], v[176:179], v[76:79]
    v_mfma_f32_16x16x32_bf16 v[80:83], a[4:7], v[172:175], v[100:103]
    v_mfma_f32_16x16x32_bf16 v[80:83], a[24:27], v[176:179], v[80:83]
    v_mfma_f32_16x16x32_bf16 v[84:87], a[8:11], v[172:175], v[104:107]
    v_mfma_f32_16x16x32_bf16 v[84:87], a[28:31], v[176:179], v[84:87]
    v_mfma_f32_16x16x32_bf16 v[88:91], a[12:15], v[172:175], v[108:111]
    v_mfma_f32_16x16x32_bf16 v[88:91], a[32:35], v[176:179], v[88:91]
    v_mfma_f32_16x16x32_bf16 v[92:95], a[16:19], v[172:175], v[112:115]
    v_mfma_f32_16x16x32_bf16 v[92:95], a[36:39], v[176:179], v[92:95]
    buffer_load_dwordx4 v[200:203], v238, s[16:19], s55 offen sc1
    s_waitcnt vmcnt(11)
    v_mfma_f32_16x16x32_bf16 v[16:19], a[40:43], v[180:183], v[16:19]
    s_waitcnt vmcnt(10)
    v_mfma_f32_16x16x32_bf16 v[16:19], a[60:63], v[184:187], v[16:19]
    v_mfma_f32_16x16x32_bf16 v[20:23], a[44:47], v[180:183], v[20:23]
    v_mfma_f32_16x16x32_bf16 v[20:23], a[64:67], v[184:187], v[20:23]
    buffer_load_dwordx4 v[156:159], v239, s[16:19], s101 offen sc1
    v_mfma_f32_16x16x32_bf16 v[24:27], a[48:51], v[180:183], v[24:27]
    v_mfma_f32_16x16x32_bf16 v[24:27], a[68:71], v[184:187], v[24:27]
    v_mfma_f32_16x16x32_bf16 v[28:31], a[52:55], v[180:183], v[28:31]
    v_mfma_f32_16x16x32_bf16 v[28:31], a[72:75], v[184:187], v[28:31]
    buffer_load_dwordx4 v[160:163], v239, s[16:19], s55 offen sc1
    v_mfma_f32_16x16x32_bf16 v[32:35], a[56:59], v[180:183], v[32:35]
    v_mfma_f32_16x16x32_bf16 v[32:35], a[76:79], v[184:187], v[32:35]
    s_waitcnt vmcnt(11)
    v_mfma_f32_16x16x32_bf16 v[36:39], a[40:43], v[188:191], v[36:39]
    s_waitcnt vmcnt(10)
    v_mfma_f32_16x16x32_bf16 v[36:39], a[60:63], v[192:195], v[36:39]
    s_add_u32 s101, s96, 65536
    buffer_load_dwordx4 v[224:227], v236, s[16:19], s101 offen sc1
    v_mfma_f32_16x16x32_bf16 v[40:43], a[44:47], v[188:191], v[40:43]
    v_mfma_f32_16x16x32_bf16 v[40:43], a[64:67], v[192:195], v[40:43]
    v_mfma_f32_16x16x32_bf16 v[44:47], a[48:51], v[188:191], v[44:47]
    v_mfma_f32_16x16x32_bf16 v[44:47], a[68:71], v[192:195], v[44:47]
    s_add_u32 s55, s96, 81920
    buffer_load_dwordx4 v[228:231], v236, s[16:19], s55 offen sc1
    v_mfma_f32_16x16x32_bf16 v[48:51], a[52:55], v[188:191], v[48:51]
    v_mfma_f32_16x16x32_bf16 v[48:51], a[72:75], v[192:195], v[48:51]
    v_mfma_f32_16x16x32_bf16 v[52:55], a[56:59], v[188:191], v[52:55]
    s_lshr_b32 s90, s90, 1
    s_add_u32 s90, s90, 65536
    v_lshl_add_u32 v9, v0, 3, s90
    s_waitcnt vmcnt(5)
    v_xor_b32 v8, s58, v204
    v_bitop3_b32 v8, v205, s58, v8 bitop3:0xbe
    v_bitop3_b32 v8, v206, s58, v8 bitop3:0xbe
    v_bitop3_b32 v8, v207, s58, v8 bitop3:0xbe
    v_bitop3_b32 v8, v208, s58, v8 bitop3:0xbe
    v_bitop3_b32 v8, v209, s58, v8 bitop3:0xbe
    v_bitop3_b32 v8, v210, s58, v8 bitop3:0xbe
    v_bitop3_b32 v8, v211, s58, v8 bitop3:0xbe
    v_bitop3_b32 v8, v212, s58, v8 bitop3:0xbe
    v_bitop3_b32 v8, v213, s58, v8 bitop3:0xbe
    v_bitop3_b32 v8, v214, s58, v8 bitop3:0xbe
    v_bitop3_b32 v8, v215, s58, v8 bitop3:0xbe
    v_bitop3_b32 v8, v216, s58, v8 bitop3:0xbe
    v_bitop3_b32 v8, v217, s58, v8 bitop3:0xbe
    v_bitop3_b32 v8, v218, s58, v8 bitop3:0xbe
    v_bitop3_b32 v8, v219, s58, v8 bitop3:0xbe
    v_bitop3_b32 v8, v248, s58, v8 bitop3:0xbe
    v_bitop3_b32 v8, v249, s58, v8 bitop3:0xbe
    v_bitop3_b32 v8, v250, s58, v8 bitop3:0xbe
    v_bitop3_b32 v8, v251, s58, v8 bitop3:0xbe
    v_bitop3_b32 v8, v252, s58, v8 bitop3:0xbe
    v_bitop3_b32 v8, v253, s58, v8 bitop3:0xbe
    v_bitop3_b32 v8, v254, s58, v8 bitop3:0xbe
    v_bitop3_b32 v8, v255, s58, v8 bitop3:0xbe
    v_and_b32 v8, 1023, v8
    v_cmp_ne_u32 vcc, 0, v8
    s_nop 3
    s_cbranch_vccnz L_slow_32
L_back_33:
    v_mfma_f32_16x16x32_bf16 v[52:55], a[76:79], v[192:195], v[52:55]
    buffer_load_dwordx4 v[220:223], v237, s[16:19], s101 offen sc1
    v_and_b32 v204, 0xfffffc00, v204
    v_mfma_f32_16x16x32_bf16 v[56:59], a[40:43], v[196:199], v[56:59]
    buffer_load_dwordx4 a[0:3], v237, s[16:19], s55 offen sc1
    v_and_b32 v205, 0xfffffc00, v205
    v_and_b32 v206, 0xfffffc00, v206
    s_waitcnt vmcnt(6)
    v_mfma_f32_16x16x32_bf16 v[56:59], a[60:63], v[200:203], v[56:59]
    v_and_b32 v207, 0xfffffc00, v207
    v_and_b32 v208, 0xfffffc00, v208
    v_mfma_f32_16x16x32_bf16 v[60:63], a[44:47], v[196:199], v[60:63]
    v_and_b32 v209, 0xfffffc00, v209
    v_and_b32 v210, 0xfffffc00, v210
    v_mfma_f32_16x16x32_bf16 v[60:63], a[64:67], v[200:203], v[60:63]
    buffer_load_dwordx4 a[20:23], v238, s[16:19], s101 offen sc1
    v_and_b32 v211, 0xfffffc00, v211
    v_and_b32 v212, 0xfffffc00, v212
    v_mfma_f32_16x16x32_bf16 v[64:67], a[48:51], v[196:199], v[64:67]
    v_and_b32 v213, 0xfffffc00, v213
    v_and_b32 v214, 0xfffffc00, v214
    v_mfma_f32_16x16x32_bf16 v[64:67], a[68:71], v[200:203], v[64:67]
    v_and_b32 v215, 0xfffffc00, v215
    v_and_b32 v216, 0xfffffc00, v216
    v_mfma_f32_16x16x32_bf16 v[68:71], a[52:55], v[196:199], v[68:71]
    v_and_b32 v217, 0xfffffc00, v217
    v_and_b32 v218, 0xfffffc00, v218
    v_mfma_f32_16x16x32_bf16 v[68:71], a[72:75], v[200:203], v[68:71]
    buffer_load_dwordx4 a[4:7], v238, s[16:19], s55 offen sc1
    v_and_b32 v219, 0xfffffc00, v219
    v_and_b32 v248, 0xfffffc00, v248
    v_mfma_f32_16x16x32_bf16 v[72:75], a[56:59], v[196:199], v[72:75]
    v_and_b32 v252, 0xfffffc00, v252
    v_mov_b32 v250, v248
    v_mfma_f32_16x16x32_bf16 v[72:75], a[76:79], v[200:203], v[72:75]
    v_mov_b32 v251, v252
    v_cvt_pk_bf16_f32 v204, v204, v205
    s_waitcnt vmcnt(7)
    v_mfma_f32_16x16x32_bf16 v[76:79], a[40:43], v[156:159], v[76:79]
    buffer_load_dwordx4 a[24:27], v239, s[16:19], s101 offen sc1
    v_cvt_pk_bf16_f32 v205, v206, v207
    s_waitcnt vmcnt(7)
    v_mfma_f32_16x16x32_bf16 v[76:79], a[60:63], v[160:163], v[76:79]
    ds_write_b64 v9, v[204:205] offset:0
    v_cvt_pk_bf16_f32 v208, v208, v209
    v_cvt_pk_bf16_f32 v209, v210, v211
    v_mfma_f32_16x16x32_bf16 v[80:83], a[44:47], v[156:159], v[80:83]
    ds_write_b64 v9, v[208:209] offset:512
    v_cvt_pk_bf16_f32 v212, v212, v213
    v_mfma_f32_16x16x32_bf16 v[80:83], a[64:67], v[160:163], v[80:83]
    v_cvt_pk_bf16_f32 v213, v214, v215
    ds_write_b64 v9, v[212:213] offset:1024
    v_mfma_f32_16x16x32_bf16 v[84:87], a[48:51], v[156:159], v[84:87]
    buffer_load_dwordx4 a[8:11], v239, s[16:19], s55 offen sc1
    v_cvt_pk_bf16_f32 v216, v216, v217
    v_cvt_pk_bf16_f32 v217, v218, v219
    v_mfma_f32_16x16x32_bf16 v[84:87], a[68:71], v[160:163], v[84:87]
    ds_write_b64 v9, v[216:217] offset:1408
    v_lshlrev_b32 v13, 6, v2
    v_mfma_f32_16x16x32_bf16 v[88:91], a[52:55], v[156:159], v[88:91]
    v_lshl_add_u32 v13, v4, 4, v13
    v_add_u32 v13, 65536, v13
    v_mfma_f32_16x16x32_bf16 v[88:91], a[72:75], v[160:163], v[88:91]
    v_mfma_f32_16x16x32_bf16 v[92:95], a[56:59], v[156:159], v[92:95]
    s_add_u32 s101, s96, 98304
    buffer_load_dwordx4 a[28:31], v236, s[16:19], s101 offen sc1
    v_mfma_f32_16x16x32_bf16 v[92:95], a[76:79], v[160:163], v[92:95]
    s_waitcnt lgkmcnt(0)
    s_barrier
    ds_read_b128 a[12:15], v13 offset:0
    ds_read_b128 a[32:35], v13 offset:1280
    s_waitcnt lgkmcnt(1)
    v_mfma_f32_4x4x4_16b_bf16 v[156:159], a[12:13], v[116:117], 0
    ds_read_b128 a[16:19], v13 offset:2560
    ds_read_b128 a[36:39], v13 offset:3840
    v_mfma_f32_4x4x4_16b_bf16 v[180:183], a[12:13], v[136:137], 0
    ds_read_b128 a[40:43], v13 offset:5120
    s_waitcnt lgkmcnt(3)
    v_mfma_f32_4x4x4_16b_bf16 v[160:163], a[32:33], v[116:117], 0
    ds_read_b128 a[60:63], v13 offset:6400
    v_mfma_f32_4x4x4_16b_bf16 v[184:187], a[32:33], v[136:137], 0
    v_mfma_f32_4x4x4_16b_bf16 v[156:159], a[14:15], v[118:119], v[156:159]
    ds_read_b128 a[44:47], v13 offset:256
    v_mfma_f32_4x4x4_16b_bf16 v[180:183], a[14:15], v[138:139], v[180:183]
    s_add_u32 s55, s96, 114688
    buffer_load_dwordx4 v[96:99], v236, s[16:19], s55 offen sc1
    v_mfma_f32_4x4x4_16b_bf16 v[160:163], a[34:35], v[118:119], v[160:163]
    ds_read_b128 a[64:67], v13 offset:1536
    v_mfma_f32_4x4x4_16b_bf16 v[184:187], a[34:35], v[138:139], v[184:187]
    s_waitcnt lgkmcnt(5)
    v_mfma_f32_4x4x4_16b_bf16 v[164:167], a[16:17], v[116:117], 0
    v_mfma_f32_4x4x4_16b_bf16 v[188:191], a[16:17], v[136:137], 0
    s_waitcnt lgkmcnt(4)
    v_mfma_f32_4x4x4_16b_bf16 v[168:171], a[36:37], v[116:117], 0
    buffer_load_dwordx4 v[100:103], v237, s[16:19], s101 offen sc1
    v_mfma_f32_4x4x4_16b_bf16 v[192:195], a[36:37], v[136:137], 0
    v_mfma_f32_4x4x4_16b_bf16 v[164:167], a[18:19], v[118:119], v[164:167]
    ds_read_b128 a[12:15], v13 offset:2816
    v_mfma_f32_4x4x4_16b_bf16 v[188:191], a[18:19], v[138:139], v[188:191]
    v_mfma_f32_4x4x4_16b_bf16 v[168:171], a[38:39], v[118:119], v[168:171]
    ds_read_b128 a[32:35], v13 offset:4096
    v_mfma_f32_4x4x4_16b_bf16 v[192:195], a[38:39], v[138:139], v[192:195]
    s_waitcnt lgkmcnt(5)
    v_mfma_f32_4x4x4_16b_bf16 v[172:175], a[40:41], v[116:117], 0
    buffer_load_dwordx4 v[104:107], v237, s[16:19], s55 offen sc1
    v_mfma_f32_4x4x4_16b_bf16 v[196:199], a[40:41], v[136:137], 0
    s_waitcnt lgkmcnt(4)
    v_mfma_f32_4x4x4_16b_bf16 v[176:179], a[60:61], v[116:117], 0
    v_mfma_f32_4x4x4_16b_bf16 v[200:203], a[60:61], v[136:137], 0
    v_mfma_f32_4x4x4_16b_bf16 v[172:175], a[42:43], v[118:119], v[172:175]
    ds_read_b128 a[16:19], v13 offset:5376
    v_mfma_f32_4x4x4_16b_bf16 v[196:199], a[42:43], v[138:139], v[196:199]
    v_mfma_f32_4x4x4_16b_bf16 v[176:179], a[62:63], v[118:119], v[176:179]
    buffer_load_dwordx4 v[108:111], v238, s[16:19], s101 offen sc1
    v_mfma_f32_4x4x4_16b_bf16 v[200:203], a[62:63], v[138:139], v[200:203]
    ds_read_b128 a[36:39], v13 offset:6656
    s_waitcnt lgkmcnt(5)
    v_mfma_f32_4x4x4_16b_bf16 v[156:159], a[44:45], v[120:121], v[156:159]
    v_mfma_f32_4x4x4_16b_bf16 v[180:183], a[44:45], v[140:141], v[180:183]
    s_waitcnt lgkmcnt(4)
    v_mfma_f32_4x4x4_16b_bf16 v[160:163], a[64:65], v[120:121], v[160:163]
    v_mfma_f32_4x4x4_16b_bf16 v[184:187], a[64:65], v[140:141], v[184:187]
    v_mfma_f32_4x4x4_16b_bf16 v[156:159], a[46:47], v[122:123], v[156:159]
    buffer_load_dwordx4 v[112:115], v238, s[16:19], s55 offen sc1
    v_mfma_f32_4x4x4_16b_bf16 v[180:183], a[46:47], v[142:143], v[180:183]
    ds_read_b128 a[40:43], v13 offset:512
    v_mfma_f32_4x4x4_16b_bf16 v[160:163], a[66:67], v[122:123], v[160:163]
    ds_read_b128 a[60:63], v13 offset:1792
    v_mfma_f32_4x4x4_16b_bf16 v[184:187], a[66:67], v[142:143], v[184:187]
    s_waitcnt lgkmcnt(5)
    v_mfma_f32_4x4x4_16b_bf16 v[164:167], a[12:13], v[120:121], v[164:167]
    v_mfma_f32_4x4x4_16b_bf16 v[188:191], a[12:13], v[140:141], v[188:191]
    s_waitcnt lgkmcnt(4)
    v_mfma_f32_4x4x4_16b_bf16 v[168:171], a[32:33], v[120:121], v[168:171]
    buffer_load_dwordx4 a[48:51], v239, s[16:19], s101 offen sc1
    v_mfma_f32_4x4x4_16b_bf16 v[192:195], a[32:33], v[140:141], v[192:195]
    v_mfma_f32_4x4x4_16b_bf16 v[164:167], a[14:15], v[122:123], v[164:167]
    ds_read_b128 a[44:47], v13 offset:3072
    v_mfma_f32_4x4x4_16b_bf16 v[188:191], a[14:15], v[142:143], v[188:191]
    v_mfma_f32_4x4x4_16b_bf16 v[168:171], a[34:35], v[122:123], v[168:171]
    ds_read_b128 a[64:67], v13 offset:4352
    v_mfma_f32_4x4x4_16b_bf16 v[192:195], a[34:35], v[142:143], v[192:195]
    s_waitcnt lgkmcnt(5)
    v_mfma_f32_4x4x4_16b_bf16 v[172:175], a[16:17], v[120:121], v[172:175]
    buffer_load_dwordx4 a[68:71], v239, s[16:19], s55 offen sc1
    v_mfma_f32_4x4x4_16b_bf16 v[196:199], a[16:17], v[140:141], v[196:199]
    s_waitcnt lgkmcnt(4)
    v_mfma_f32_4x4x4_16b_bf16 v[176:179], a[36:37], v[120:121], v[176:179]
    v_mfma_f32_4x4x4_16b_bf16 v[200:203], a[36:37], v[140:141], v[200:203]
    v_mfma_f32_4x4x4_16b_bf16 v[172:175], a[18:19], v[122:123], v[172:175]
    ds_read_b128 a[12:15], v13 offset:5632
    v_mfma_f32_4x4x4_16b_bf16 v[196:199], a[18:19], v[142:143], v[196:199]
    v_mfma_f32_4x4x4_16b_bf16 v[176:179], a[38:39], v[122:123], v[176:179]
    s_add_u32 s101, s96, 131072
    buffer_load_dwordx4 a[52:55], v236, s[16:19], s101 offen sc1
    v_mfma_f32_4x4x4_16b_bf16 v[200:203], a[38:39], v[142:143], v[200:203]
    ds_read_b128 a[32:35], v13 offset:6912
    s_waitcnt lgkmcnt(5)
    v_mfma_f32_4x4x4_16b_bf16 v[156:159], a[40:41], v[124:125], v[156:159]
    v_mfma_f32_4x4x4_16b_bf16 v[180:183], a[40:41], v[144:145], v[180:183]
    s_waitcnt lgkmcnt(4)
    v_mfma_f32_4x4x4_16b_bf16 v[160:163], a[60:61], v[124:125], v[160:163]
    v_mfma_f32_4x4x4_16b_bf16 v[184:187], a[60:61], v[144:145], v[184:187]
    v_mfma_f32_4x4x4_16b_bf16 v[156:159], a[42:43], v[126:127], v[156:159]
    ds_read_b128 a[16:19], v13 offset:768
    v_mfma_f32_4x4x4_16b_bf16 v[180:183], a[42:43], v[146:147], v[180:183]
    v_mfma_f32_4x4x4_16b_bf16 v[160:163], a[62:63], v[126:127], v[160:163]
    ds_read_b128 a[36:39], v13 offset:2048
    v_mfma_f32_4x4x4_16b_bf16 v[184:187], a[62:63], v[146:147], v[184:187]
    s_waitcnt lgkmcnt(5)
    v_mfma_f32_4x4x4_16b_bf16 v[164:167], a[44:45], v[124:125], v[164:167]
    v_mfma_f32_4x4x4_16b_bf16 v[188:191], a[44:45], v[144:145], v[188:191]
    s_waitcnt lgkmcnt(4)
    v_mfma_f32_4x4x4_16b_bf16 v[168:171], a[64:65], v[124:125], v[168:171]
    v_mfma_f32_4x4x4_16b_bf16 v[192:195], a[64:65], v[144:145], v[192:195]
    v_mfma_f32_4x4x4_16b_bf16 v[164:167], a[46:47], v[126:127], v[164:167]
    ds_read_b128 a[40:43], v13 offset:3328
    v_mfma_f32_4x4x4_16b_bf16 v[188:191], a[46:47], v[146:147], v[188:191]
    v_mfma_f32_4x4x4_16b_bf16 v[168:171], a[66:67], v[126:127], v[168:171]
    ds_read_b128 a[60:63], v13 offset:4608
    v_mfma_f32_4x4x4_16b_bf16 v[192:195], a[66:67], v[146:147], v[192:195]
    s_waitcnt lgkmcnt(5)
    v_mfma_f32_4x4x4_16b_bf16 v[172:175], a[12:13], v[124:125], v[172:175]
    v_mfma_f32_4x4x4_16b_bf16 v[196:199], a[12:13], v[144:145], v[196:199]
    s_waitcnt lgkmcnt(4)
    v_mfma_f32_4x4x4_16b_bf16 v[176:179], a[32:33], v[124:125], v[176:179]
    v_mfma_f32_4x4x4_16b_bf16 v[200:203], a[32:33], v[144:145], v[200:203]
    v_mfma_f32_4x4x4_16b_bf16 v[172:175], a[14:15], v[126:127], v[172:175]
    ds_read_b128 a[44:47], v13 offset:5888
    v_mfma_f32_4x4x4_16b_bf16 v[196:199], a[14:15], v[146:147], v[196:199]
    v_mfma_f32_4x4x4_16b_bf16 v[176:179], a[34:35], v[126:127], v[176:179]
    ds_read_b128 a[64:67], v13 offset:7168
    v_mfma_f32_4x4x4_16b_bf16 v[200:203], a[34:35], v[146:147], v[200:203]
    s_waitcnt lgkmcnt(5)
    v_mfma_f32_4x4x4_16b_bf16 v[156:159], a[16:17], v[128:129], v[156:159]
    v_mfma_f32_4x4x4_16b_bf16 v[180:183], a[16:17], v[148:149], v[180:183]
    s_waitcnt lgkmcnt(4)
    v_mfma_f32_4x4x4_16b_bf16 v[160:163], a[36:37], v[128:129], v[160:163]
    v_mfma_f32_4x4x4_16b_bf16 v[184:187], a[36:37], v[148:149], v[184:187]
    v_mfma_f32_4x4x4_16b_bf16 v[156:159], a[18:19], v[130:131], v[156:159]
    ds_read_b128 a[12:15], v13 offset:1024
    v_mfma_f32_4x4x4_16b_bf16 v[180:183], a[18:19], v[150:151], v[180:183]
    v_mfma_f32_4x4x4_16b_bf16 v[160:163], a[38:39], v[130:131], v[160:163]
    ds_read_b128 a[32:35], v13 offset:2304
    v_mfma_f32_4x4x4_16b_bf16 v[184:187], a[38:39], v[150:151], v[184:187]
    s_waitcnt lgkmcnt(5)
    v_mfma_f32_4x4x4_16b_bf16 v[164:167], a[40:41], v[128:129], v[164:167]
    v_mfma_f32_4x4x4_16b_bf16 v[188:191], a[40:41], v[148:149], v[188:191]
    s_waitcnt lgkmcnt(4)
    v_mfma_f32_4x4x4_16b_bf16 v[168:171], a[60:61], v[128:129], v[168:171]
    v_mfma_f32_4x4x4_16b_bf16 v[192:195], a[60:61], v[148:149], v[192:195]
    v_mfma_f32_4x4x4_16b_bf16 v[164:167], a[42:43], v[130:131], v[164:167]
    ds_read_b128 a[16:19], v13 offset:3584
    v_mfma_f32_4x4x4_16b_bf16 v[188:191], a[42:43], v[150:151], v[188:191]
    v_mfma_f32_4x4x4_16b_bf16 v[168:171], a[62:63], v[130:131], v[168:171]
    ds_read_b128 a[36:39], v13 offset:4864
    v_mfma_f32_4x4x4_16b_bf16 v[192:195], a[62:63], v[150:151], v[192:195]
    s_waitcnt lgkmcnt(5)
    v_mfma_f32_4x4x4_16b_bf16 v[172:175], a[44:45], v[128:129], v[172:175]
    v_mfma_f32_4x4x4_16b_bf16 v[196:199], a[44:45], v[148:149], v[196:199]
    s_waitcnt lgkmcnt(4)
    v_mfma_f32_4x4x4_16b_bf16 v[176:179], a[64:65], v[128:129], v[176:179]
    v_mfma_f32_4x4x4_16b_bf16 v[200:203], a[64:65], v[148:149], v[200:203]
    v_mfma_f32_4x4x4_16b_bf16 v[172:175], a[46:47], v[130:131], v[172:175]
    ds_read_b128 a[40:43], v13 offset:6144
    v_mfma_f32_4x4x4_16b_bf16 v[196:199], a[46:47], v[150:151], v[196:199]
    v_mfma_f32_4x4x4_16b_bf16 v[176:179], a[66:67], v[130:131], v[176:179]
    ds_read_b128 a[60:63], v13 offset:7424
    v_mfma_f32_4x4x4_16b_bf16 v[200:203], a[66:67], v[150:151], v[200:203]
    s_waitcnt lgkmcnt(5)
    v_mfma_f32_4x4x4_16b_bf16 v[156:159], a[12:13], v[132:133], v[156:159]
    v_mfma_f32_4x4x4_16b_bf16 v[180:183], a[12:13], v[152:153], v[180:183]
    s_waitcnt lgkmcnt(4)
    v_mfma_f32_4x4x4_16b_bf16 v[160:163], a[32:33], v[132:133], v[160:163]
    v_mfma_f32_4x4x4_16b_bf16 v[184:187], a[32:33], v[152:153], v[184:187]
    v_mfma_f32_4x4x4_16b_bf16 v[156:159], a[14:15], v[134:135], v[156:159]
    v_mfma_f32_4x4x4_16b_bf16 v[180:183], a[14:15], v[154:155], v[180:183]
    v_mfma_f32_4x4x4_16b_bf16 v[160:163], a[34:35], v[134:135], v[160:163]
    v_mfma_f32_4x4x4_16b_bf16 v[184:187], a[34:35], v[154:155], v[184:187]
    s_waitcnt lgkmcnt(3)
    v_mfma_f32_4x4x4_16b_bf16 v[164:167], a[16:17], v[132:133], v[164:167]
    v_mfma_f32_4x4x4_16b_bf16 v[188:191], a[16:17], v[152:153], v[188:191]
    s_waitcnt lgkmcnt(2)
    v_mfma_f32_4x4x4_16b_bf16 v[168:171], a[36:37], v[132:133], v[168:171]
    v_mfma_f32_4x4x4_16b_bf16 v[192:195], a[36:37], v[152:153], v[192:195]
    v_mfma_f32_4x4x4_16b_bf16 v[164:167], a[18:19], v[134:135], v[164:167]
    v_mfma_f32_4x4x4_16b_bf16 v[188:191], a[18:19], v[154:155], v[188:191]
    v_mfma_f32_4x4x4_16b_bf16 v[168:171], a[38:39], v[134:135], v[168:171]
    v_mfma_f32_4x4x4_16b_bf16 v[192:195], a[38:39], v[154:155], v[192:195]
    s_waitcnt lgkmcnt(1)
    v_mfma_f32_4x4x4_16b_bf16 v[172:175], a[40:41], v[132:133], v[172:175]
    v_mfma_f32_4x4x4_16b_bf16 v[196:199], a[40:41], v[152:153], v[196:199]
    s_waitcnt lgkmcnt(0)
    v_mfma_f32_4x4x4_16b_bf16 v[176:179], a[60:61], v[132:133], v[176:179]
    v_mfma_f32_4x4x4_16b_bf16 v[200:203], a[60:61], v[152:153], v[200:203]
    v_mfma_f32_4x4x4_16b_bf16 v[172:175], a[42:43], v[134:135], v[172:175]
    v_mfma_f32_4x4x4_16b_bf16 v[196:199], a[42:43], v[154:155], v[196:199]
    v_mfma_f32_4x4x4_16b_bf16 v[176:179], a[62:63], v[134:135], v[176:179]
    v_mfma_f32_4x4x4_16b_bf16 v[200:203], a[62:63], v[154:155], v[200:203]
    s_nop 3
    v_add_f32 v8, 0x358637bd, v176
    v_add_f32 v10, 0x358637bd, v200
    v_rcp_f32 v8, v8
    v_rcp_f32 v10, v10
    v_mul_f32 v8, v8, v250
    v_mul_f32 v10, v10, v251
    v_pk_mul_f32 v[156:157], v[156:157], v[8:9] op_sel_hi:[1,0]
    v_pk_mul_f32 v[158:159], v[158:159], v[8:9] op_sel_hi:[1,0]
    v_pk_mul_f32 v[160:161], v[160:161], v[8:9] op_sel_hi:[1,0]
    v_pk_mul_f32 v[162:163], v[162:163], v[8:9] op_sel_hi:[1,0]
    v_pk_mul_f32 v[164:165], v[164:165], v[8:9] op_sel_hi:[1,0]
    v_pk_mul_f32 v[166:167], v[166:167], v[8:9] op_sel_hi:[1,0]
    v_pk_mul_f32 v[168:169], v[168:169], v[8:9] op_sel_hi:[1,0]
    v_pk_mul_f32 v[170:171], v[170:171], v[8:9] op_sel_hi:[1,0]
    v_pk_mul_f32 v[172:173], v[172:173], v[8:9] op_sel_hi:[1,0]
    v_pk_mul_f32 v[174:175], v[174:175], v[8:9] op_sel_hi:[1,0]
    v_cvt_pk_bf16_f32 v156, v156, v157
    v_cvt_pk_bf16_f32 v157, v158, v159
    v_cvt_pk_bf16_f32 v158, v160, v161
    v_cvt_pk_bf16_f32 v159, v162, v163
    v_cvt_pk_bf16_f32 v160, v164, v165
    v_cvt_pk_bf16_f32 v161, v166, v167
    v_cvt_pk_bf16_f32 v162, v168, v169
    v_cvt_pk_bf16_f32 v163, v170, v171
    v_cvt_pk_bf16_f32 v164, v172, v173
    v_cvt_pk_bf16_f32 v165, v174, v175
    v_min_u32 v156, -2, v156
    v_min_u32 v157, -2, v157
    v_min_u32 v158, -2, v158
    v_min_u32 v159, -2, v159
    v_min_u32 v160, -2, v160
    v_min_u32 v161, -2, v161
    v_min_u32 v162, -2, v162
    v_min_u32 v163, -2, v163
    v_min_u32 v164, -2, v164
    v_min_u32 v165, -2, v165
    buffer_store_dwordx4 v[156:159], v6, s[16:19], s38 offen offset:0 sc1
    buffer_store_dwordx4 v[160:163], v240, s[16:19], s38 offen offset:0 sc1
    buffer_store_dwordx2 v[164:165], v6, s[16:19], s39 offen offset:0 sc1
    v_pk_mul_f32 v[180:181], v[180:181], v[10:11] op_sel_hi:[1,0]
    v_pk_mul_f32 v[182:183], v[182:183], v[10:11] op_sel_hi:[1,0]
    v_pk_mul_f32 v[184:185], v[184:185], v[10:11] op_sel_hi:[1,0]
    v_pk_mul_f32 v[186:187], v[186:187], v[10:11] op_sel_hi:[1,0]
    v_pk_mul_f32 v[188:189], v[188:189], v[10:11] op_sel_hi:[1,0]
    v_pk_mul_f32 v[190:191], v[190:191], v[10:11] op_sel_hi:[1,0]
    v_pk_mul_f32 v[192:193], v[192:193], v[10:11] op_sel_hi:[1,0]
    v_pk_mul_f32 v[194:195], v[194:195], v[10:11] op_sel_hi:[1,0]
    v_pk_mul_f32 v[196:197], v[196:197], v[10:11] op_sel_hi:[1,0]
    v_pk_mul_f32 v[198:199], v[198:199], v[10:11] op_sel_hi:[1,0]
    v_cvt_pk_bf16_f32 v180, v180, v181
    v_cvt_pk_bf16_f32 v181, v182, v183
    v_cvt_pk_bf16_f32 v182, v184, v185
    v_cvt_pk_bf16_f32 v183, v186, v187
    v_cvt_pk_bf16_f32 v184, v188, v189
    v_cvt_pk_bf16_f32 v185, v190, v191
    v_cvt_pk_bf16_f32 v186, v192, v193
    v_cvt_pk_bf16_f32 v187, v194, v195
    v_cvt_pk_bf16_f32 v188, v196, v197
    v_cvt_pk_bf16_f32 v189, v198, v199
    v_min_u32 v180, -2, v180
    v_min_u32 v181, -2, v181
    v_min_u32 v182, -2, v182
    v_min_u32 v183, -2, v183
    v_min_u32 v184, -2, v184
    v_min_u32 v185, -2, v185
    v_min_u32 v186, -2, v186
    v_min_u32 v187, -2, v187
    v_min_u32 v188, -2, v188
    v_min_u32 v189, -2, v189
    buffer_store_dwordx4 v[180:183], v6, s[16:19], s38 offen offset:1024 sc1
    buffer_store_dwordx4 v[184:187], v240, s[16:19], s38 offen offset:1024 sc1
    buffer_store_dwordx2 v[188:189], v6, s[16:19], s39 offen offset:1024 sc1
    s_waitcnt vmcnt(22)
    v_mfma_f32_16x16x32_bf16 v[16:19], a[80:83], v[224:227], v[16:19]
    s_waitcnt vmcnt(21)
    v_mfma_f32_16x16x32_bf16 v[16:19], a[100:103], v[228:231], v[16:19]
    v_mfma_f32_16x16x32_bf16 v[20:23], a[84:87], v[224:227], v[20:23]
    v_mfma_f32_16x16x32_bf16 v[20:23], a[104:107], v[228:231], v[20:23]
    v_mfma_f32_16x16x32_bf16 v[24:27], a[88:91], v[224:227], v[24:27]
    v_mfma_f32_16x16x32_bf16 v[24:27], a[108:111], v[228:231], v[24:27]
    v_mfma_f32_16x16x32_bf16 v[28:31], a[92:95], v[224:227], v[28:31]
    v_mfma_f32_16x16x32_bf16 v[28:31], a[112:115], v[228:231], v[28:31]
    v_mfma_f32_16x16x32_bf16 v[32:35], a[96:99], v[224:227], v[32:35]
    v_mfma_f32_16x16x32_bf16 v[32:35], a[116:119], v[228:231], v[32:35]
    s_mov_b32 s55, s87
    buffer_load_dwordx4 v[164:167], v236, s[16:19], s55 offen sc1
    s_waitcnt vmcnt(21)
    v_mfma_f32_16x16x32_bf16 v[36:39], a[80:83], v[220:223], v[36:39]
    s_waitcnt vmcnt(20)
    v_mfma_f32_16x16x32_bf16 v[36:39], a[100:103], a[0:3], v[36:39]
    v_mfma_f32_16x16x32_bf16 v[40:43], a[84:87], v[220:223], v[40:43]
    v_mfma_f32_16x16x32_bf16 v[40:43], a[104:107], a[0:3], v[40:43]
    buffer_load_dwordx4 v[204:207], v237, s[16:19], s101 offen sc1
    v_mfma_f32_16x16x32_bf16 v[44:47], a[88:91], v[220:223], v[44:47]
    v_mfma_f32_16x16x32_bf16 v[44:47], a[108:111], a[0:3], v[44:47]
    v_mfma_f32_16x16x32_bf16 v[48:51], a[92:95], v[220:223], v[48:51]
    v_mfma_f32_16x16x32_bf16 v[48:51], a[112:115], a[0:3], v[48:51]
    buffer_load_dwordx4 v[208:211], v237, s[16:19], s55 offen sc1
    v_mfma_f32_16x16x32_bf16 v[52:55], a[96:99], v[220:223], v[52:55]
    v_mfma_f32_16x16x32_bf16 v[52:55], a[116:119], a[0:3], v[52:55]
    s_waitcnt vmcnt(21)
    v_mfma_f32_16x16x32_bf16 v[56:59], a[80:83], a[20:23], v[56:59]
    s_waitcnt vmcnt(20)
    v_mfma_f32_16x16x32_bf16 v[56:59], a[100:103], a[4:7], v[56:59]
    buffer_load_dwordx4 v[212:215], v238, s[16:19], s101 offen sc1
    v_mfma_f32_16x16x32_bf16 v[60:63], a[84:87], a[20:23], v[60:63]
    v_mfma_f32_16x16x32_bf16 v[60:63], a[104:107], a[4:7], v[60:63]
    v_mfma_f32_16x16x32_bf16 v[64:67], a[88:91], a[20:23], v[64:67]
    v_mfma_f32_16x16x32_bf16 v[64:67], a[108:111], a[4:7], v[64:67]
    buffer_load_dwordx4 v[216:219], v238, s[16:19], s55 offen sc1
    v_mfma_f32_16x16x32_bf16 v[68:71], a[92:95], a[20:23], v[68:71]
    v_mfma_f32_16x16x32_bf16 v[68:71], a[112:115], a[4:7], v[68:71]
    v_mfma_f32_16x16x32_bf16 v[72:75], a[96:99], a[20:23], v[72:75]
    v_mfma_f32_16x16x32_bf16 v[72:75], a[116:119], a[4:7], v[72:75]
    buffer_load_dwordx4 v[168:171], v239, s[16:19], s101 offen sc1
    s_waitcnt vmcnt(22)
    v_mfma_f32_16x16x32_bf16 v[76:79], a[80:83], a[24:27], v[76:79]
    s_waitcnt vmcnt(21)
    v_mfma_f32_16x16x32_bf16 v[76:79], a[100:103], a[8:11], v[76:79]
    v_mfma_f32_16x16x32_bf16 v[80:83], a[84:87], a[24:27], v[80:83]
    v_mfma_f32_16x16x32_bf16 v[80:83], a[104:107], a[8:11], v[80:83]
    buffer_load_dwordx4 a[12:15], v239, s[16:19], s55 offen sc1
    v_mfma_f32_16x16x32_bf16 v[84:87], a[88:91], a[24:27], v[84:87]
    v_mfma_f32_16x16x32_bf16 v[84:87], a[108:111], a[8:11], v[84:87]
    v_mfma_f32_16x16x32_bf16 v[88:91], a[92:95], a[24:27], v[88:91]
    v_mfma_f32_16x16x32_bf16 v[88:91], a[112:115], a[8:11], v[88:91]
    s_add_u32 s100, s97, 337920
    buffer_load_dwordx4 a[32:35], v6, s[16:19], s100 offen offset:0 sc1
    v_mfma_f32_16x16x32_bf16 v[92:95], a[96:99], a[24:27], v[92:95]
    v_mfma_f32_16x16x32_bf16 v[92:95], a[116:119], a[8:11], v[92:95]
    s_waitcnt vmcnt(22)
    v_mfma_f32_16x16x32_bf16 v[16:19], a[120:123], a[28:31], v[16:19]
    s_waitcnt vmcnt(21)
    v_mfma_f32_16x16x32_bf16 v[16:19], a[140:143], v[96:99], v[16:19]
    s_add_u32 s100, s97, 358400
    buffer_load_dwordx4 v[172:175], v6, s[16:19], s100 offen offset:0 sc1
    v_mfma_f32_16x16x32_bf16 v[20:23], a[124:127], a[28:31], v[20:23]
    v_mfma_f32_16x16x32_bf16 v[20:23], a[144:147], v[96:99], v[20:23]
    v_mfma_f32_16x16x32_bf16 v[24:27], a[128:131], a[28:31], v[24:27]
    v_mfma_f32_16x16x32_bf16 v[24:27], a[148:151], v[96:99], v[24:27]
    s_add_u32 s100, s97, 337920
    buffer_load_dwordx4 a[16:19], v6, s[16:19], s100 offen offset:1024 sc1
    v_mfma_f32_16x16x32_bf16 v[28:31], a[132:135], a[28:31], v[28:31]
    v_mfma_f32_16x16x32_bf16 v[28:31], a[152:155], v[96:99], v[28:31]
    v_mfma_f32_16x16x32_bf16 v[32:35], a[136:139], a[28:31], v[32:35]
    v_mfma_f32_16x16x32_bf16 v[32:35], a[156:159], v[96:99], v[32:35]
    s_add_u32 s100, s97, 358400
    buffer_load_dwordx4 v[176:179], v6, s[16:19], s100 offen offset:1024 sc1
    s_waitcnt vmcnt(23)
    v_mfma_f32_16x16x32_bf16 v[36:39], a[120:123], v[100:103], v[36:39]
    s_waitcnt vmcnt(22)
    v_mfma_f32_16x16x32_bf16 v[36:39], a[140:143], v[104:107], v[36:39]
    v_mfma_f32_16x16x32_bf16 v[40:43], a[124:127], v[100:103], v[40:43]
    v_mfma_f32_16x16x32_bf16 v[40:43], a[144:147], v[104:107], v[40:43]
    s_add_u32 s100, s97, 317440
    buffer_load_dwordx4 a[36:39], v6, s[16:19], s100 offen offset:2048 sc1
    v_mfma_f32_16x16x32_bf16 v[44:47], a[128:131], v[100:103], v[44:47]
    v_mfma_f32_16x16x32_bf16 v[44:47], a[148:151], v[104:107], v[44:47]
    v_mfma_f32_16x16x32_bf16 v[48:51], a[132:135], v[100:103], v[48:51]
    v_mfma_f32_16x16x32_bf16 v[48:51], a[152:155], v[104:107], v[48:51]
    s_add_u32 s100, s97, 337920
    buffer_load_dwordx4 v[180:183], v6, s[16:19], s100 offen offset:2048 sc1
    v_mfma_f32_16x16x32_bf16 v[52:55], a[136:139], v[100:103], v[52:55]
    v_mfma_f32_16x16x32_bf16 v[52:55], a[156:159], v[104:107], v[52:55]
    s_waitcnt vmcnt(23)
    v_mfma_f32_16x16x32_bf16 v[56:59], a[120:123], v[108:111], v[56:59]
    buffer_load_dwordx2 v[252:253], v235, s[16:19], s84 offen sc1
    s_waitcnt vmcnt(23)
    v_mfma_f32_16x16x32_bf16 v[56:59], a[140:143], v[112:115], v[56:59]
    v_mfma_f32_16x16x32_bf16 v[60:63], a[124:127], v[108:111], v[60:63]
    v_mfma_f32_16x16x32_bf16 v[60:63], a[144:147], v[112:115], v[60:63]
    v_mfma_f32_16x16x32_bf16 v[64:67], a[128:131], v[108:111], v[64:67]
    v_mfma_f32_16x16x32_bf16 v[64:67], a[148:151], v[112:115], v[64:67]
    s_add_u32 s100, s97, 358400
    buffer_load_dwordx4 v[184:187], v6, s[16:19], s100 offen offset:2048 sc1
    v_mfma_f32_16x16x32_bf16 v[68:71], a[132:135], v[108:111], v[68:71]
    v_mfma_f32_16x16x32_bf16 v[68:71], a[152:155], v[112:115], v[68:71]
    v_mfma_f32_16x16x32_bf16 v[72:75], a[136:139], v[108:111], v[72:75]
    v_mfma_f32_16x16x32_bf16 v[72:75], a[156:159], v[112:115], v[72:75]
    s_add_u32 s100, s97, 317440
    buffer_load_dwordx4 v[188:191], v6, s[16:19], s100 offen offset:3072 sc1
    s_waitcnt vmcnt(24)
    v_mfma_f32_16x16x32_bf16 v[76:79], a[120:123], a[48:51], v[76:79]
    s_waitcnt vmcnt(23)
    v_mfma_f32_16x16x32_bf16 v[76:79], a[140:143], a[68:71], v[76:79]
    v_mfma_f32_16x16x32_bf16 v[80:83], a[124:127], a[48:51], v[80:83]
    s_add_u32 s100, s97, 337920
    buffer_load_dwordx4 a[40:43], v6, s[16:19], s100 offen offset:3072 sc1
    v_mfma_f32_16x16x32_bf16 v[80:83], a[144:147], a[68:71], v[80:83]
    v_mfma_f32_16x16x32_bf16 v[84:87], a[128:131], a[48:51], v[84:87]
    v_mfma_f32_16x16x32_bf16 v[84:87], a[148:151], a[68:71], v[84:87]
    v_mfma_f32_16x16x32_bf16 v[88:91], a[132:135], a[48:51], v[88:91]
    s_add_u32 s100, s97, 358400
    buffer_load_dwordx4 a[60:63], v6, s[16:19], s100 offen offset:3072 sc1
    v_mfma_f32_16x16x32_bf16 v[88:91], a[152:155], a[68:71], v[88:91]
    v_mfma_f32_16x16x32_bf16 v[92:95], a[136:139], a[48:51], v[92:95]
    v_mfma_f32_16x16x32_bf16 v[92:95], a[156:159], a[68:71], v[92:95]
    s_waitcnt vmcnt(24)
    v_mfma_f32_16x16x32_bf16 v[16:19], a[160:163], a[52:55], v[16:19]
    s_add_u32 s100, s97, 317440
    buffer_load_dwordx4 a[44:47], v240, s[16:19], s100 offen offset:0 sc1
    s_waitcnt vmcnt(18)
    v_mfma_f32_16x16x32_bf16 v[16:19], a[180:183], v[164:167], v[16:19]
    v_mfma_f32_16x16x32_bf16 v[20:23], a[164:167], a[52:55], v[20:23]
    v_mfma_f32_16x16x32_bf16 v[20:23], a[184:187], v[164:167], v[20:23]
    v_mfma_f32_16x16x32_bf16 v[24:27], a[168:171], a[52:55], v[24:27]
    s_add_u32 s100, s97, 337920
    buffer_load_dwordx4 a[64:67], v240, s[16:19], s100 offen offset:0 sc1
    v_mfma_f32_16x16x32_bf16 v[24:27], a[188:191], v[164:167], v[24:27]
    s_waitcnt vmcnt(6)
    v_cmp_ne_u64 vcc, s[58:59], v[252:253]
    s_nop 3
    s_cbranch_vccnz L_slow_34
L_back_35:
    s_lshl_b32 s74, s62, 10
    s_add_u32 s74, s74, 2621440
    v_lshlrev_b32 v7, 4, v1
    v_subrev_u32 v8, v6, v236
    v_lshrrev_b32 v8, 2, v8
    v_add_u32 v8, v8, v7
    buffer_load_dword v241, v8, s[16:19], s74 offen sc1
    v_subrev_u32 v8, v6, v237
    v_lshrrev_b32 v8, 2, v8
    v_add_u32 v8, v8, v7
    buffer_load_dword v242, v8, s[16:19], s74 offen sc1
    v_subrev_u32 v8, v6, v238
    v_lshrrev_b32 v8, 2, v8
    v_add_u32 v8, v8, v7
    buffer_load_dword v243, v8, s[16:19], s74 offen sc1
    v_subrev_u32 v8, v6, v239
    v_lshrrev_b32 v8, 2, v8
    v_add_u32 v8, v8, v7
    buffer_load_dword v244, v8, s[16:19], s74 offen sc1
    s_add_u32 s101, s96, 155648
    buffer_load_dwordx4 a[72:75], v236, s[16:19], s101 offen sc1
    s_add_u32 s55, s96, 172032
    buffer_load_dwordx4 a[56:59], v236, s[16:19], s55 offen sc1
    buffer_load_dwordx4 a[76:79], v237, s[16:19], s101 offen sc1
    buffer_load_dwordx4 a[0:3], v237, s[16:19], s55 offen sc1
    v_mfma_f32_16x16x32_bf16 v[28:31], a[172:175], a[52:55], v[28:31]
    v_mfma_f32_16x16x32_bf16 v[28:31], a[192:195], v[164:167], v[28:31]
    v_mfma_f32_16x16x32_bf16 v[32:35], a[176:179], a[52:55], v[32:35]
    v_mfma_f32_16x16x32_bf16 v[32:35], a[196:199], v[164:167], v[32:35]
    v_mfma_f32_16x16x32_bf16 v[36:39], a[160:163], v[204:207], v[36:39]
    v_mfma_f32_16x16x32_bf16 v[36:39], a[180:183], v[208:211], v[36:39]
    v_mfma_f32_16x16x32_bf16 v[40:43], a[164:167], v[204:207], v[40:43]
    v_mfma_f32_16x16x32_bf16 v[40:43], a[184:187], v[208:211], v[40:43]
    v_mfma_f32_16x16x32_bf16 v[44:47], a[168:171], v[204:207], v[44:47]
    buffer_load_dwordx4 a[20:23], v238, s[16:19], s101 offen sc1
    v_mfma_f32_16x16x32_bf16 v[44:47], a[188:191], v[208:211], v[44:47]
    v_mfma_f32_16x16x32_bf16 v[48:51], a[172:175], v[204:207], v[48:51]
    v_mfma_f32_16x16x32_bf16 v[48:51], a[192:195], v[208:211], v[48:51]
    v_mfma_f32_16x16x32_bf16 v[52:55], a[176:179], v[204:207], v[52:55]
    buffer_load_dwordx4 a[4:7], v238, s[16:19], s55 offen sc1
    v_mfma_f32_16x16x32_bf16 v[52:55], a[196:199], v[208:211], v[52:55]
    v_mfma_f32_16x16x32_bf16 v[56:59], a[160:163], v[212:215], v[56:59]
    v_mfma_f32_16x16x32_bf16 v[56:59], a[180:183], v[216:219], v[56:59]
    v_mfma_f32_16x16x32_bf16 v[60:63], a[164:167], v[212:215], v[60:63]
    buffer_load_dwordx4 a[80:83], v239, s[16:19], s101 offen sc1
    v_mfma_f32_16x16x32_bf16 v[60:63], a[184:187], v[216:219], v[60:63]
    v_mfma_f32_16x16x32_bf16 v[64:67], a[168:171], v[212:215], v[64:67]
    v_mfma_f32_16x16x32_bf16 v[64:67], a[188:191], v[216:219], v[64:67]
    v_mfma_f32_16x16x32_bf16 v[68:71], a[172:175], v[212:215], v[68:71]
    buffer_load_dwordx4 a[100:103], v239, s[16:19], s55 offen sc1
    v_mfma_f32_16x16x32_bf16 v[68:71], a[192:195], v[216:219], v[68:71]
    v_mfma_f32_16x16x32_bf16 v[72:75], a[176:179], v[212:215], v[72:75]
    v_mfma_f32_16x16x32_bf16 v[72:75], a[196:199], v[216:219], v[72:75]
    v_mfma_f32_16x16x32_bf16 v[76:79], a[160:163], v[168:171], v[76:79]
    v_mfma_f32_16x16x32_bf16 v[76:79], a[180:183], a[12:15], v[76:79]
    s_add_u32 s101, s96, 188416
    buffer_load_dwordx4 a[84:87], v237, s[16:19], s101 offen sc1
    v_mfma_f32_16x16x32_bf16 v[80:83], a[164:167], v[168:171], v[80:83]
    v_mfma_f32_16x16x32_bf16 v[80:83], a[184:187], a[12:15], v[80:83]
    v_mfma_f32_16x16x32_bf16 v[84:87], a[168:171], v[168:171], v[84:87]
    s_add_u32 s55, s96, 204800
    buffer_load_dwordx4 a[104:107], v237, s[16:19], s55 offen sc1
    v_mfma_f32_16x16x32_bf16 v[84:87], a[188:191], a[12:15], v[84:87]
    v_mfma_f32_16x16x32_bf16 v[88:91], a[172:175], v[168:171], v[88:91]
    v_mfma_f32_16x16x32_bf16 v[88:91], a[192:195], a[12:15], v[88:91]
    v_mfma_f32_16x16x32_bf16 v[92:95], a[176:179], v[168:171], v[92:95]
    v_mfma_f32_16x16x32_bf16 v[92:95], a[196:199], a[12:15], v[92:95]
    buffer_load_dwordx4 a[88:91], v238, s[16:19], s101 offen sc1
    s_waitcnt vmcnt(10)
    v_mfma_f32_16x16x32_bf16 v[16:19], a[200:203], a[72:75], v[16:19]
    s_waitcnt vmcnt(9)
    v_mfma_f32_16x16x32_bf16 v[16:19], a[220:223], a[56:59], v[16:19]
    v_mfma_f32_16x16x32_bf16 v[20:23], a[204:207], a[72:75], v[20:23]
    buffer_load_dwordx4 a[108:111], v238, s[16:19], s55 offen sc1
    v_mfma_f32_16x16x32_bf16 v[20:23], a[224:227], a[56:59], v[20:23]
    v_mfma_f32_16x16x32_bf16 v[24:27], a[208:211], a[72:75], v[24:27]
    v_mfma_f32_16x16x32_bf16 v[24:27], a[228:231], a[56:59], v[24:27]
    s_add_u32 s74, s3, 1
    s_and_b32 s74, s74, 3
    v_mfma_f32_16x16x32_bf16 v[28:31], a[212:215], a[72:75], v[28:31]
    s_mul_i32 s74, s74, 15360
    s_add_u32 s74, s74, 0
    v_mfma_f32_16x16x32_bf16 v[28:31], a[232:235], a[56:59], v[28:31]
    buffer_load_dwordx4 a[92:95], v239, s[16:19], s101 offen sc1
    v_add_u32 v9, s74, v6
    v_mfma_f32_16x16x32_bf16 v[32:35], a[216:219], a[72:75], v[32:35]
    s_add_u32 s74, s3, 2
    s_and_b32 s74, s74, 3
    v_mfma_f32_16x16x32_bf16 v[32:35], a[236:239], a[56:59], v[32:35]
    s_mul_i32 s74, s74, 15360
    s_add_u32 s74, s74, 5120
    s_waitcnt vmcnt(10)
    v_mfma_f32_16x16x32_bf16 v[36:39], a[200:203], a[76:79], v[36:39]
    v_add_u32 v10, s74, v6
    s_add_u32 s74, s3, 3
    s_waitcnt vmcnt(9)
    v_mfma_f32_16x16x32_bf16 v[36:39], a[220:223], a[0:3], v[36:39]
    buffer_load_dwordx4 a[112:115], v239, s[16:19], s55 offen sc1
    s_and_b32 s74, s74, 3
    v_mfma_f32_16x16x32_bf16 v[40:43], a[204:207], a[76:79], v[40:43]
    s_mul_i32 s74, s74, 15360
    s_add_u32 s74, s74, 10240
    v_mfma_f32_16x16x32_bf16 v[40:43], a[224:227], a[0:3], v[40:43]
    v_add_u32 v11, s74, v6
    s_mul_i32 s74, s3, 15360
    v_mfma_f32_16x16x32_bf16 v[44:47], a[208:211], a[76:79], v[44:47]
    s_add_u32 s74, s74, 0
    v_add_u32 v8, s74, v6
    v_mfma_f32_16x16x32_bf16 v[44:47], a[228:231], a[0:3], v[44:47]
    buffer_load_dwordx4 a[24:27], v236, s[16:19], s101 offen sc1
    s_lshl_b32 s74, s62, 2
    v_mfma_f32_16x16x32_bf16 v[48:51], a[212:215], a[76:79], v[48:51]
    s_add_u32 s74, s74, s3
    s_mul_i32 s74, s74, 20480
    v_mfma_f32_16x16x32_bf16 v[48:51], a[232:235], a[0:3], v[48:51]
    ds_read_b128 a[96:99], v234 offset:1024
    s_add_u32 s77, s74, s82
    v_mfma_f32_16x16x32_bf16 v[52:55], a[216:219], a[76:79], v[52:55]
    s_add_u32 s76, s74, s81
    v_mul_u32_u24 v12, 1280, v1
    v_mfma_f32_16x16x32_bf16 v[52:55], a[236:239], a[0:3], v[52:55]
    ds_read_b128 a[8:11], v234 offset:2048
    v_lshl_add_u32 v13, v2, 3, v12
    s_waitcnt vmcnt(10)
    v_mfma_f32_16x16x32_bf16 v[56:59], a[200:203], a[20:23], v[56:59]
    buffer_load_dwordx4 a[116:119], v236, s[16:19], s55 offen sc1
    v_lshl_add_u32 v12, v2, 4, v12
    s_waitcnt vmcnt(10)
    v_mfma_f32_16x16x32_bf16 v[56:59], a[220:223], a[4:7], v[56:59]
    ds_read_b128 a[28:31], v234 offset:3072
    v_mfma_f32_16x16x32_bf16 v[60:63], a[204:207], a[20:23], v[60:63]
    s_add_u32 s100, s97, 358400
    buffer_load_dwordx4 a[120:123], v240, s[16:19], s100 offen offset:0 sc1
    v_mfma_f32_16x16x32_bf16 v[60:63], a[224:227], a[4:7], v[60:63]
    ds_read_b128 a[140:143], v234 offset:4096
    v_mfma_f32_16x16x32_bf16 v[64:67], a[208:211], a[20:23], v[64:67]
    ds_read_b128 a[124:127], v234 offset:0
    v_mfma_f32_16x16x32_bf16 v[64:67], a[228:231], a[4:7], v[64:67]
    ds_read_b128 a[144:147], v234 offset:5120
    v_mfma_f32_16x16x32_bf16 v[68:71], a[212:215], a[20:23], v[68:71]
    s_add_u32 s101, s96, 221184
    buffer_load_dwordx4 v[192:195], v237, s[16:19], s101 offen sc1
    v_mfma_f32_16x16x32_bf16 v[68:71], a[232:235], a[4:7], v[68:71]
    v_mfma_f32_16x16x32_bf16 v[72:75], a[216:219], a[20:23], v[72:75]
    v_mfma_f32_16x16x32_bf16 v[72:75], a[236:239], a[4:7], v[72:75]
    s_add_u32 s55, s96, 237568
    buffer_load_dwordx4 v[196:199], v237, s[16:19], s55 offen sc1
    s_waitcnt vmcnt(12)
    v_mfma_f32_16x16x32_bf16 v[76:79], a[200:203], a[80:83], v[76:79]
    s_waitcnt vmcnt(11)
    v_mfma_f32_16x16x32_bf16 v[76:79], a[220:223], a[100:103], v[76:79]
    v_and_b32 v241, 0xfffffc00, v241
    v_and_b32 v242, 0xfffffc00, v242
    v_mfma_f32_16x16x32_bf16 v[80:83], a[204:207], a[80:83], v[80:83]
    v_and_b32 v243, 0xfffffc00, v243
    v_and_b32 v244, 0xfffffc00, v244
    v_mfma_f32_16x16x32_bf16 v[80:83], a[224:227], a[100:103], v[80:83]
    v_sub_f32 v241, 1.0, v241
    v_sub_f32 v242, 1.0, v242
    v_mfma_f32_16x16x32_bf16 v[84:87], a[208:211], a[80:83], v[84:87]
    buffer_load_dwordx4 v[200:203], v238, s[16:19], s101 offen sc1
    v_sub_f32 v243, 1.0, v243
    v_mfma_f32_16x16x32_bf16 v[84:87], a[228:231], a[100:103], v[84:87]
    v_sub_f32 v244, 1.0, v244
    v_mfma_f32_16x16x32_bf16 v[88:91], a[212:215], a[80:83], v[88:91]
    v_mfma_f32_16x16x32_bf16 v[88:91], a[232:235], a[100:103], v[88:91]
    buffer_load_dwordx4 v[156:159], v238, s[16:19], s55 offen sc1
    v_mfma_f32_16x16x32_bf16 v[92:95], a[216:219], a[80:83], v[92:95]
    v_mfma_f32_16x16x32_bf16 v[92:95], a[236:239], a[100:103], v[92:95]
    s_waitcnt vmcnt(12)
    v_mfma_f32_16x16x32_bf16 v[36:39], a[240:243], a[84:87], v[36:39]
    s_waitcnt vmcnt(11) lgkmcnt(5)
    v_mfma_f32_16x16x32_bf16 v[36:39], a[96:99], a[104:107], v[36:39]
    v_mfma_f32_16x16x32_bf16 v[40:43], a[244:247], a[84:87], v[40:43]
    buffer_load_dwordx4 v[160:163], v239, s[16:19], s101 offen sc1
    s_waitcnt lgkmcnt(4)
    v_mfma_f32_16x16x32_bf16 v[40:43], a[8:11], a[104:107], v[40:43]
    v_mfma_f32_16x16x32_bf16 v[44:47], a[248:251], a[84:87], v[44:47]
    s_nop 2
    v_mul_f32 v36, v242, v36
    v_mul_f32 v37, v242, v37
    s_waitcnt lgkmcnt(3)
    v_mfma_f32_16x16x32_bf16 v[44:47], a[28:31], a[104:107], v[44:47]
    buffer_load_dwordx4 v[116:119], v239, s[16:19], s55 offen sc1
    v_mul_f32 v38, v242, v38
    v_mfma_f32_16x16x32_bf16 v[48:51], a[252:255], a[84:87], v[48:51]
    v_mul_f32 v39, v242, v39
    v_mul_f32 v40, v242, v40
    s_waitcnt lgkmcnt(2)
    v_mfma_f32_16x16x32_bf16 v[48:51], a[140:143], a[104:107], v[48:51]
    v_mul_f32 v41, v242, v41
    v_mul_f32 v42, v242, v42
    s_waitcnt lgkmcnt(1)
    v_mfma_f32_16x16x32_bf16 v[52:55], a[124:127], a[84:87], v[52:55]
    v_mul_f32 v43, v242, v43
    v_mul_f32 v44, v242, v44
    s_waitcnt lgkmcnt(0)
    v_mfma_f32_16x16x32_bf16 v[52:55], a[144:147], a[104:107], v[52:55]
    buffer_load_dwordx4 v[120:123], v236, s[16:19], s101 offen sc1
    v_mul_f32 v45, v242, v45
    s_waitcnt vmcnt(13)
    v_mfma_f32_16x16x32_bf16 v[56:59], a[240:243], a[88:91], v[56:59]
    v_mul_f32 v46, v242, v46
    v_mul_f32 v47, v242, v47
    s_waitcnt vmcnt(12)
    v_mfma_f32_16x16x32_bf16 v[56:59], a[96:99], a[108:111], v[56:59]
    v_mul_f32 v48, v242, v48
    v_mul_f32 v49, v242, v49
    v_mfma_f32_16x16x32_bf16 v[60:63], a[244:247], a[88:91], v[60:63]
    v_mul_f32 v50, v242, v50
    v_mul_f32 v51, v242, v51
    v_mfma_f32_16x16x32_bf16 v[60:63], a[8:11], a[108:111], v[60:63]
    buffer_load_dwordx4 v[124:127], v236, s[16:19], s55 offen sc1
    v_mul_f32 v52, v242, v52
    v_mfma_f32_16x16x32_bf16 v[64:67], a[248:251], a[88:91], v[64:67]
    v_mul_f32 v53, v242, v53
    v_mul_f32 v54, v242, v54
    v_mfma_f32_16x16x32_bf16 v[64:67], a[28:31], a[108:111], v[64:67]
    v_mul_f32 v55, v242, v55
    v_mul_f32 v56, v243, v56
    v_mfma_f32_16x16x32_bf16 v[68:71], a[252:255], a[88:91], v[68:71]
    ds_read_b128 a[128:131], v234 offset:6144
    v_mul_f32 v57, v243, v57
    v_mfma_f32_16x16x32_bf16 v[68:71], a[140:143], a[108:111], v[68:71]
    ds_read_b128 a[148:151], v234 offset:11264
    v_mul_f32 v58, v243, v58
    v_mfma_f32_16x16x32_bf16 v[72:75], a[124:127], a[88:91], v[72:75]
    ds_read_b128 a[132:135], v234 offset:7168
    v_mul_f32 v59, v243, v59
    v_mfma_f32_16x16x32_bf16 v[72:75], a[144:147], a[108:111], v[72:75]
    ds_read_b128 a[152:155], v234 offset:12288
    v_mul_f32 v60, v243, v60
    s_waitcnt vmcnt(12)
    v_mfma_f32_16x16x32_bf16 v[76:79], a[240:243], a[92:95], v[76:79]
    ds_read_b128 a[48:51], v234 offset:8192
    v_mul_f32 v61, v243, v61
    s_waitcnt vmcnt(11)
    v_mfma_f32_16x16x32_bf16 v[76:79], a[96:99], a[112:115], v[76:79]
    ds_read_b128 a[136:139], v234 offset:13312
    v_mul_f32 v62, v243, v62
    v_mfma_f32_16x16x32_bf16 v[80:83], a[244:247], a[92:95], v[80:83]
    ds_read_b128 a[68:71], v234 offset:9216
    v_mul_f32 v63, v243, v63
    v_mfma_f32_16x16x32_bf16 v[80:83], a[8:11], a[112:115], v[80:83]
    ds_read_b128 a[156:159], v234 offset:14336
    v_mul_f32 v64, v243, v64
    v_mfma_f32_16x16x32_bf16 v[84:87], a[248:251], a[92:95], v[84:87]
    ds_read_b128 a[52:55], v234 offset:10240
    v_mul_f32 v65, v243, v65
    v_mfma_f32_16x16x32_bf16 v[84:87], a[28:31], a[112:115], v[84:87]
    ds_read_b128 a[160:163], v234 offset:15360
    v_mul_f32 v66, v243, v66
    v_mfma_f32_16x16x32_bf16 v[88:91], a[252:255], a[92:95], v[88:91]
    s_add_u32 s101, s96, 253952
    buffer_load_dwordx4 v[128:131], v237, s[16:19], s101 offen sc1
    v_mfma_f32_16x16x32_bf16 v[88:91], a[140:143], a[112:115], v[88:91]
    s_add_u32 s55, s96, 270336
    buffer_load_dwordx4 v[132:135], v237, s[16:19], s55 offen sc1
    v_mfma_f32_16x16x32_bf16 v[92:95], a[124:127], a[92:95], v[92:95]
    v_mul_f32 v67, v243, v67
    v_mul_f32 v68, v243, v68
    v_mfma_f32_16x16x32_bf16 v[92:95], a[144:147], a[112:115], v[92:95]
    v_mul_f32 v69, v243, v69
    v_mul_f32 v70, v243, v70
    s_waitcnt vmcnt(12)
    v_mfma_f32_16x16x32_bf16 v[16:19], a[240:243], a[24:27], v[16:19]
    v_mul_f32 v71, v243, v71
    v_mul_f32 v72, v243, v72
    s_waitcnt vmcnt(11)
    v_mfma_f32_16x16x32_bf16 v[16:19], a[96:99], a[116:119], v[16:19]
    s_add_u32 s101, s96, 286720
    buffer_load_dwordx4 v[136:139], v237, s[16:19], s101 offen sc1
    v_mfma_f32_16x16x32_bf16 v[20:23], a[244:247], a[24:27], v[20:23]
    v_mul_f32 v73, v243, v73
    v_mul_f32 v74, v243, v74
    v_mfma_f32_16x16x32_bf16 v[20:23], a[8:11], a[116:119], v[20:23]
    s_waitcnt vmcnt(9)
    v_max3_u32 v7, v192, v193, v194
    v_mfma_f32_16x16x32_bf16 v[24:27], a[248:251], a[24:27], v[24:27]
    v_max3_u32 v7, v7, v195, v196
    v_max3_u32 v7, v7, v197, v198
    v_mfma_f32_16x16x32_bf16 v[24:27], a[28:31], a[116:119], v[24:27]
    v_max3_u32 v7, v7, v199, v199
    v_cmp_eq_u32 vcc, -1, v7
    v_mfma_f32_16x16x32_bf16 v[28:31], a[252:255], a[24:27], v[28:31]
    s_add_u32 s101, s96, 253952
    buffer_load_dwordx4 v[140:143], v238, s[16:19], s101 offen sc1
    v_mfma_f32_16x16x32_bf16 v[28:31], a[140:143], a[116:119], v[28:31]
    s_cbranch_vccnz L_slow_36
L_back_37:
    v_mfma_f32_16x16x32_bf16 v[32:35], a[124:127], a[24:27], v[32:35]
    v_mul_f32 v75, v243, v75
    v_mul_f32 v76, v244, v76
    v_mfma_f32_16x16x32_bf16 v[32:35], a[144:147], a[116:119], v[32:35]
    buffer_load_dwordx4 v[144:147], v238, s[16:19], s55 offen sc1
    v_mul_f32 v77, v244, v77
    s_waitcnt lgkmcnt(9)
    v_mfma_f32_16x16x32_bf16 v[36:39], a[128:131], v[192:195], v[36:39]
    v_mul_f32 v78, v244, v78
    v_mul_f32 v79, v244, v79
    s_waitcnt lgkmcnt(8)
    v_mfma_f32_16x16x32_bf16 v[36:39], a[148:151], v[196:199], v[36:39]
    v_mul_f32 v80, v244, v80
    v_mul_f32 v81, v244, v81
    s_waitcnt lgkmcnt(7)
    v_mfma_f32_16x16x32_bf16 v[40:43], a[132:135], v[192:195], v[40:43]
    s_add_u32 s101, s96, 286720
    buffer_load_dwordx4 v[148:151], v238, s[16:19], s101 offen sc1
    s_waitcnt lgkmcnt(6)
    v_mfma_f32_16x16x32_bf16 v[40:43], a[152:155], v[196:199], v[40:43]
    s_waitcnt vmcnt(10)
    v_max3_u32 v7, v200, v201, v202
    s_waitcnt lgkmcnt(5)
    v_mfma_f32_16x16x32_bf16 v[44:47], a[48:51], v[192:195], v[44:47]
    v_max3_u32 v7, v7, v203, v156
    v_max3_u32 v7, v7, v157, v158
    s_waitcnt lgkmcnt(4)
    v_mfma_f32_16x16x32_bf16 v[44:47], a[136:139], v[196:199], v[44:47]
    v_max3_u32 v7, v7, v159, v159
    v_cmp_eq_u32 vcc, -1, v7
    s_waitcnt lgkmcnt(3)
    v_mfma_f32_16x16x32_bf16 v[48:51], a[68:71], v[192:195], v[48:51]
    s_add_u32 s101, s96, 253952
    buffer_load_dwordx4 v[152:155], v239, s[16:19], s101 offen sc1
    s_waitcnt lgkmcnt(2)
    v_mfma_f32_16x16x32_bf16 v[48:51], a[156:159], v[196:199], v[48:51]
    s_cbranch_vccnz L_slow_38
L_back_39:
    s_waitcnt lgkmcnt(1)
    v_mfma_f32_16x16x32_bf16 v[52:55], a[52:55], v[192:195], v[52:55]
    v_mul_f32 v82, v244, v82
    v_mul_f32 v83, v244, v83
    s_waitcnt lgkmcnt(0)
    v_mfma_f32_16x16x32_bf16 v[52:55], a[160:163], v[196:199], v[52:55]
    v_mul_f32 v84, v244, v84
    v_mul_f32 v85, v244, v85
    v_mfma_f32_16x16x32_bf16 v[56:59], a[128:131], v[200:203], v[56:59]
    buffer_load_dwordx4 v[224:227], v239, s[16:19], s55 offen sc1
    v_mul_f32 v86, v244, v86
    v_mfma_f32_16x16x32_bf16 v[56:59], a[148:151], v[156:159], v[56:59]
    v_mul_f32 v87, v244, v87
    v_mul_f32 v88, v244, v88
    v_mfma_f32_16x16x32_bf16 v[60:63], a[132:135], v[200:203], v[60:63]
    v_mul_f32 v89, v244, v89
    v_mul_f32 v90, v244, v90
    v_mfma_f32_16x16x32_bf16 v[60:63], a[152:155], v[156:159], v[60:63]
    s_waitcnt vmcnt(10)
    v_max3_u32 v7, v160, v161, v162
    v_mfma_f32_16x16x32_bf16 v[64:67], a[48:51], v[200:203], v[64:67]
    s_add_u32 s101, s96, 286720
    buffer_load_dwordx4 v[228:231], v239, s[16:19], s101 offen sc1
    v_mfma_f32_16x16x32_bf16 v[64:67], a[136:139], v[156:159], v[64:67]
    v_max3_u32 v7, v7, v163, v116
    v_max3_u32 v7, v7, v117, v118
    v_mfma_f32_16x16x32_bf16 v[68:71], a[68:71], v[200:203], v[68:71]
    ds_read_b128 a[180:183], v234 offset:16384
    v_max3_u32 v7, v7, v119, v119
    v_mfma_f32_16x16x32_bf16 v[68:71], a[156:159], v[156:159], v[68:71]
    v_cmp_eq_u32 vcc, -1, v7
    s_nop 3
    s_cbranch_vccnz L_slow_40
L_back_41:
    v_mfma_f32_16x16x32_bf16 v[72:75], a[52:55], v[200:203], v[72:75]
    s_add_u32 s101, s96, 253952
    buffer_load_dwordx4 v[220:223], v236, s[16:19], s101 offen sc1
    v_mfma_f32_16x16x32_bf16 v[72:75], a[160:163], v[156:159], v[72:75]
    ds_read_b128 a[164:167], v234 offset:17408
    v_mul_f32 v91, v244, v91
    v_mfma_f32_16x16x32_bf16 v[76:79], a[128:131], v[160:163], v[76:79]
    v_mul_f32 v92, v244, v92
    v_mul_f32 v93, v244, v93
    v_mfma_f32_16x16x32_bf16 v[76:79], a[148:151], v[116:119], v[76:79]
    v_mul_f32 v94, v244, v94
    v_mul_f32 v95, v244, v95
    v_mfma_f32_16x16x32_bf16 v[80:83], a[132:135], v[160:163], v[80:83]
    buffer_load_dwordx4 v[96:99], v236, s[16:19], s55 offen sc1
    v_mul_f32 v16, v241, v16
    v_mfma_f32_16x16x32_bf16 v[80:83], a[152:155], v[116:119], v[80:83]
    v_mul_f32 v17, v241, v17
    v_mul_f32 v18, v241, v18
    v_mfma_f32_16x16x32_bf16 v[84:87], a[48:51], v[160:163], v[84:87]
    v_mul_f32 v19, v241, v19
    s_waitcnt vmcnt(11)
    v_mfma_f32_16x16x32_bf16 v[84:87], a[136:139], v[116:119], v[84:87]
    v_max3_u32 v7, v120, v121, v122
    v_max3_u32 v7, v7, v123, v124
    v_mfma_f32_16x16x32_bf16 v[88:91], a[68:71], v[160:163], v[88:91]
    s_add_u32 s101, s96, 286720
    buffer_load_dwordx4 v[100:103], v236, s[16:19], s101 offen sc1
    v_mfma_f32_16x16x32_bf16 v[88:91], a[156:159], v[116:119], v[88:91]
    v_max3_u32 v7, v7, v125, v126
    v_max3_u32 v7, v7, v127, v127
    v_mfma_f32_16x16x32_bf16 v[92:95], a[52:55], v[160:163], v[92:95]
    v_cmp_eq_u32 vcc, -1, v7
    s_nop 3
    s_cbranch_vccnz L_slow_42
L_back_43:
    v_mfma_f32_16x16x32_bf16 v[92:95], a[160:163], v[116:119], v[92:95]
    v_mul_f32 v20, v241, v20
    v_mul_f32 v21, v241, v21
    v_mfma_f32_16x16x32_bf16 v[16:19], a[128:131], v[120:123], v[16:19]
    v_mul_f32 v22, v241, v22
    v_mul_f32 v23, v241, v23
    v_mfma_f32_16x16x32_bf16 v[16:19], a[148:151], v[124:127], v[16:19]
    v_mul_f32 v24, v241, v24
    v_mul_f32 v25, v241, v25
    v_mfma_f32_16x16x32_bf16 v[20:23], a[132:135], v[120:123], v[20:23]
    v_mul_f32 v26, v241, v26
    v_mul_f32 v27, v241, v27
    v_mfma_f32_16x16x32_bf16 v[20:23], a[152:155], v[124:127], v[20:23]
    v_mul_f32 v28, v241, v28
    v_mul_f32 v29, v241, v29
    v_mul_f32 v30, v241, v30
    v_mul_f32 v31, v241, v31
    v_mul_f32 v32, v241, v32
    v_mfma_f32_16x16x32_bf16 v[24:27], a[48:51], v[120:123], v[24:27]
    v_mul_f32 v33, v241, v33
    v_mul_f32 v34, v241, v34
    v_mfma_f32_16x16x32_bf16 v[24:27], a[136:139], v[124:127], v[24:27]
    v_mul_f32 v35, v241, v35
    s_waitcnt vmcnt(9)
    v_mfma_f32_16x16x32_bf16 v[28:31], a[68:71], v[120:123], v[28:31]
    v_max3_u32 v7, v128, v129, v130
    v_max3_u32 v7, v7, v131, v132
    v_mfma_f32_16x16x32_bf16 v[28:31], a[156:159], v[124:127], v[28:31]
    v_max3_u32 v7, v7, v133, v134
    v_max3_u32 v7, v7, v135, v136
    v_mfma_f32_16x16x32_bf16 v[32:35], a[52:55], v[120:123], v[32:35]
    v_max3_u32 v7, v7, v137, v138
    v_max3_u32 v7, v7, v139, v139
    v_mfma_f32_16x16x32_bf16 v[32:35], a[160:163], v[124:127], v[32:35]
    v_cmp_eq_u32 vcc, -1, v7
    s_nop 3
    s_cbranch_vccnz L_slow_44
L_back_45:
    s_waitcnt lgkmcnt(1)
    v_mfma_f32_16x16x32_bf16 v[36:39], a[180:183], v[128:131], v[36:39]
    v_mfma_f32_16x16x32_bf16 v[36:39], a[32:35], v[132:135], v[36:39]
    v_mfma_f32_16x16x32_bf16 v[36:39], v[172:175], v[136:139], v[36:39]
    s_waitcnt lgkmcnt(0)
    v_mfma_f32_16x16x32_bf16 v[40:43], a[164:167], v[128:131], v[40:43]
    v_mfma_f32_16x16x32_bf16 v[40:43], a[16:19], v[132:135], v[40:43]
    v_mfma_f32_16x16x32_bf16 v[40:43], v[176:179], v[136:139], v[40:43]
    s_nop 3
    ds_write_b128 v9, v[36:39] offset:0
    v_mfma_f32_16x16x32_bf16 v[44:47], a[36:39], v[128:131], v[44:47]
    v_mfma_f32_16x16x32_bf16 v[44:47], v[180:183], v[132:135], v[44:47]
    v_mfma_f32_16x16x32_bf16 v[44:47], v[184:187], v[136:139], v[44:47]
    s_waitcnt vmcnt(6)
    v_max3_u32 v7, v140, v141, v142
    v_mfma_f32_16x16x32_bf16 v[48:51], v[188:191], v[128:131], v[48:51]
    v_max3_u32 v7, v7, v143, v144
    v_max3_u32 v7, v7, v145, v146
    v_mfma_f32_16x16x32_bf16 v[48:51], a[40:43], v[132:135], v[48:51]
    v_max3_u32 v7, v7, v147, v148
    v_max3_u32 v7, v7, v149, v150
    v_mfma_f32_16x16x32_bf16 v[48:51], a[60:63], v[136:139], v[48:51]
    v_max3_u32 v7, v7, v151, v151
    v_cmp_eq_u32 vcc, -1, v7
    v_mfma_f32_16x16x32_bf16 v[52:55], a[44:47], v[128:131], v[52:55]
    s_nop 2
    s_cbranch_vccnz L_slow_46
L_back_47:
    v_mfma_f32_16x16x32_bf16 v[52:55], a[64:67], v[132:135], v[52:55]
    ds_write_b128 v9, v[40:43] offset:1024
    v_mfma_f32_16x16x32_bf16 v[52:55], a[120:123], v[136:139], v[52:55]
    ds_write_b128 v9, v[44:47] offset:2048
    v_mfma_f32_16x16x32_bf16 v[56:59], a[180:183], v[140:143], v[56:59]
    ds_write_b128 v9, v[48:51] offset:3072
    v_mfma_f32_16x16x32_bf16 v[56:59], a[32:35], v[144:147], v[56:59]
    v_mfma_f32_16x16x32_bf16 v[56:59], v[172:175], v[148:151], v[56:59]
    s_nop 2
    ds_write_b128 v9, v[52:55] offset:4096
    v_mfma_f32_16x16x32_bf16 v[60:63], a[164:167], v[140:143], v[60:63]
    v_mfma_f32_16x16x32_bf16 v[60:63], a[16:19], v[144:147], v[60:63]
    v_mfma_f32_16x16x32_bf16 v[60:63], v[176:179], v[148:151], v[60:63]
    s_nop 0
    ds_write_b128 v10, v[56:59] offset:0
    v_mfma_f32_16x16x32_bf16 v[64:67], a[36:39], v[140:143], v[64:67]
    v_mfma_f32_16x16x32_bf16 v[64:67], v[180:183], v[144:147], v[64:67]
    v_mfma_f32_16x16x32_bf16 v[64:67], v[184:187], v[148:151], v[64:67]
    s_waitcnt vmcnt(3)
    v_max3_u32 v7, v152, v153, v154
    v_mfma_f32_16x16x32_bf16 v[68:71], v[188:191], v[140:143], v[68:71]
    v_max3_u32 v7, v7, v155, v224
    v_max3_u32 v7, v7, v225, v226
    v_mfma_f32_16x16x32_bf16 v[68:71], a[40:43], v[144:147], v[68:71]
    v_max3_u32 v7, v7, v227, v228
    v_max3_u32 v7, v7, v229, v230
    v_mfma_f32_16x16x32_bf16 v[68:71], a[60:63], v[148:151], v[68:71]
    v_max3_u32 v7, v7, v231, v231
    v_cmp_eq_u32 vcc, -1, v7
    v_mfma_f32_16x16x32_bf16 v[72:75], a[44:47], v[140:143], v[72:75]
    s_nop 2
    s_cbranch_vccnz L_slow_48
L_back_49:
    v_mfma_f32_16x16x32_bf16 v[72:75], a[64:67], v[144:147], v[72:75]
    ds_write_b128 v10, v[60:63] offset:1024
    v_mfma_f32_16x16x32_bf16 v[72:75], a[120:123], v[148:151], v[72:75]
    ds_write_b128 v10, v[64:67] offset:2048
    v_mfma_f32_16x16x32_bf16 v[76:79], a[180:183], v[152:155], v[76:79]
    ds_write_b128 v10, v[68:71] offset:3072
    v_mfma_f32_16x16x32_bf16 v[76:79], a[32:35], v[224:227], v[76:79]
    v_mfma_f32_16x16x32_bf16 v[76:79], v[172:175], v[228:231], v[76:79]
    s_nop 2
    ds_write_b128 v10, v[72:75] offset:4096
    v_mfma_f32_16x16x32_bf16 v[80:83], a[164:167], v[152:155], v[80:83]
    v_mfma_f32_16x16x32_bf16 v[80:83], a[16:19], v[224:227], v[80:83]
    v_mfma_f32_16x16x32_bf16 v[80:83], v[176:179], v[228:231], v[80:83]
    s_nop 0
    ds_write_b128 v11, v[76:79] offset:0
    v_mfma_f32_16x16x32_bf16 v[84:87], a[36:39], v[152:155], v[84:87]
    v_mfma_f32_16x16x32_bf16 v[84:87], v[180:183], v[224:227], v[84:87]
    v_mfma_f32_16x16x32_bf16 v[84:87], v[184:187], v[228:231], v[84:87]
    s_waitcnt vmcnt(0)
    v_max3_u32 v7, v220, v221, v222
    v_mfma_f32_16x16x32_bf16 v[88:91], v[188:191], v[152:155], v[88:91]
    v_max3_u32 v7, v7, v223, v96
    v_max3_u32 v7, v7, v97, v98
    v_mfma_f32_16x16x32_bf16 v[88:91], a[40:43], v[224:227], v[88:91]
    v_max3_u32 v7, v7, v99, v100
    v_max3_u32 v7, v7, v101, v102
    v_mfma_f32_16x16x32_bf16 v[88:91], a[60:63], v[228:231], v[88:91]
    v_max3_u32 v7, v7, v103, v103
    v_cmp_eq_u32 vcc, -1, v7
    v_mfma_f32_16x16x32_bf16 v[92:95], a[44:47], v[152:155], v[92:95]
    s_nop 2
    s_cbranch_vccnz L_slow_50
L_back_51:
    v_mfma_f32_16x16x32_bf16 v[92:95], a[64:67], v[224:227], v[92:95]
    ds_write_b128 v11, v[80:83] offset:1024
    v_mfma_f32_16x16x32_bf16 v[92:95], a[120:123], v[228:231], v[92:95]
    ds_write_b128 v11, v[84:87] offset:2048
    v_mfma_f32_16x16x32_bf16 v[16:19], a[180:183], v[220:223], v[16:19]
    ds_write_b128 v11, v[88:91] offset:3072
    v_mfma_f32_16x16x32_bf16 v[16:19], a[32:35], v[96:99], v[16:19]
    v_mfma_f32_16x16x32_bf16 v[16:19], v[172:175], v[100:103], v[16:19]
    s_nop 2
    ds_write_b128 v11, v[92:95] offset:4096
    v_mfma_f32_16x16x32_bf16 v[20:23], a[164:167], v[220:223], v[20:23]
    v_mfma_f32_16x16x32_bf16 v[20:23], a[16:19], v[96:99], v[20:23]
    v_mfma_f32_16x16x32_bf16 v[20:23], v[176:179], v[100:103], v[20:23]
    v_mfma_f32_16x16x32_bf16 v[24:27], a[36:39], v[220:223], v[24:27]
    v_mfma_f32_16x16x32_bf16 v[24:27], v[180:183], v[96:99], v[24:27]
    s_waitcnt lgkmcnt(0)
    s_barrier
    v_mfma_f32_16x16x32_bf16 v[24:27], v[184:187], v[100:103], v[24:27]
    ds_read_b128 v[36:39], v8 offset:0
    v_mfma_f32_16x16x32_bf16 v[28:31], v[188:191], v[220:223], v[28:31]
    ds_read_b128 v[40:43], v8 offset:5120
    v_mfma_f32_16x16x32_bf16 v[28:31], a[40:43], v[96:99], v[28:31]
    ds_read_b128 v[44:47], v8 offset:10240
    v_mfma_f32_16x16x32_bf16 v[28:31], a[60:63], v[100:103], v[28:31]
    ds_read_b128 v[48:51], v8 offset:1024
    v_mfma_f32_16x16x32_bf16 v[32:35], a[44:47], v[220:223], v[32:35]
    ds_read_b128 v[52:55], v8 offset:6144
    v_mfma_f32_16x16x32_bf16 v[32:35], a[64:67], v[96:99], v[32:35]
    ds_read_b128 v[56:59], v8 offset:11264
    v_mfma_f32_16x16x32_bf16 v[32:35], a[120:123], v[100:103], v[32:35]
    ds_read_b128 v[60:63], v8 offset:2048
    ds_read_b128 v[64:67], v8 offset:7168
    ds_read_b128 v[68:71], v8 offset:12288
    ds_read_b128 v[72:75], v8 offset:3072
    ds_read_b128 v[76:79], v8 offset:8192
    ds_read_b128 v[80:83], v8 offset:13312
    ds_read_b128 v[84:87], v8 offset:4096
    ds_read_b128 v[88:91], v8 offset:9216
    ds_read_b128 v[92:95], v8 offset:14336
    s_waitcnt lgkmcnt(12)
    v_pk_add_f32 v[16:17], v[16:17], v[36:37]
    v_pk_add_f32 v[18:19], v[18:19], v[38:39]
    v_pk_add_f32 v[40:41], v[40:41], v[44:45]
    v_pk_add_f32 v[42:43], v[42:43], v[46:47]
    v_pk_add_f32 v[16:17], v[16:17], v[40:41]
    v_pk_add_f32 v[18:19], v[18:19], v[42:43]
    v_cvt_pk_bf16_f32 v96, v16, v17
    v_cvt_pk_bf16_f32 v97, v18, v19
    s_waitcnt lgkmcnt(9)
    v_pk_add_f32 v[20:21], v[20:21], v[48:49]
    v_pk_add_f32 v[22:23], v[22:23], v[50:51]
    v_pk_add_f32 v[52:53], v[52:53], v[56:57]
    v_pk_add_f32 v[54:55], v[54:55], v[58:59]
    v_pk_add_f32 v[20:21], v[20:21], v[52:53]
    v_pk_add_f32 v[22:23], v[22:23], v[54:55]
    v_cvt_pk_bf16_f32 v98, v20, v21
    v_cvt_pk_bf16_f32 v99, v22, v23
    buffer_store_dwordx4 v[96:99], v12, s[20:23], s77 offen sc1 nt
    s_waitcnt lgkmcnt(6)
    v_pk_add_f32 v[24:25], v[24:25], v[60:61]
    v_pk_add_f32 v[26:27], v[26:27], v[62:63]
    v_pk_add_f32 v[64:65], v[64:65], v[68:69]
    v_pk_add_f32 v[66:67], v[66:67], v[70:71]
    v_pk_add_f32 v[24:25], v[24:25], v[64:65]
    v_pk_add_f32 v[26:27], v[26:27], v[66:67]
    v_cvt_pk_bf16_f32 v100, v24, v25
    v_cvt_pk_bf16_f32 v101, v26, v27
    s_waitcnt lgkmcnt(3)
    v_pk_add_f32 v[28:29], v[28:29], v[72:73]
    v_pk_add_f32 v[30:31], v[30:31], v[74:75]
    v_pk_add_f32 v[76:77], v[76:77], v[80:81]
    v_pk_add_f32 v[78:79], v[78:79], v[82:83]
    v_pk_add_f32 v[28:29], v[28:29], v[76:77]
    v_pk_add_f32 v[30:31], v[30:31], v[78:79]
    v_cvt_pk_bf16_f32 v102, v28, v29
    v_cvt_pk_bf16_f32 v103, v30, v31
    buffer_store_dwordx4 v[100:103], v12, s[20:23], s77 offen offset:64 sc1 nt
    s_waitcnt lgkmcnt(0)
    v_pk_add_f32 v[32:33], v[32:33], v[84:85]
    v_pk_add_f32 v[34:35], v[34:35], v[86:87]
    v_pk_add_f32 v[88:89], v[88:89], v[92:93]
    v_pk_add_f32 v[90:91], v[90:91], v[94:95]
    v_pk_add_f32 v[32:33], v[32:33], v[88:89]
    v_pk_add_f32 v[34:35], v[34:35], v[90:91]
    v_cvt_pk_bf16_f32 v104, v32, v33
    v_cvt_pk_bf16_f32 v105, v34, v35
    buffer_store_dwordx2 v[104:105], v13, s[20:23], s76 offen sc1 nt
    s_endpgm
L_slow_1:
    s_mov_b32 s54, 200000
L_slow_1_l:
    s_sleep 1
    buffer_load_dwordx2 v[248:249], v235, s[16:19], s74 offen sc1
    s_waitcnt vmcnt(0)
    v_cmp_ne_u64 vcc, s[58:59], v[248:249]
    s_sub_u32 s54, s54, 1
    s_nop 2
    s_cbranch_vccz L_slow_1_x
    s_cmp_lg_u32 s54, 0
    s_cbranch_scc1 L_slow_1_l
L_slow_1_x:
    s_nop 4
    s_branch L_back_2
L_slow_4:
    s_mov_b32 s54, 200000
L_slow_4_l:
    s_sleep 1
    buffer_load_dwordx2 v[248:249], v200, s[16:19], s55 offen sc1
    buffer_load_dwordx2 v[250:251], v201, s[16:19], s55 offen sc1
    buffer_load_dwordx2 v[252:253], v202, s[16:19], s55 offen sc1
    buffer_load_dwordx2 v[254:255], v203, s[16:19], s55 offen sc1
    s_waitcnt vmcnt(0)
    v_cmp_ne_u64 vcc, s[58:59], v[248:249]
    v_cmp_ne_u64 s[28:29], s[58:59], v[250:251]
    v_cmp_ne_u64 s[30:31], s[58:59], v[252:253]
    v_cmp_ne_u64 s[46:47], s[58:59], v[254:255]
    s_nop 1
    s_or_b64 vcc, vcc, s[28:29]
    s_or_b64 vcc, vcc, s[30:31]
    s_or_b64 vcc, vcc, s[46:47]
    s_sub_u32 s54, s54, 1
    s_cbranch_vccz L_slow_4_x
    s_cmp_lg_u32 s54, 0
    s_cbranch_scc1 L_slow_4_l
L_slow_4_x:
    s_nop 4
    s_branch L_back_5
L_slow_6:
    s_mov_b32 s54, 200000
L_slow_6_l:
    s_sleep 1
    buffer_load_dwordx4 v[16:19], v12, s[16:19], s32 offen sc1
    buffer_load_dwordx4 v[20:23], v12, s[16:19], s33 offen sc1
    buffer_load_dwordx4 v[24:27], v12, s[16:19], s34 offen sc1
    buffer_load_dwordx4 v[28:31], v12, s[16:19], s35 offen sc1
    s_waitcnt vmcnt(0)
    v_xor_b32 v9, s58, v16
    v_bitop3_b32 v9, v17, s58, v9 bitop3:0xbe
    v_bitop3_b32 v9, v18, s58, v9 bitop3:0xbe
    v_bitop3_b32 v9, v19, s58, v9 bitop3:0xbe
    v_bitop3_b32 v9, v20, s58, v9 bitop3:0xbe
    v_bitop3_b32 v9, v21, s58, v9 bitop3:0xbe
    v_bitop3_b32 v9, v22, s58, v9 bitop3:0xbe
    v_bitop3_b32 v9, v23, s58, v9 bitop3:0xbe
    v_bitop3_b32 v9, v24, s58, v9 bitop3:0xbe
    v_bitop3_b32 v9, v25, s58, v9 bitop3:0xbe
    v_bitop3_b32 v9, v26, s58, v9 bitop3:0xbe
    v_bitop3_b32 v9, v27, s58, v9 bitop3:0xbe
    v_bitop3_b32 v9, v28, s58, v9 bitop3:0xbe
    v_bitop3_b32 v9, v29, s58, v9 bitop3:0xbe
    v_bitop3_b32 v9, v30, s58, v9 bitop3:0xbe
    v_bitop3_b32 v9, v31, s58, v9 bitop3:0xbe
    v_and_b32 v9, 1023, v9
    v_cmp_ne_u32 vcc, 0, v9
    s_sub_u32 s54, s54, 1
    s_nop 2
    s_cbranch_vccz L_slow_6_x
    s_cmp_lg_u32 s54, 0
    s_cbranch_scc1 L_slow_6_l
L_slow_6_x:
    s_nop 4
    s_branch L_back_7
L_slow_8:
    s_mov_b32 s54, 200000
L_slow_8_l:
    s_sleep 1
    buffer_load_dwordx2 v[252:253], v235, s[16:19], s83 offen sc1
    s_waitcnt vmcnt(0)
    v_cmp_ne_u64 vcc, s[58:59], v[252:253]
    s_sub_u32 s54, s54, 1
    s_nop 2
    s_cbranch_vccz L_slow_8_x
    s_cmp_lg_u32 s54, 0
    s_cbranch_scc1 L_slow_8_l
L_slow_8_x:
    s_nop 4
    s_branch L_back_9
L_slow_10:
    s_mov_b32 s54, 200000
L_slow_10_l:
    s_sleep 1
    buffer_load_dwordx2 v[252:253], v235, s[16:19], s84 offen sc1
    s_waitcnt vmcnt(0)
    v_cmp_ne_u64 vcc, s[58:59], v[252:253]
    s_sub_u32 s54, s54, 1
    s_nop 2
    s_cbranch_vccz L_slow_10_x
    s_cmp_lg_u32 s54, 0
    s_cbranch_scc1 L_slow_10_l
L_slow_10_x:
    s_nop 4
    s_branch L_back_11
L_slow_12:
    s_mov_b32 s54, 200000
L_slow_12_l:
    s_sleep 1
    s_add_u32 s75, s96, 221184
    buffer_load_dwordx4 v[192:195], v237, s[16:19], s75 offen sc1
    s_add_u32 s75, s96, 237568
    buffer_load_dwordx4 v[196:199], v237, s[16:19], s75 offen sc1
    s_waitcnt vmcnt(0)
    v_max3_u32 v7, v192, v193, v194
    v_max3_u32 v7, v7, v195, v196
    v_max3_u32 v7, v7, v197, v198
    v_max3_u32 v7, v7, v199, v199
    v_cmp_eq_u32 vcc, -1, v7
    s_sub_u32 s54, s54, 1
    s_nop 2
    s_cbranch_vccz L_slow_12_x
    s_cmp_lg_u32 s54, 0
    s_cbranch_scc1 L_slow_12_l
L_slow_12_x:
    s_nop 4
    s_branch L_back_13
L_slow_14:
    s_mov_b32 s54, 200000
L_slow_14_l:
    s_sleep 1
    s_add_u32 s75, s96, 221184
    buffer_load_dwordx4 v[96:99], v238, s[16:19], s75 offen sc1
    s_add_u32 s75, s96, 237568
    buffer_load_dwordx4 v[100:103], v238, s[16:19], s75 offen sc1
    s_waitcnt vmcnt(0)
    v_max3_u32 v7, v96, v97, v98
    v_max3_u32 v7, v7, v99, v100
    v_max3_u32 v7, v7, v101, v102
    v_max3_u32 v7, v7, v103, v103
    v_cmp_eq_u32 vcc, -1, v7
    s_sub_u32 s54, s54, 1
    s_nop 2
    s_cbranch_vccz L_slow_14_x
    s_cmp_lg_u32 s54, 0
    s_cbranch_scc1 L_slow_14_l
L_slow_14_x:
    s_nop 4
    s_branch L_back_15
L_slow_16:
    s_mov_b32 s54, 200000
L_slow_16_l:
    s_sleep 1
    s_add_u32 s75, s96, 221184
    buffer_load_dwordx4 v[104:107], v239, s[16:19], s75 offen sc1
    s_add_u32 s75, s96, 237568
    buffer_load_dwordx4 v[108:111], v239, s[16:19], s75 offen sc1
    s_waitcnt vmcnt(0)
    v_max3_u32 v7, v104, v105, v106
    v_max3_u32 v7, v7, v107, v108
    v_max3_u32 v7, v7, v109, v110
    v_max3_u32 v7, v7, v111, v111
    v_cmp_eq_u32 vcc, -1, v7
    s_sub_u32 s54, s54, 1
    s_nop 2
    s_cbranch_vccz L_slow_16_x
    s_cmp_lg_u32 s54, 0
    s_cbranch_scc1 L_slow_16_l
L_slow_16_x:
    s_nop 4
    s_branch L_back_17
L_slow_18:
    s_mov_b32 s54, 200000
L_slow_18_l:
    s_sleep 1
    s_add_u32 s75, s96, 221184
    buffer_load_dwordx4 v[112:115], v236, s[16:19], s75 offen sc1
    s_add_u32 s75, s96, 237568
    buffer_load_dwordx4 v[200:203], v236, s[16:19], s75 offen sc1
    s_waitcnt vmcnt(0)
    v_max3_u32 v7, v112, v113, v114
    v_max3_u32 v7, v7, v115, v200
    v_max3_u32 v7, v7, v201, v202
    v_max3_u32 v7, v7, v203, v203
    v_cmp_eq_u32 vcc, -1, v7
    s_sub_u32 s54, s54, 1
    s_nop 2
    s_cbranch_vccz L_slow_18_x
    s_cmp_lg_u32 s54, 0
    s_cbranch_scc1 L_slow_18_l
L_slow_18_x:
    s_nop 4
    s_branch L_back_19
L_slow_20:
    s_mov_b32 s54, 200000
L_slow_20_l:
    s_sleep 1
    s_add_u32 s75, s96, 253952
    buffer_load_dwordx4 v[204:207], v237, s[16:19], s75 offen sc1
    s_add_u32 s75, s96, 270336
    buffer_load_dwordx4 v[208:211], v237, s[16:19], s75 offen sc1
    s_add_u32 s75, s96, 286720
    buffer_load_dwordx4 v[212:215], v237, s[16:19], s75 offen sc1
    s_waitcnt vmcnt(0)
    v_max3_u32 v7, v204, v205, v206
    v_max3_u32 v7, v7, v207, v208
    v_max3_u32 v7, v7, v209, v210
    v_max3_u32 v7, v7, v211, v212
    v_max3_u32 v7, v7, v213, v214
    v_max3_u32 v7, v7, v215, v215
    v_cmp_eq_u32 vcc, -1, v7
    s_sub_u32 s54, s54, 1
    s_nop 2
    s_cbranch_vccz L_slow_20_x
    s_cmp_lg_u32 s54, 0
    s_cbranch_scc1 L_slow_20_l
L_slow_20_x:
    s_nop 4
    s_branch L_back_21
L_slow_22:
    s_mov_b32 s54, 200000
L_slow_22_l:
    s_sleep 1
    s_add_u32 s75, s96, 253952
    buffer_load_dwordx4 v[216:219], v238, s[16:19], s75 offen sc1
    s_add_u32 s75, s96, 270336
    buffer_load_dwordx4 v[220:223], v238, s[16:19], s75 offen sc1
    s_add_u32 s75, s96, 286720
    buffer_load_dwordx4 v[116:119], v238, s[16:19], s75 offen sc1
    s_waitcnt vmcnt(0)
    v_max3_u32 v7, v216, v217, v218
    v_max3_u32 v7, v7, v219, v220
    v_max3_u32 v7, v7, v221, v222
    v_max3_u32 v7, v7, v223, v116
    v_max3_u32 v7, v7, v117, v118
    v_max3_u32 v7, v7, v119, v119
    v_cmp_eq_u32 vcc, -1, v7
    s_sub_u32 s54, s54, 1
    s_nop 2
    s_cbranch_vccz L_slow_22_x
    s_cmp_lg_u32 s54, 0
    s_cbranch_scc1 L_slow_22_l
L_slow_22_x:
    s_nop 4
    s_branch L_back_23
L_slow_24:
    s_mov_b32 s54, 200000
L_slow_24_l:
    s_sleep 1
    s_add_u32 s75, s96, 253952
    buffer_load_dwordx4 v[120:123], v239, s[16:19], s75 offen sc1
    s_add_u32 s75, s96, 270336
    buffer_load_dwordx4 v[124:127], v239, s[16:19], s75 offen sc1
    s_add_u32 s75, s96, 286720
    buffer_load_dwordx4 v[128:131], v239, s[16:19], s75 offen sc1
    s_waitcnt vmcnt(0)
    v_max3_u32 v7, v120, v121, v122
    v_max3_u32 v7, v7, v123, v124
    v_max3_u32 v7, v7, v125, v126
    v_max3_u32 v7, v7, v127, v128
    v_max3_u32 v7, v7, v129, v130
    v_max3_u32 v7, v7, v131, v131
    v_cmp_eq_u32 vcc, -1, v7
    s_sub_u32 s54, s54, 1
    s_nop 2
    s_cbranch_vccz L_slow_24_x
    s_cmp_lg_u32 s54, 0
    s_cbranch_scc1 L_slow_24_l
L_slow_24_x:
    s_nop 4
    s_branch L_back_25
L_slow_26:
    s_mov_b32 s54, 200000
L_slow_26_l:
    s_sleep 1
    s_add_u32 s75, s96, 253952
    buffer_load_dwordx4 v[132:135], v236, s[16:19], s75 offen sc1
    s_add_u32 s75, s96, 270336
    buffer_load_dwordx4 v[136:139], v236, s[16:19], s75 offen sc1
    s_add_u32 s75, s96, 286720
    buffer_load_dwordx4 v[140:143], v236, s[16:19], s75 offen sc1
    s_waitcnt vmcnt(0)
    v_max3_u32 v7, v132, v133, v134
    v_max3_u32 v7, v7, v135, v136
    v_max3_u32 v7, v7, v137, v138
    v_max3_u32 v7, v7, v139, v140
    v_max3_u32 v7, v7, v141, v142
    v_max3_u32 v7, v7, v143, v143
    v_cmp_eq_u32 vcc, -1, v7
    s_sub_u32 s54, s54, 1
    s_nop 2
    s_cbranch_vccz L_slow_26_x
    s_cmp_lg_u32 s54, 0
    s_cbranch_scc1 L_slow_26_l
L_slow_26_x:
    s_nop 4
    s_branch L_back_27
L_slow_28:
    s_mov_b32 s54, 200000
L_slow_28_l:
    s_sleep 1
    buffer_load_dwordx2 v[248:249], v235, s[16:19], s74 offen sc1
    s_waitcnt vmcnt(0)
    v_cmp_ne_u64 vcc, s[58:59], v[248:249]
    s_sub_u32 s54, s54, 1
    s_nop 2
    s_cbranch_vccz L_slow_28_x
    s_cmp_lg_u32 s54, 0
    s_cbranch_scc1 L_slow_28_l
L_slow_28_x:
    s_nop 4
    s_branch L_back_29
L_slow_30:
    s_mov_b32 s54, 200000
L_slow_30_l:
    s_sleep 1
    buffer_load_dwordx2 v[252:253], v235, s[16:19], s83 offen sc1
    s_waitcnt vmcnt(0)
    v_cmp_ne_u64 vcc, s[58:59], v[252:253]
    s_sub_u32 s54, s54, 1
    s_nop 2
    s_cbranch_vccz L_slow_30_x
    s_cmp_lg_u32 s54, 0
    s_cbranch_scc1 L_slow_30_l
L_slow_30_x:
    s_nop 4
    s_branch L_back_31
L_slow_32:
    s_mov_b32 s54, 200000
L_slow_32_l:
    s_sleep 1
    buffer_load_dwordx4 v[204:207], v6, s[16:19], s89 offen offset:0 sc1
    buffer_load_dwordx4 v[208:211], v6, s[16:19], s89 offen offset:1024 sc1
    buffer_load_dwordx4 v[212:215], v6, s[16:19], s89 offen offset:2048 sc1
    buffer_load_dwordx4 v[216:219], v6, s[16:19], s89 offen offset:2816 sc1
    buffer_load_dwordx4 v[248:251], v13, s[16:19], s43 offen offset:0 sc1
    buffer_load_dwordx4 v[252:255], v13, s[16:19], s43 offen offset:256 sc1
    s_waitcnt vmcnt(0)
    v_xor_b32 v8, s58, v204
    v_bitop3_b32 v8, v205, s58, v8 bitop3:0xbe
    v_bitop3_b32 v8, v206, s58, v8 bitop3:0xbe
    v_bitop3_b32 v8, v207, s58, v8 bitop3:0xbe
    v_bitop3_b32 v8, v208, s58, v8 bitop3:0xbe
    v_bitop3_b32 v8, v209, s58, v8 bitop3:0xbe
    v_bitop3_b32 v8, v210, s58, v8 bitop3:0xbe
    v_bitop3_b32 v8, v211, s58, v8 bitop3:0xbe
    v_bitop3_b32 v8, v212, s58, v8 bitop3:0xbe
    v_bitop3_b32 v8, v213, s58, v8 bitop3:0xbe
    v_bitop3_b32 v8, v214, s58, v8 bitop3:0xbe
    v_bitop3_b32 v8, v215, s58, v8 bitop3:0xbe
    v_bitop3_b32 v8, v216, s58, v8 bitop3:0xbe
    v_bitop3_b32 v8, v217, s58, v8 bitop3:0xbe
    v_bitop3_b32 v8, v218, s58, v8 bitop3:0xbe
    v_bitop3_b32 v8, v219, s58, v8 bitop3:0xbe
    v_bitop3_b32 v8, v248, s58, v8 bitop3:0xbe
    v_bitop3_b32 v8, v249, s58, v8 bitop3:0xbe
    v_bitop3_b32 v8, v250, s58, v8 bitop3:0xbe
    v_bitop3_b32 v8, v251, s58, v8 bitop3:0xbe
    v_bitop3_b32 v8, v252, s58, v8 bitop3:0xbe
    v_bitop3_b32 v8, v253, s58, v8 bitop3:0xbe
    v_bitop3_b32 v8, v254, s58, v8 bitop3:0xbe
    v_bitop3_b32 v8, v255, s58, v8 bitop3:0xbe
    v_and_b32 v8, 1023, v8
    v_cmp_ne_u32 vcc, 0, v8
    s_sub_u32 s54, s54, 1
    s_nop 2
    s_cbranch_vccz L_slow_32_x
    s_cmp_lg_u32 s54, 0
    s_cbranch_scc1 L_slow_32_l
L_slow_32_x:
    s_nop 4
    s_branch L_back_33
L_slow_34:
    s_mov_b32 s54, 200000
L_slow_34_l:
    s_sleep 1
    buffer_load_dwordx2 v[252:253], v235, s[16:19], s84 offen sc1
    s_waitcnt vmcnt(0)
    v_cmp_ne_u64 vcc, s[58:59], v[252:253]
    s_sub_u32 s54, s54, 1
    s_nop 2
    s_cbranch_vccz L_slow_34_x
    s_cmp_lg_u32 s54, 0
    s_cbranch_scc1 L_slow_34_l
L_slow_34_x:
    s_nop 4
    s_branch L_back_35
L_slow_36:
    s_mov_b32 s54, 200000
L_slow_36_l:
    s_sleep 1
    s_add_u32 s75, s96, 221184
    buffer_load_dwordx4 v[192:195], v237, s[16:19], s75 offen sc1
    s_add_u32 s75, s96, 237568
    buffer_load_dwordx4 v[196:199], v237, s[16:19], s75 offen sc1
    s_waitcnt vmcnt(0)
    v_max3_u32 v7, v192, v193, v194
    v_max3_u32 v7, v7, v195, v196
    v_max3_u32 v7, v7, v197, v198
    v_max3_u32 v7, v7, v199, v199
    v_cmp_eq_u32 vcc, -1, v7
    s_sub_u32 s54, s54, 1
    s_nop 2
    s_cbranch_vccz L_slow_36_x
    s_cmp_lg_u32 s54, 0
    s_cbranch_scc1 L_slow_36_l
L_slow_36_x:
    s_nop 4
    s_branch L_back_37
L_slow_38:
    s_mov_b32 s54, 200000
L_slow_38_l:
    s_sleep 1
    s_add_u32 s75, s96, 221184
    buffer_load_dwordx4 v[200:203], v238, s[16:19], s75 offen sc1
    s_add_u32 s75, s96, 237568
    buffer_load_dwordx4 v[156:159], v238, s[16:19], s75 offen sc1
    s_waitcnt vmcnt(0)
    v_max3_u32 v7, v200, v201, v202
    v_max3_u32 v7, v7, v203, v156
    v_max3_u32 v7, v7, v157, v158
    v_max3_u32 v7, v7, v159, v159
    v_cmp_eq_u32 vcc, -1, v7
    s_sub_u32 s54, s54, 1
    s_nop 2
    s_cbranch_vccz L_slow_38_x
    s_cmp_lg_u32 s54, 0
    s_cbranch_scc1 L_slow_38_l
L_slow_38_x:
    s_nop 4
    s_branch L_back_39
L_slow_40:
    s_mov_b32 s54, 200000
L_slow_40_l:
    s_sleep 1
    s_add_u32 s75, s96, 221184
    buffer_load_dwordx4 v[160:163], v239, s[16:19], s75 offen sc1
    s_add_u32 s75, s96, 237568
    buffer_load_dwordx4 v[116:119], v239, s[16:19], s75 offen sc1
    s_waitcnt vmcnt(0)
    v_max3_u32 v7, v160, v161, v162
    v_max3_u32 v7, v7, v163, v116
    v_max3_u32 v7, v7, v117, v118
    v_max3_u32 v7, v7, v119, v119
    v_cmp_eq_u32 vcc, -1, v7
    s_sub_u32 s54, s54, 1
    s_nop 2
    s_cbranch_vccz L_slow_40_x
    s_cmp_lg_u32 s54, 0
    s_cbranch_scc1 L_slow_40_l
L_slow_40_x:
    s_nop 4
    s_branch L_back_41
L_slow_42:
    s_mov_b32 s54, 200000
L_slow_42_l:
    s_sleep 1
    s_add_u32 s75, s96, 221184
    buffer_load_dwordx4 v[120:123], v236, s[16:19], s75 offen sc1
    s_add_u32 s75, s96, 237568
    buffer_load_dwordx4 v[124:127], v236, s[16:19], s75 offen sc1
    s_waitcnt vmcnt(0)
    v_max3_u32 v7, v120, v121, v122
    v_max3_u32 v7, v7, v123, v124
    v_max3_u32 v7, v7, v125, v126
    v_max3_u32 v7, v7, v127, v127
    v_cmp_eq_u32 vcc, -1, v7
    s_sub_u32 s54, s54, 1
    s_nop 2
    s_cbranch_vccz L_slow_42_x
    s_cmp_lg_u32 s54, 0
    s_cbranch_scc1 L_slow_42_l
L_slow_42_x:
    s_nop 4
    s_branch L_back_43
L_slow_44:
    s_mov_b32 s54, 200000
L_slow_44_l:
    s_sleep 1
    s_add_u32 s75, s96, 253952
    buffer_load_dwordx4 v[128:131], v237, s[16:19], s75 offen sc1
    s_add_u32 s75, s96, 270336
    buffer_load_dwordx4 v[132:135], v237, s[16:19], s75 offen sc1
    s_add_u32 s75, s96, 286720
    buffer_load_dwordx4 v[136:139], v237, s[16:19], s75 offen sc1
    s_waitcnt vmcnt(0)
    v_max3_u32 v7, v128, v129, v130
    v_max3_u32 v7, v7, v131, v132
    v_max3_u32 v7, v7, v133, v134
    v_max3_u32 v7, v7, v135, v136
    v_max3_u32 v7, v7, v137, v138
    v_max3_u32 v7, v7, v139, v139
    v_cmp_eq_u32 vcc, -1, v7
    s_sub_u32 s54, s54, 1
    s_nop 2
    s_cbranch_vccz L_slow_44_x
    s_cmp_lg_u32 s54, 0
    s_cbranch_scc1 L_slow_44_l
L_slow_44_x:
    s_nop 4
    s_branch L_back_45
L_slow_46:
    s_mov_b32 s54, 200000
L_slow_46_l:
    s_sleep 1
    s_add_u32 s75, s96, 253952
    buffer_load_dwordx4 v[140:143], v238, s[16:19], s75 offen sc1
    s_add_u32 s75, s96, 270336
    buffer_load_dwordx4 v[144:147], v238, s[16:19], s75 offen sc1
    s_add_u32 s75, s96, 286720
    buffer_load_dwordx4 v[148:151], v238, s[16:19], s75 offen sc1
    s_waitcnt vmcnt(0)
    v_max3_u32 v7, v140, v141, v142
    v_max3_u32 v7, v7, v143, v144
    v_max3_u32 v7, v7, v145, v146
    v_max3_u32 v7, v7, v147, v148
    v_max3_u32 v7, v7, v149, v150
    v_max3_u32 v7, v7, v151, v151
    v_cmp_eq_u32 vcc, -1, v7
    s_sub_u32 s54, s54, 1
    s_nop 2
    s_cbranch_vccz L_slow_46_x
    s_cmp_lg_u32 s54, 0
    s_cbranch_scc1 L_slow_46_l
L_slow_46_x:
    s_nop 4
    s_branch L_back_47
L_slow_48:
    s_mov_b32 s54, 200000
L_slow_48_l:
    s_sleep 1
    s_add_u32 s75, s96, 253952
    buffer_load_dwordx4 v[152:155], v239, s[16:19], s75 offen sc1
    s_add_u32 s75, s96, 270336
    buffer_load_dwordx4 v[224:227], v239, s[16:19], s75 offen sc1
    s_add_u32 s75, s96, 286720
    buffer_load_dwordx4 v[228:231], v239, s[16:19], s75 offen sc1
    s_waitcnt vmcnt(0)
    v_max3_u32 v7, v152, v153, v154
    v_max3_u32 v7, v7, v155, v224
    v_max3_u32 v7, v7, v225, v226
    v_max3_u32 v7, v7, v227, v228
    v_max3_u32 v7, v7, v229, v230
    v_max3_u32 v7, v7, v231, v231
    v_cmp_eq_u32 vcc, -1, v7
    s_sub_u32 s54, s54, 1
    s_nop 2
    s_cbranch_vccz L_slow_48_x
    s_cmp_lg_u32 s54, 0
    s_cbranch_scc1 L_slow_48_l
L_slow_48_x:
    s_nop 4
    s_branch L_back_49
L_slow_50:
    s_mov_b32 s54, 200000
L_slow_50_l:
    s_sleep 1
    s_add_u32 s75, s96, 253952
    buffer_load_dwordx4 v[220:223], v236, s[16:19], s75 offen sc1
    s_add_u32 s75, s96, 270336
    buffer_load_dwordx4 v[96:99], v236, s[16:19], s75 offen sc1
    s_add_u32 s75, s96, 286720
    buffer_load_dwordx4 v[100:103], v236, s[16:19], s75 offen sc1
    s_waitcnt vmcnt(0)
    v_max3_u32 v7, v220, v221, v222
    v_max3_u32 v7, v7, v223, v96
    v_max3_u32 v7, v7, v97, v98
    v_max3_u32 v7, v7, v99, v100
    v_max3_u32 v7, v7, v101, v102
    v_max3_u32 v7, v7, v103, v103
    v_cmp_eq_u32 vcc, -1, v7
    s_sub_u32 s54, s54, 1
    s_nop 2
    s_cbranch_vccz L_slow_50_x
    s_cmp_lg_u32 s54, 0
    s_cbranch_scc1 L_slow_50_l
L_slow_50_x:
    s_nop 4
    s_branch L_back_51
L_end:
    s_endpgm
.fill 64, 4, 0xbf800000
.section .rodata,"a"
.p2align 6
.amdhsa_kernel gated_mix__linear_kernel_hedgehog__dense_activation_gelu__prompt_kernel
  .amdhsa_next_free_vgpr 512
  .amdhsa_next_free_sgpr 102
  .amdhsa_accum_offset 256
  .amdhsa_group_segment_fixed_size 0
  .amdhsa_kernarg_size 104
  .amdhsa_user_sgpr_count 2
  .amdhsa_user_sgpr_kernarg_segment_ptr 1
  .amdhsa_system_sgpr_workgroup_id_x 1
.end_amdhsa_kernel
```
